```python
import torch

def _softmax(x, axis=-1):
    return torch.softmax(x, dim=axis)
def _gelu(x):
    return torch.nn.functional.gelu(x, approximate="tanh")
def _silu(x):
    return torch.nn.functional.silu(x)
def _sigmoid(x):
    return torch.sigmoid(x)
def _layernorm(x, axis=-1, eps=1e-5):
    m = x.mean(dim=axis, keepdim=True)
    v = x.var(dim=axis, keepdim=True, unbiased=False)
    return (x - m) / torch.sqrt(v + eps)
def _scatter_add(tgt, idx, src, axis=0):
    return tgt.clone().index_add_(axis, idx, src)
def _segment_sum(src, seg, n):
    out = torch.zeros((n,) + src.shape[1:], dtype=src.dtype)
    return out.index_add_(0, seg, src)
def _pad(x, pw):
    flat = tuple(v for pair in reversed(pw) for v in pair)
    return torch.nn.functional.pad(x, flat)

kernel_name = 'recurrent_scan__ssm_conv_s4__dense_activation_silu__prompt'

def setup_inputs():

    _w = (lambda a: (lambda t: t.to(torch.bfloat16) if t.is_floating_point() else t)(torch.as_tensor(a)))
    def _A_setup():
        B, L, D, N = 1, 2048, 576, 128
        A_re = -(lambda _x: torch.exp(torch.as_tensor(_x)))((lambda *s: torch.randn(*s, dtype=torch.bfloat16) * 3.2)(D, N))
        A_im = torch.pi * (lambda *s: torch.randn(*s, dtype=torch.bfloat16) * 0.2)(D, N)
        B_re = (lambda *s: torch.randn(*s, dtype=torch.bfloat16) * 0.2)(D, N)
        B_im = (lambda *s: torch.randn(*s, dtype=torch.bfloat16) * 0.2)(D, N)
        C_re = (lambda *s: torch.randn(*s, dtype=torch.bfloat16) * 0.2)(D, N)
        C_im = (lambda *s: torch.randn(*s, dtype=torch.bfloat16) * 0.2)(D, N)
        log_dt = (lambda *s: torch.randn(*s, dtype=torch.bfloat16) * 0.2)(D) * 0.5 - 4.0
        Dskip = (lambda *s: torch.randn(*s, dtype=torch.bfloat16) * 0.2)(D)
        return {
            "u": _w((lambda *s: torch.randn(*s, dtype=torch.bfloat16) * 0.05)(B, L, D)),
            "A_re": _w(A_re),
            "A_im": _w(A_im),
            "B_re": _w(B_re),
            "B_im": _w(B_im),
            "C_re": _w(C_re),
            "C_im": _w(C_im),
            "log_dt": _w(log_dt),
            "Dskip": _w(Dskip),
        }
    _A_in = _A_setup()

    def _B_setup():
        B, S, D, F = 1, 2048, 576, 4608
        return {
            "x": _w((lambda *s: torch.randn(*s, dtype=torch.bfloat16) * 0.05)(B, S, D)),
            "w1": _w((lambda *s: torch.randn(*s, dtype=torch.bfloat16) * 0.8)(D, F) * (D ** -0.5)),
            "w2": _w((lambda *s: torch.randn(*s, dtype=torch.bfloat16) * 0.1)(F, D) * (F ** -0.5)),
        }
    _B_in = _B_setup()

    return {
        "A_u": _A_in["u"],
        "A_A_re": _A_in["A_re"],
        "A_A_im": _A_in["A_im"],
        "A_B_re": _A_in["B_re"],
        "A_B_im": _A_in["B_im"],
        "A_C_re": _A_in["C_re"],
        "A_C_im": _A_in["C_im"],
        "A_log_dt": _A_in["log_dt"],
        "A_Dskip": _A_in["Dskip"],
        "B_x": _B_in["x"],
        "B_w1": _B_in["w1"],
        "B_w2": _B_in["w2"],
    }

def reference(A_u, A_A_re, A_A_im, A_B_re, A_B_im, A_C_re, A_C_im, A_log_dt, A_Dskip, B_x, B_w1, B_w2):
    def _A_ref(u, A_re, A_im, B_re, B_im, C_re, C_im, log_dt, Dskip):
        Bsz, L, D = u.shape
        dt = torch.exp(log_dt)[:, None]
        A = A_re + 1j * A_im
        Bc = B_re + 1j * B_im
        Cc = C_re + 1j * C_im
        logdA = dt * A
        dB = dt * Bc
        l = (lambda x, dt: x.to(dt))(torch.arange(L), A_re.dtype)
        P = torch.exp(logdA[:, :, None] * l[None, None, :])
        K = torch.einsum("dn,dnl,dn->dl", Cc, P, dB).real
        L2 = 2 * L
        Kp = _pad(K, ((0, 0), (0, L)))
        up = (lambda x, *d: x.permute(*d))(u, 0, 2, 1)
        up = _pad(up, ((0, 0), (0, 0), (0, L)))
        Kf = (lambda x, axes=(-2,-1): torch.fft.rfft2(x.float(), dim=axes))(Kp[:, None, :], axes=(-2, -1))
        Uf = (lambda x, axes=(-2,-1): torch.fft.rfft2(x.float(), dim=axes))(up[:, :, None, :], axes=(-2, -1))
        Yf = Uf * Kf[None, :, :, :]
        y = (lambda x, s, axes=(-2,-1): torch.fft.irfft2(x, s=s, dim=axes).to(torch.bfloat16))(Yf, (1, L2), axes=(-2, -1))[:, :, 0, :L]
        y = (lambda x, *d: x.permute(*d))(y, 0, 2, 1) + u * Dskip[None, None, :]
        return y

    def _B_ref(x, w1, w2):
        h = torch.einsum("bsd,df->bsf", x, w1)
        h = _silu(h)
        out = torch.einsum("bsf,fd->bsd", h, w2)
        return out

    x = A_u
    xn = _layernorm(x, axis=-1)
    s = _A_ref(xn, A_A_re, A_A_im, A_B_re, A_B_im, A_C_re, A_C_im, A_log_dt, A_Dskip)
    g = _silu(_B_ref(xn, B_w1, B_w2))
    return x + s * g
```

```asm
; @launch grid=(256,1,1) block=(256,1,1) lds=163840
.amdgcn_target "amdgcn-amd-amdhsa--gfx950"
.text
.globl recurrent_scan__ssm_conv_s4__dense_activation_silu__prompt_kernel
.p2align 8
.type recurrent_scan__ssm_conv_s4__dense_activation_silu__prompt_kernel,@function
recurrent_scan__ssm_conv_s4__dense_activation_silu__prompt_kernel:
    s_cmp_ge_u32 s2, 256
    s_cbranch_scc1 L_ka_end
    s_getpc_b64 s[40:41]
L_pc0:
    s_bfe_u32 s42, s2, 0x40003
    v_and_b32 v234, 31, v0
    v_lshl_add_u32 v234, v234, 4, s42
    v_lshlrev_b32 v234, 7, v234
    v_min_u32 v234, L_code_end-4-L_pc0, v234
    global_load_dword a253, v234, s[40:41]
    s_load_dwordx2 s[12:13], s[0:1], 0
    s_load_dwordx4 s[44:47], s[0:1], 80
    s_load_dwordx4 s[96:99], s[0:1], 104
    s_load_dwordx16 s[76:91], s[0:1], 8
    v_lshrrev_b32 v232, 6, v0
    v_and_b32 v253, 63, v0
    s_nop 0
    v_readfirstlane_b32 s20, v232
    s_and_b32 s40, s2, 7
    s_lshl_b32 s40, s40, 2
    s_lshr_b32 s22, 0x75643210, s40
    s_and_b32 s22, s22, 7
    s_lshr_b32 s21, s2, 4
    s_bfe_u32 s23, s2, 0x10003
    s_lshl_b32 s40, s21, 1
    s_add_u32 s70, s40, s23
    v_lshrrev_b32 v160, 3, v253
    v_and_b32 v161, 7, v253
    v_lshrrev_b32 v162, 1, v160
    v_xor_b32 v163, v161, v162
    v_lshlrev_b32 v163, 4, v163
    v_mul_u32_u24 v164, 1152, v160
    v_add_u32 v165, v163, v164
    v_xor_b32 v163, 64, v163
    v_add_u32 v166, v163, v164
    s_lshl_b32 s40, s21, 2
    s_add_u32 s40, s40, s20
    s_mul_i32 s40, s40, 36864
    s_mul_i32 s48, s20, 36864
    s_mov_b32 s92, s40
    s_add_u32 s94, s40, 18432
    s_mov_b32 s72, s48
    s_add_u32 s73, s48, 18432
    s_add_u32 s93, s92, 9216
    s_add_u32 s95, s94, 9216
    s_mov_b32 s14, 2359296
    s_mov_b32 s15, 0x00020000
    s_waitcnt lgkmcnt(0)
    s_add_u32 m0, s72, 0
    s_nop 0
    buffer_load_dwordx4 v165, s[12:15], s92 offen offset:0 lds
    s_add_u32 m0, s72, 9216
    s_nop 0
    buffer_load_dwordx4 v166, s[12:15], s93 offen offset:0 lds
    s_add_u32 m0, s73, 0
    s_nop 0
    buffer_load_dwordx4 v165, s[12:15], s94 offen offset:0 lds
    s_add_u32 m0, s73, 9216
    s_nop 0
    buffer_load_dwordx4 v166, s[12:15], s95 offen offset:0 lds
    s_add_u32 m0, s72, 896
    s_nop 0
    buffer_load_dwordx4 v165, s[12:15], s92 offen offset:128 lds
    s_add_u32 m0, s72, 10112
    s_nop 0
    buffer_load_dwordx4 v166, s[12:15], s93 offen offset:128 lds
    s_mul_i32 s68, s70, 6
    s_add_u32 s68, s68, s22
    s_mul_i32 s101, s68, 3
    s_min_u32 s101, s101, 573
    s_and_b32 s68, s20, 1
    s_lshl_b32 s68, s68, 7
    s_lshl_b32 s69, s101, 8
    s_add_u32 s68, s68, s69
    v_lshl_add_u32 v232, v253, 1, s68
    s_lshl_b32 s69, s101, 1
    v_mov_b32 v233, s69
    global_load_ushort v218, v233, s[88:89] offset:0
    global_load_ushort v221, v233, s[90:91] offset:0
    global_load_ushort v200, v232, s[76:77] offset:0
    global_load_ushort v201, v232, s[78:79] offset:0
    global_load_ushort v202, v232, s[80:81] offset:0
    global_load_ushort v203, v232, s[82:83] offset:0
    global_load_ushort v204, v232, s[84:85] offset:0
    global_load_ushort v205, v232, s[86:87] offset:0
    global_load_ushort v219, v233, s[88:89] offset:2
    global_load_ushort v222, v233, s[90:91] offset:2
    global_load_ushort v206, v232, s[76:77] offset:256
    global_load_ushort v207, v232, s[78:79] offset:256
    global_load_ushort v208, v232, s[80:81] offset:256
    global_load_ushort v209, v232, s[82:83] offset:256
    global_load_ushort v210, v232, s[84:85] offset:256
    global_load_ushort v211, v232, s[86:87] offset:256
    global_load_ushort v220, v233, s[88:89] offset:4
    global_load_ushort v223, v233, s[90:91] offset:4
    global_load_ushort v212, v232, s[76:77] offset:512
    global_load_ushort v213, v232, s[78:79] offset:512
    global_load_ushort v214, v232, s[80:81] offset:512
    global_load_ushort v215, v232, s[82:83] offset:512
    global_load_ushort v216, v232, s[84:85] offset:512
    global_load_ushort v217, v232, s[86:87] offset:512
    s_add_u32 m0, s73, 896
    s_nop 0
    buffer_load_dwordx4 v165, s[12:15], s94 offen offset:128 lds
    s_add_u32 m0, s73, 10112
    s_nop 0
    buffer_load_dwordx4 v166, s[12:15], s95 offen offset:128 lds
    s_add_u32 m0, s72, 1792
    s_nop 0
    buffer_load_dwordx4 v165, s[12:15], s92 offen offset:256 lds
    s_add_u32 m0, s72, 11008
    s_nop 0
    buffer_load_dwordx4 v166, s[12:15], s93 offen offset:256 lds
    s_add_u32 m0, s73, 1792
    s_mov_b32 s4, s44
    s_mov_b32 s5, s45
    s_mov_b32 s6, 5308416
    s_mov_b32 s7, 0x00020000
    s_sub_u32 s8, s46, 4096
    s_subb_u32 s9, s47, 0
    s_mov_b32 s10, 5312512
    s_mov_b32 s11, 0x00020000
    s_and_b32 s40, s21, 15
    s_mul_i32 s40, s40, 36
    s_mul_i32 s41, s40, 9216
    s_mul_i32 s42, s22, 1152
    s_add_u32 s41, s41, s42
    s_mul_i32 s43, s23, 512
    s_add_u32 s51, s41, s43
    s_mul_i32 s42, s22, 576
    s_add_u32 s40, s40, s42
    s_mul_i32 s40, s40, 1152
    s_add_u32 s40, s40, s43
    s_add_u32 s3, s40, 4096
    s_mov_b32 s16, s98
    s_mov_b32 s17, s99
    s_mov_b32 s18, 0x10000000
    s_mov_b32 s19, 0x00020000
    s_and_b32 s40, s2, 7
    s_lshr_b32 s41, s2, 4
    s_lshl_b32 s40, s40, 4
    s_add_u32 s40, s40, s41
    s_lshl_b32 s40, s40, 2
    s_add_u32 s40, s40, s20
    s_lshl_b32 s40, s40, 7
    s_add_u32 s38, s40, 54525952
    v_mov_b32 v251, 0
    s_cmp_lt_u32 s20, 2
    s_cselect_b64 vcc, -1, 0
    s_lshl_b32 s30, s20, 12
    s_and_b32 s49, s20, 1
    s_add_u32 s40, s49, 16
    s_lshl_b32 s31, s40, 10
    s_mul_i32 s40, s22, 1152
    s_mul_i32 s41, s23, 640
    s_add_u32 s24, s40, s41
    v_lshlrev_b32 v250, 4, v253
    v_and_b32 v163, 1, v162
    v_lshlrev_b32 v163, 2, v163
    v_xor_b32 v163, v161, v163
    v_lshlrev_b32 v167, 4, v163
    v_mul_u32_u24 v168, 9216, v160
    v_add_u32 v168, v168, v167
    v_add_u32 v161, v164, v167
    s_mul_i32 s40, s20, 294912
    s_add_u32 s41, s40, 0
    v_add_u32 v243, s41, v168
    s_add_u32 s41, s40, 72704
    v_add_u32 v244, s41, v168
    s_add_u32 s41, s40, 145408
    v_add_u32 v245, s41, v168
    s_add_u32 s41, s40, 218112
    v_add_u32 v246, s41, v168
    s_mul_i32 s41, s49, 73728
    buffer_load_dwordx4 v165, s[12:15], s94 offen offset:256 lds
    s_add_u32 m0, s73, 11008
    s_add_u32 s41, s41, 1179648
    v_add_u32 v247, s41, v168
    v_bfe_u32 v174, v253, 4, 1
    v_lshrrev_b32 v175, 5, v253
    v_bfe_u32 v176, v253, 2, 2
    v_and_b32 v177, 3, v253
    v_lshlrev_b32 v164, 3, v177
    v_lshl_add_u32 v164, v174, 5, v164
    v_lshrrev_b32 v163, 1, v176
    v_lshl_add_u32 v163, v163, 6, v164
    v_lshl_add_u32 v163, v176, 7, v163
    v_lshl_add_u32 v240, v175, 10, v163
    v_xor_b32 v241, 64, v240
    v_lshl_add_u32 v163, v175, 9, v163
    v_accvgpr_write_b32 a57, v163
    v_xor_b32 v163, 64, v163
    v_accvgpr_write_b32 a58, v163
    v_lshl_add_u32 v164, v176, 6, v164
    v_lshl_add_u32 v242, v175, 9, v164
    v_lshl_add_u32 v163, v175, 8, v164
    v_accvgpr_write_b32 a59, v163
    v_and_b32 v178, 31, v253
    v_bfe_u32 v179, v253, 1, 3
    v_xor_b32 v179, v179, v175
    v_lshrrev_b32 v163, 3, v178
    v_mul_u32_u24 v163, 9216, v163
    v_and_b32 v164, 7, v178
    v_lshl_add_u32 v163, v164, 7, v163
    v_add_u32 v163, s48, v163
    v_xor_b32 v164, 0, v179
    v_lshl_add_u32 v180, v164, 4, v163
    v_xor_b32 v164, 2, v179
    v_lshl_add_u32 v181, v164, 4, v163
    v_xor_b32 v164, 4, v179
    v_lshl_add_u32 v182, v164, 4, v163
    v_xor_b32 v164, 6, v179
    v_lshl_add_u32 v183, v164, 4, v163
    s_mul_i32 s40, s23, 10
    s_add_u32 s40, s40, s22
    s_lshl_b32 s41, s40, 6
    s_and_b32 s41, s41, 64
    v_xor_b32 v236, s41, v180
    s_lshr_b32 s41, s40, 1
    v_lshl_add_u32 v236, s41, 10, v236
    v_xor_b32 v237, 32, v236
    v_and_b32 v193, 1, v253
    v_lshlrev_b32 v193, 4, v193
    v_mov_b32 v163, 0x3f80
    v_lshlrev_b32 v193, v193, v163
    v_bfe_u32 v192, v253, 1, 1
    v_bfe_u32 v163, v253, 3, 2
    v_lshl_add_u32 v192, v163, 1, v192
    v_bfe_u32 v163, v253, 2, 1
    v_xor_b32 v163, v163, v175
    v_lshl_add_u32 v192, v163, 3, v192
    v_cmp_eq_u32 s[44:45], 0, v192
    s_nop 1
    v_cndmask_b32 v184, 0, v193, s[44:45]
    v_cmp_eq_u32 s[44:45], 1, v192
    s_nop 1
    buffer_load_dwordx4 v166, s[12:15], s95 offen offset:256 lds
    s_add_u32 m0, s72, 2688
    v_cndmask_b32 v185, 0, v193, s[44:45]
    v_cmp_eq_u32 s[44:45], 2, v192
    s_nop 1
    v_cndmask_b32 v186, 0, v193, s[44:45]
    v_cmp_eq_u32 s[44:45], 3, v192
    s_nop 1
    v_cndmask_b32 v187, 0, v193, s[44:45]
    v_cmp_eq_u32 s[44:45], 4, v192
    s_nop 1
    v_cndmask_b32 v188, 0, v193, s[44:45]
    v_cmp_eq_u32 s[44:45], 5, v192
    s_nop 1
    v_cndmask_b32 v189, 0, v193, s[44:45]
    v_cmp_eq_u32 s[44:45], 6, v192
    s_nop 1
    v_cndmask_b32 v190, 0, v193, s[44:45]
    v_cmp_eq_u32 s[44:45], 7, v192
    s_nop 1
    v_cndmask_b32 v191, 0, v193, s[44:45]
    v_mov_b32 v196, 0
    v_mov_b32 v197, 0
    v_mov_b32 v198, 0
    v_mov_b32 v199, 0
    s_mov_b32 s100, 0x3f803f80
    s_lshl_b32 s40, s22, 1
    s_add_u32 s39, s40, s23
    v_lshrrev_b32 v168, 4, v253
    v_lshrrev_b32 v163, 1, v176
    v_lshl_add_u32 v163, v174, 2, v163
    v_lshrrev_b32 v164, 1, v177
    v_xor_b32 v163, v163, v164
    s_and_b32 s40, s39, 3
    s_lshl_b32 s40, s40, 1
    v_xor_b32 v163, s40, v163
    v_lshlrev_b32 v163, 4, v163
    v_and_b32 v164, 1, v177
    v_lshl_add_u32 v163, v164, 3, v163
    v_lshl_add_u32 v163, v176, 7, v163
    v_mul_u32_u24 v164, 9216, v168
    s_lshr_b32 s40, s39, 2
    s_lshl_b32 s40, s40, 10
    s_add_u32 s40, s40, s48
    v_add3_u32 v194, v163, v164, s40
    v_xor_b32 v195, 32, v194
    v_add_u32 v195, 512, v195
    s_lshl_b32 s40, s20, 8
    s_add_u32 s40, s40, 147456
    v_lshl_add_u32 v192, v178, 3, s40
    v_lshl_add_u32 v193, v168, 6, s40
    v_and_b32 v163, 15, v253
    v_lshlrev_b32 v163, 13, v163
    v_lshl_add_u32 v167, v168, 4, v163
    s_lshl_b32 s40, s21, 2
    s_add_u32 s40, s40, s20
    s_lshl_b32 s40, s40, 6
    s_lshl_b32 s41, s39, 17
    s_add_u32 s40, s40, s41
    s_add_u32 s33, s40, 44040704
    buffer_load_dwordx4 v165, s[12:15], s92 offen offset:384 lds
    s_cmp_ge_u32 s20, 2
    s_cbranch_scc1 L_iss1
    s_add_u32 m0, s72, 11904
    s_waitcnt vmcnt(7)
    v_lshlrev_b32 v52, 16, v218
    v_lshlrev_b32 v84, 16, v219
    v_lshlrev_b32 v116, 16, v220
    v_mul_f32 v52, 0x3fb8aa3b, v52
    v_mul_f32 v84, 0x3fb8aa3b, v84
    v_mul_f32 v116, 0x3fb8aa3b, v116
    v_exp_f32 v52, v52
    v_exp_f32 v84, v84
    v_exp_f32 v116, v116
    v_accvgpr_write_b32 a248, v221
    v_accvgpr_write_b32 a249, v222
    v_accvgpr_write_b32 a250, v223
    v_lshlrev_b32 v200, 16, v200
    v_lshlrev_b32 v206, 16, v206
    v_lshlrev_b32 v212, 16, v212
    v_lshlrev_b32 v201, 16, v201
    v_lshlrev_b32 v207, 16, v207
    v_lshlrev_b32 v213, 16, v213
    v_lshlrev_b32 v202, 16, v202
    v_lshlrev_b32 v208, 16, v208
    v_lshlrev_b32 v214, 16, v214
    buffer_load_dwordx4 v166, s[12:15], s93 offen offset:384 lds
    s_add_u32 m0, s73, 2688
    v_lshlrev_b32 v203, 16, v203
    v_lshlrev_b32 v209, 16, v209
    v_lshlrev_b32 v215, 16, v215
    v_lshlrev_b32 v204, 16, v204
    v_lshlrev_b32 v210, 16, v210
    v_lshlrev_b32 v216, 16, v216
    v_lshlrev_b32 v205, 16, v205
    v_lshlrev_b32 v211, 16, v211
    v_lshlrev_b32 v217, 16, v217
    v_cvt_pk_bf16_f32 v52, v52, v52
    v_cvt_pk_bf16_f32 v84, v84, v84
    v_cvt_pk_bf16_f32 v116, v116, v116
    v_and_b32 v52, 0xffff0000, v52
    v_and_b32 v84, 0xffff0000, v84
    v_and_b32 v116, 0xffff0000, v116
    v_pk_mul_f32 v[48:49], v[200:201], v[52:53] op_sel_hi:[1,0]
    v_pk_mul_f32 v[80:81], v[206:207], v[84:85] op_sel_hi:[1,0]
    v_pk_mul_f32 v[112:113], v[212:213], v[116:117] op_sel_hi:[1,0]
    v_pk_mul_f32 v[202:203], v[202:203], v[52:53] op_sel_hi:[1,0]
    v_pk_mul_f32 v[208:209], v[208:209], v[84:85] op_sel_hi:[1,0]
    v_pk_mul_f32 v[214:215], v[214:215], v[116:117] op_sel_hi:[1,0]
    buffer_load_dwordx4 v165, s[12:15], s94 offen offset:384 lds
    s_add_u32 m0, s73, 11904
    v_mul_f32 v48, 0x3fb8aa3b, v48
    v_mul_f32 v80, 0x3fb8aa3b, v80
    v_mul_f32 v112, 0x3fb8aa3b, v112
    v_mul_f32 v49, 0.15915494, v49
    v_mul_f32 v81, 0.15915494, v81
    v_mul_f32 v113, 0.15915494, v113
    v_rndne_f32 v54, v49
    v_rndne_f32 v86, v81
    v_rndne_f32 v118, v113
    v_sub_f32 v49, v49, v54
    v_sub_f32 v81, v81, v86
    v_sub_f32 v113, v113, v118
    v_pk_mul_f32 v[54:55], v[204:205], v[202:203] op_sel_hi:[1,0]
    v_pk_mul_f32 v[86:87], v[210:211], v[208:209] op_sel_hi:[1,0]
    v_pk_mul_f32 v[118:119], v[216:217], v[214:215] op_sel_hi:[1,0]
    v_pk_fma_f32 v[50:51], v[204:205], v[202:203], v[54:55] op_sel:[1,1,0] op_sel_hi:[0,1,1] neg_lo:[0,1,0]
    v_pk_fma_f32 v[82:83], v[210:211], v[208:209], v[86:87] op_sel:[1,1,0] op_sel_hi:[0,1,1] neg_lo:[0,1,0]
    v_pk_fma_f32 v[114:115], v[216:217], v[214:215], v[118:119] op_sel:[1,1,0] op_sel_hi:[0,1,1] neg_lo:[0,1,0]
    v_mul_f32 v54, 0x41800000, v48
    v_mul_f32 v86, 0x41800000, v80
    v_mul_f32 v118, 0x41800000, v112
    buffer_load_dwordx4 v166, s[12:15], s95 offen offset:384 lds
    s_add_u32 m0, s72, 3584
    v_mul_f32 v55, 0x41800000, v49
    v_mul_f32 v87, 0x41800000, v81
    v_mul_f32 v119, 0x41800000, v113
    v_exp_f32 v54, v54
    v_exp_f32 v86, v86
    v_exp_f32 v118, v118
    v_fract_f32 v55, v55
    v_fract_f32 v87, v87
    v_fract_f32 v119, v119
    v_sin_f32 v59, v55
    v_sin_f32 v91, v87
    v_sin_f32 v123, v119
    v_cos_f32 v58, v55
    v_cos_f32 v90, v87
    v_cos_f32 v122, v119
    v_pk_mul_f32 v[58:59], v[58:59], v[54:55] op_sel_hi:[1,0]
    v_pk_mul_f32 v[90:91], v[90:91], v[86:87] op_sel_hi:[1,0]
    v_pk_mul_f32 v[122:123], v[122:123], v[118:119] op_sel_hi:[1,0]
    v_exp_f32 v66, v48
    v_exp_f32 v98, v80
    v_exp_f32 v130, v112
    buffer_load_dwordx4 v165, s[12:15], s92 offen offset:512 lds
    s_add_u32 m0, s72, 12800
    v_sin_f32 v57, v49
    v_sin_f32 v89, v81
    v_sin_f32 v121, v113
    v_cos_f32 v56, v49
    v_cos_f32 v88, v81
    v_cos_f32 v120, v113
    v_pk_mul_f32 v[56:57], v[56:57], v[66:67] op_sel_hi:[1,0]
    v_pk_mul_f32 v[88:89], v[88:89], v[98:99] op_sel_hi:[1,0]
    v_pk_mul_f32 v[120:121], v[120:121], v[130:131] op_sel_hi:[1,0]
    v_mov_b32 v60, 1.0
    v_mov_b32 v92, 1.0
    v_mov_b32 v124, 1.0
    v_mov_b32 v61, 0
    v_mov_b32 v93, 0
    v_mov_b32 v125, 0
    v_pk_mul_f32 v[54:55], v[50:51], v[56:57] op_sel_hi:[1,0]
    v_pk_mul_f32 v[86:87], v[82:83], v[88:89] op_sel_hi:[1,0]
    v_pk_mul_f32 v[118:119], v[114:115], v[120:121] op_sel_hi:[1,0]
    v_pk_fma_f32 v[64:65], v[50:51], v[56:57], v[54:55] op_sel:[1,1,0] op_sel_hi:[0,1,1] neg_lo:[0,1,0]
    v_pk_fma_f32 v[96:97], v[82:83], v[88:89], v[86:87] op_sel:[1,1,0] op_sel_hi:[0,1,1] neg_lo:[0,1,0]
    v_pk_fma_f32 v[128:129], v[114:115], v[120:121], v[118:119] op_sel:[1,1,0] op_sel_hi:[0,1,1] neg_lo:[0,1,0]
    buffer_load_dwordx4 v166, s[12:15], s93 offen offset:512 lds
    s_add_u32 m0, s73, 3584
    v_cvt_pk_bf16_f32 v76, v60, v58
    v_cvt_pk_bf16_f32 v108, v92, v90
    v_cvt_pk_bf16_f32 v140, v124, v122
    v_cvt_pk_bf16_f32 v77, v61, v59
    v_cvt_pk_bf16_f32 v109, v93, v91
    v_cvt_pk_bf16_f32 v141, v125, v123
    v_accvgpr_write_b32 a152, v76
    v_accvgpr_write_b32 a184, v108
    v_accvgpr_write_b32 a216, v140
    v_accvgpr_write_b32 a156, v77
    v_accvgpr_write_b32 a188, v109
    v_accvgpr_write_b32 a220, v141
    v_cvt_pk_bf16_f32 v78, v50, v64
    v_cvt_pk_bf16_f32 v110, v82, v96
    v_cvt_pk_bf16_f32 v142, v114, v128
    v_cvt_pk_bf16_f32 v79, -v51, -v65
    v_cvt_pk_bf16_f32 v111, -v83, -v97
    v_cvt_pk_bf16_f32 v143, -v115, -v129
    v_accvgpr_write_b32 a168, v78
    v_accvgpr_write_b32 a200, v110
    v_accvgpr_write_b32 a232, v142
    buffer_load_dwordx4 v165, s[12:15], s94 offen offset:512 lds
    s_add_u32 m0, s73, 12800
    v_accvgpr_write_b32 a172, v79
    v_accvgpr_write_b32 a204, v111
    v_accvgpr_write_b32 a236, v143
    v_pk_mul_f32 v[66:67], v[58:59], v[58:59] op_sel_hi:[1,0]
    v_pk_mul_f32 v[98:99], v[90:91], v[90:91] op_sel_hi:[1,0]
    v_pk_mul_f32 v[130:131], v[122:123], v[122:123] op_sel_hi:[1,0]
    v_pk_fma_f32 v[60:61], v[58:59], v[58:59], v[66:67] op_sel:[1,1,0] op_sel_hi:[0,1,1] neg_lo:[0,1,0]
    v_pk_fma_f32 v[92:93], v[90:91], v[90:91], v[98:99] op_sel:[1,1,0] op_sel_hi:[0,1,1] neg_lo:[0,1,0]
    v_pk_fma_f32 v[124:125], v[122:123], v[122:123], v[130:131] op_sel:[1,1,0] op_sel_hi:[0,1,1] neg_lo:[0,1,0]
    v_pk_mul_f32 v[54:55], v[64:65], v[56:57] op_sel_hi:[1,0]
    v_pk_mul_f32 v[86:87], v[96:97], v[88:89] op_sel_hi:[1,0]
    v_pk_mul_f32 v[118:119], v[128:129], v[120:121] op_sel_hi:[1,0]
    v_pk_fma_f32 v[50:51], v[64:65], v[56:57], v[54:55] op_sel:[1,1,0] op_sel_hi:[0,1,1] neg_lo:[0,1,0]
    v_pk_fma_f32 v[82:83], v[96:97], v[88:89], v[86:87] op_sel:[1,1,0] op_sel_hi:[0,1,1] neg_lo:[0,1,0]
    v_pk_fma_f32 v[114:115], v[128:129], v[120:121], v[118:119] op_sel:[1,1,0] op_sel_hi:[0,1,1] neg_lo:[0,1,0]
    v_pk_mul_f32 v[66:67], v[60:61], v[58:59] op_sel_hi:[1,0]
    v_pk_mul_f32 v[98:99], v[92:93], v[90:91] op_sel_hi:[1,0]
    v_pk_mul_f32 v[130:131], v[124:125], v[122:123] op_sel_hi:[1,0]
    v_pk_fma_f32 v[62:63], v[60:61], v[58:59], v[66:67] op_sel:[1,1,0] op_sel_hi:[0,1,1] neg_lo:[0,1,0]
    v_pk_fma_f32 v[94:95], v[92:93], v[90:91], v[98:99] op_sel:[1,1,0] op_sel_hi:[0,1,1] neg_lo:[0,1,0]
    v_pk_fma_f32 v[126:127], v[124:125], v[122:123], v[130:131] op_sel:[1,1,0] op_sel_hi:[0,1,1] neg_lo:[0,1,0]
    buffer_load_dwordx4 v166, s[12:15], s95 offen offset:512 lds
    s_add_u32 m0, s72, 4480
    v_pk_mul_f32 v[54:55], v[50:51], v[56:57] op_sel_hi:[1,0]
    v_pk_mul_f32 v[86:87], v[82:83], v[88:89] op_sel_hi:[1,0]
    v_pk_mul_f32 v[118:119], v[114:115], v[120:121] op_sel_hi:[1,0]
    v_pk_fma_f32 v[64:65], v[50:51], v[56:57], v[54:55] op_sel:[1,1,0] op_sel_hi:[0,1,1] neg_lo:[0,1,0]
    v_pk_fma_f32 v[96:97], v[82:83], v[88:89], v[86:87] op_sel:[1,1,0] op_sel_hi:[0,1,1] neg_lo:[0,1,0]
    v_pk_fma_f32 v[128:129], v[114:115], v[120:121], v[118:119] op_sel:[1,1,0] op_sel_hi:[0,1,1] neg_lo:[0,1,0]
    v_cvt_pk_bf16_f32 v76, v60, v62
    v_cvt_pk_bf16_f32 v108, v92, v94
    v_cvt_pk_bf16_f32 v140, v124, v126
    v_cvt_pk_bf16_f32 v77, v61, v63
    v_cvt_pk_bf16_f32 v109, v93, v95
    v_cvt_pk_bf16_f32 v141, v125, v127
    v_accvgpr_write_b32 a153, v76
    v_accvgpr_write_b32 a185, v108
    v_accvgpr_write_b32 a217, v140
    v_accvgpr_write_b32 a157, v77
    v_accvgpr_write_b32 a189, v109
    v_accvgpr_write_b32 a221, v141
    v_cvt_pk_bf16_f32 v78, v50, v64
    v_cvt_pk_bf16_f32 v110, v82, v96
    v_cvt_pk_bf16_f32 v142, v114, v128
    buffer_load_dwordx4 v165, s[12:15], s92 offen offset:640 lds
    s_add_u32 m0, s72, 13696
    v_cvt_pk_bf16_f32 v79, -v51, -v65
    v_cvt_pk_bf16_f32 v111, -v83, -v97
    v_cvt_pk_bf16_f32 v143, -v115, -v129
    v_accvgpr_write_b32 a169, v78
    v_accvgpr_write_b32 a201, v110
    v_accvgpr_write_b32 a233, v142
    v_accvgpr_write_b32 a173, v79
    v_accvgpr_write_b32 a205, v111
    v_accvgpr_write_b32 a237, v143
    v_pk_mul_f32 v[66:67], v[62:63], v[58:59] op_sel_hi:[1,0]
    v_pk_mul_f32 v[98:99], v[94:95], v[90:91] op_sel_hi:[1,0]
    v_pk_mul_f32 v[130:131], v[126:127], v[122:123] op_sel_hi:[1,0]
    v_pk_fma_f32 v[60:61], v[62:63], v[58:59], v[66:67] op_sel:[1,1,0] op_sel_hi:[0,1,1] neg_lo:[0,1,0]
    v_pk_fma_f32 v[92:93], v[94:95], v[90:91], v[98:99] op_sel:[1,1,0] op_sel_hi:[0,1,1] neg_lo:[0,1,0]
    v_pk_fma_f32 v[124:125], v[126:127], v[122:123], v[130:131] op_sel:[1,1,0] op_sel_hi:[0,1,1] neg_lo:[0,1,0]
    v_pk_mul_f32 v[54:55], v[64:65], v[56:57] op_sel_hi:[1,0]
    v_pk_mul_f32 v[86:87], v[96:97], v[88:89] op_sel_hi:[1,0]
    v_pk_mul_f32 v[118:119], v[128:129], v[120:121] op_sel_hi:[1,0]
    v_pk_fma_f32 v[50:51], v[64:65], v[56:57], v[54:55] op_sel:[1,1,0] op_sel_hi:[0,1,1] neg_lo:[0,1,0]
    v_pk_fma_f32 v[82:83], v[96:97], v[88:89], v[86:87] op_sel:[1,1,0] op_sel_hi:[0,1,1] neg_lo:[0,1,0]
    v_pk_fma_f32 v[114:115], v[128:129], v[120:121], v[118:119] op_sel:[1,1,0] op_sel_hi:[0,1,1] neg_lo:[0,1,0]
    buffer_load_dwordx4 v166, s[12:15], s93 offen offset:640 lds
    s_add_u32 m0, s73, 4480
    v_pk_mul_f32 v[66:67], v[60:61], v[58:59] op_sel_hi:[1,0]
    v_pk_mul_f32 v[98:99], v[92:93], v[90:91] op_sel_hi:[1,0]
    v_pk_mul_f32 v[130:131], v[124:125], v[122:123] op_sel_hi:[1,0]
    v_pk_fma_f32 v[62:63], v[60:61], v[58:59], v[66:67] op_sel:[1,1,0] op_sel_hi:[0,1,1] neg_lo:[0,1,0]
    v_pk_fma_f32 v[94:95], v[92:93], v[90:91], v[98:99] op_sel:[1,1,0] op_sel_hi:[0,1,1] neg_lo:[0,1,0]
    v_pk_fma_f32 v[126:127], v[124:125], v[122:123], v[130:131] op_sel:[1,1,0] op_sel_hi:[0,1,1] neg_lo:[0,1,0]
    v_pk_mul_f32 v[54:55], v[50:51], v[56:57] op_sel_hi:[1,0]
    v_pk_mul_f32 v[86:87], v[82:83], v[88:89] op_sel_hi:[1,0]
    v_pk_mul_f32 v[118:119], v[114:115], v[120:121] op_sel_hi:[1,0]
    v_pk_fma_f32 v[64:65], v[50:51], v[56:57], v[54:55] op_sel:[1,1,0] op_sel_hi:[0,1,1] neg_lo:[0,1,0]
    v_pk_fma_f32 v[96:97], v[82:83], v[88:89], v[86:87] op_sel:[1,1,0] op_sel_hi:[0,1,1] neg_lo:[0,1,0]
    v_pk_fma_f32 v[128:129], v[114:115], v[120:121], v[118:119] op_sel:[1,1,0] op_sel_hi:[0,1,1] neg_lo:[0,1,0]
    v_cvt_pk_bf16_f32 v76, v60, v62
    v_cvt_pk_bf16_f32 v108, v92, v94
    v_cvt_pk_bf16_f32 v140, v124, v126
    v_cvt_pk_bf16_f32 v77, v61, v63
    v_cvt_pk_bf16_f32 v109, v93, v95
    v_cvt_pk_bf16_f32 v141, v125, v127
    v_accvgpr_write_b32 a154, v76
    v_accvgpr_write_b32 a186, v108
    v_accvgpr_write_b32 a218, v140
    buffer_load_dwordx4 v165, s[12:15], s94 offen offset:640 lds
    s_add_u32 m0, s73, 13696
    v_accvgpr_write_b32 a158, v77
    v_accvgpr_write_b32 a190, v109
    v_accvgpr_write_b32 a222, v141
    v_cvt_pk_bf16_f32 v78, v50, v64
    v_cvt_pk_bf16_f32 v110, v82, v96
    v_cvt_pk_bf16_f32 v142, v114, v128
    v_cvt_pk_bf16_f32 v79, -v51, -v65
    v_cvt_pk_bf16_f32 v111, -v83, -v97
    v_cvt_pk_bf16_f32 v143, -v115, -v129
    v_accvgpr_write_b32 a170, v78
    v_accvgpr_write_b32 a202, v110
    v_accvgpr_write_b32 a234, v142
    v_accvgpr_write_b32 a174, v79
    v_accvgpr_write_b32 a206, v111
    v_accvgpr_write_b32 a238, v143
    v_pk_mul_f32 v[66:67], v[62:63], v[58:59] op_sel_hi:[1,0]
    v_pk_mul_f32 v[98:99], v[94:95], v[90:91] op_sel_hi:[1,0]
    v_pk_mul_f32 v[130:131], v[126:127], v[122:123] op_sel_hi:[1,0]
    v_pk_fma_f32 v[60:61], v[62:63], v[58:59], v[66:67] op_sel:[1,1,0] op_sel_hi:[0,1,1] neg_lo:[0,1,0]
    v_pk_fma_f32 v[92:93], v[94:95], v[90:91], v[98:99] op_sel:[1,1,0] op_sel_hi:[0,1,1] neg_lo:[0,1,0]
    v_pk_fma_f32 v[124:125], v[126:127], v[122:123], v[130:131] op_sel:[1,1,0] op_sel_hi:[0,1,1] neg_lo:[0,1,0]
    buffer_load_dwordx4 v166, s[12:15], s95 offen offset:640 lds
    s_add_u32 m0, s72, 5376
    v_pk_mul_f32 v[54:55], v[64:65], v[56:57] op_sel_hi:[1,0]
    v_pk_mul_f32 v[86:87], v[96:97], v[88:89] op_sel_hi:[1,0]
    v_pk_mul_f32 v[118:119], v[128:129], v[120:121] op_sel_hi:[1,0]
    v_pk_fma_f32 v[50:51], v[64:65], v[56:57], v[54:55] op_sel:[1,1,0] op_sel_hi:[0,1,1] neg_lo:[0,1,0]
    v_pk_fma_f32 v[82:83], v[96:97], v[88:89], v[86:87] op_sel:[1,1,0] op_sel_hi:[0,1,1] neg_lo:[0,1,0]
    v_pk_fma_f32 v[114:115], v[128:129], v[120:121], v[118:119] op_sel:[1,1,0] op_sel_hi:[0,1,1] neg_lo:[0,1,0]
    v_pk_mul_f32 v[66:67], v[60:61], v[58:59] op_sel_hi:[1,0]
    v_pk_mul_f32 v[98:99], v[92:93], v[90:91] op_sel_hi:[1,0]
    v_pk_mul_f32 v[130:131], v[124:125], v[122:123] op_sel_hi:[1,0]
    v_pk_fma_f32 v[62:63], v[60:61], v[58:59], v[66:67] op_sel:[1,1,0] op_sel_hi:[0,1,1] neg_lo:[0,1,0]
    v_pk_fma_f32 v[94:95], v[92:93], v[90:91], v[98:99] op_sel:[1,1,0] op_sel_hi:[0,1,1] neg_lo:[0,1,0]
    v_pk_fma_f32 v[126:127], v[124:125], v[122:123], v[130:131] op_sel:[1,1,0] op_sel_hi:[0,1,1] neg_lo:[0,1,0]
    v_pk_mul_f32 v[54:55], v[50:51], v[56:57] op_sel_hi:[1,0]
    v_pk_mul_f32 v[86:87], v[82:83], v[88:89] op_sel_hi:[1,0]
    v_pk_mul_f32 v[118:119], v[114:115], v[120:121] op_sel_hi:[1,0]
    v_pk_fma_f32 v[64:65], v[50:51], v[56:57], v[54:55] op_sel:[1,1,0] op_sel_hi:[0,1,1] neg_lo:[0,1,0]
    v_pk_fma_f32 v[96:97], v[82:83], v[88:89], v[86:87] op_sel:[1,1,0] op_sel_hi:[0,1,1] neg_lo:[0,1,0]
    v_pk_fma_f32 v[128:129], v[114:115], v[120:121], v[118:119] op_sel:[1,1,0] op_sel_hi:[0,1,1] neg_lo:[0,1,0]
    v_cvt_pk_bf16_f32 v76, v60, v62
    v_cvt_pk_bf16_f32 v108, v92, v94
    v_cvt_pk_bf16_f32 v140, v124, v126
    buffer_load_dwordx4 v165, s[12:15], s92 offen offset:768 lds
    s_add_u32 m0, s72, 14592
    v_cvt_pk_bf16_f32 v77, v61, v63
    v_cvt_pk_bf16_f32 v109, v93, v95
    v_cvt_pk_bf16_f32 v141, v125, v127
    v_accvgpr_write_b32 a155, v76
    v_accvgpr_write_b32 a187, v108
    v_accvgpr_write_b32 a219, v140
    v_accvgpr_write_b32 a159, v77
    v_accvgpr_write_b32 a191, v109
    v_accvgpr_write_b32 a223, v141
    v_cvt_pk_bf16_f32 v78, v50, v64
    v_cvt_pk_bf16_f32 v110, v82, v96
    v_cvt_pk_bf16_f32 v142, v114, v128
    v_cvt_pk_bf16_f32 v79, -v51, -v65
    v_cvt_pk_bf16_f32 v111, -v83, -v97
    v_cvt_pk_bf16_f32 v143, -v115, -v129
    v_accvgpr_write_b32 a171, v78
    v_accvgpr_write_b32 a203, v110
    v_accvgpr_write_b32 a235, v142
    v_accvgpr_write_b32 a175, v79
    v_accvgpr_write_b32 a207, v111
    v_accvgpr_write_b32 a239, v143
    buffer_load_dwordx4 v166, s[12:15], s93 offen offset:768 lds
    s_add_u32 m0, s73, 5376
    v_pk_mul_f32 v[66:67], v[62:63], v[58:59] op_sel_hi:[1,0]
    v_pk_mul_f32 v[98:99], v[94:95], v[90:91] op_sel_hi:[1,0]
    v_pk_mul_f32 v[130:131], v[126:127], v[122:123] op_sel_hi:[1,0]
    v_pk_fma_f32 v[60:61], v[62:63], v[58:59], v[66:67] op_sel:[1,1,0] op_sel_hi:[0,1,1] neg_lo:[0,1,0]
    v_pk_fma_f32 v[92:93], v[94:95], v[90:91], v[98:99] op_sel:[1,1,0] op_sel_hi:[0,1,1] neg_lo:[0,1,0]
    v_pk_fma_f32 v[124:125], v[126:127], v[122:123], v[130:131] op_sel:[1,1,0] op_sel_hi:[0,1,1] neg_lo:[0,1,0]
    v_pk_mul_f32 v[54:55], v[64:65], v[56:57] op_sel_hi:[1,0]
    v_pk_mul_f32 v[86:87], v[96:97], v[88:89] op_sel_hi:[1,0]
    v_pk_mul_f32 v[118:119], v[128:129], v[120:121] op_sel_hi:[1,0]
    v_pk_fma_f32 v[50:51], v[64:65], v[56:57], v[54:55] op_sel:[1,1,0] op_sel_hi:[0,1,1] neg_lo:[0,1,0]
    v_pk_fma_f32 v[82:83], v[96:97], v[88:89], v[86:87] op_sel:[1,1,0] op_sel_hi:[0,1,1] neg_lo:[0,1,0]
    v_pk_fma_f32 v[114:115], v[128:129], v[120:121], v[118:119] op_sel:[1,1,0] op_sel_hi:[0,1,1] neg_lo:[0,1,0]
    v_pk_mul_f32 v[66:67], v[60:61], v[58:59] op_sel_hi:[1,0]
    v_pk_mul_f32 v[98:99], v[92:93], v[90:91] op_sel_hi:[1,0]
    v_pk_mul_f32 v[130:131], v[124:125], v[122:123] op_sel_hi:[1,0]
    v_pk_fma_f32 v[62:63], v[60:61], v[58:59], v[66:67] op_sel:[1,1,0] op_sel_hi:[0,1,1] neg_lo:[0,1,0]
    v_pk_fma_f32 v[94:95], v[92:93], v[90:91], v[98:99] op_sel:[1,1,0] op_sel_hi:[0,1,1] neg_lo:[0,1,0]
    v_pk_fma_f32 v[126:127], v[124:125], v[122:123], v[130:131] op_sel:[1,1,0] op_sel_hi:[0,1,1] neg_lo:[0,1,0]
    v_pk_mul_f32 v[54:55], v[50:51], v[56:57] op_sel_hi:[1,0]
    v_pk_mul_f32 v[86:87], v[82:83], v[88:89] op_sel_hi:[1,0]
    v_pk_mul_f32 v[118:119], v[114:115], v[120:121] op_sel_hi:[1,0]
    buffer_load_dwordx4 v165, s[12:15], s94 offen offset:768 lds
    s_add_u32 m0, s73, 14592
    v_pk_fma_f32 v[64:65], v[50:51], v[56:57], v[54:55] op_sel:[1,1,0] op_sel_hi:[0,1,1] neg_lo:[0,1,0]
    v_pk_fma_f32 v[96:97], v[82:83], v[88:89], v[86:87] op_sel:[1,1,0] op_sel_hi:[0,1,1] neg_lo:[0,1,0]
    v_pk_fma_f32 v[128:129], v[114:115], v[120:121], v[118:119] op_sel:[1,1,0] op_sel_hi:[0,1,1] neg_lo:[0,1,0]
    v_cvt_pk_bf16_f32 v76, v60, v62
    v_cvt_pk_bf16_f32 v108, v92, v94
    v_cvt_pk_bf16_f32 v140, v124, v126
    v_cvt_pk_bf16_f32 v77, v61, v63
    v_cvt_pk_bf16_f32 v109, v93, v95
    v_cvt_pk_bf16_f32 v141, v125, v127
    v_accvgpr_write_b32 a160, v76
    v_accvgpr_write_b32 a192, v108
    v_accvgpr_write_b32 a224, v140
    v_accvgpr_write_b32 a164, v77
    v_accvgpr_write_b32 a196, v109
    v_accvgpr_write_b32 a228, v141
    v_cvt_pk_bf16_f32 v78, v50, v64
    v_cvt_pk_bf16_f32 v110, v82, v96
    v_cvt_pk_bf16_f32 v142, v114, v128
    v_cvt_pk_bf16_f32 v79, -v51, -v65
    v_cvt_pk_bf16_f32 v111, -v83, -v97
    v_cvt_pk_bf16_f32 v143, -v115, -v129
    buffer_load_dwordx4 v166, s[12:15], s95 offen offset:768 lds
    s_waitcnt vmcnt(48)
    ds_read_b128 v[0:3], v180 offset:0
    ds_read_b128 v[4:7], v181 offset:0
    ds_read_b128 v[8:11], v182 offset:0
    ds_read_b128 v[12:15], v183 offset:0
    s_add_u32 m0, s72, 6272
    v_accvgpr_write_b32 a176, v78
    v_accvgpr_write_b32 a208, v110
    v_accvgpr_write_b32 a240, v142
    v_accvgpr_write_b32 a180, v79
    v_accvgpr_write_b32 a212, v111
    v_accvgpr_write_b32 a244, v143
    v_pk_mul_f32 v[66:67], v[62:63], v[58:59] op_sel_hi:[1,0]
    v_pk_mul_f32 v[98:99], v[94:95], v[90:91] op_sel_hi:[1,0]
    v_pk_mul_f32 v[130:131], v[126:127], v[122:123] op_sel_hi:[1,0]
    v_pk_fma_f32 v[60:61], v[62:63], v[58:59], v[66:67] op_sel:[1,1,0] op_sel_hi:[0,1,1] neg_lo:[0,1,0]
    v_pk_fma_f32 v[92:93], v[94:95], v[90:91], v[98:99] op_sel:[1,1,0] op_sel_hi:[0,1,1] neg_lo:[0,1,0]
    v_pk_fma_f32 v[124:125], v[126:127], v[122:123], v[130:131] op_sel:[1,1,0] op_sel_hi:[0,1,1] neg_lo:[0,1,0]
    v_pk_mul_f32 v[54:55], v[64:65], v[56:57] op_sel_hi:[1,0]
    v_pk_mul_f32 v[86:87], v[96:97], v[88:89] op_sel_hi:[1,0]
    v_pk_mul_f32 v[118:119], v[128:129], v[120:121] op_sel_hi:[1,0]
    v_pk_fma_f32 v[50:51], v[64:65], v[56:57], v[54:55] op_sel:[1,1,0] op_sel_hi:[0,1,1] neg_lo:[0,1,0]
    v_pk_fma_f32 v[82:83], v[96:97], v[88:89], v[86:87] op_sel:[1,1,0] op_sel_hi:[0,1,1] neg_lo:[0,1,0]
    v_pk_fma_f32 v[114:115], v[128:129], v[120:121], v[118:119] op_sel:[1,1,0] op_sel_hi:[0,1,1] neg_lo:[0,1,0]
    v_pk_mul_f32 v[66:67], v[60:61], v[58:59] op_sel_hi:[1,0]
    v_pk_mul_f32 v[98:99], v[92:93], v[90:91] op_sel_hi:[1,0]
    v_pk_mul_f32 v[130:131], v[124:125], v[122:123] op_sel_hi:[1,0]
    buffer_load_dwordx4 v165, s[12:15], s92 offen offset:896 lds
    s_add_u32 m0, s72, 15488
    v_pk_fma_f32 v[62:63], v[60:61], v[58:59], v[66:67] op_sel:[1,1,0] op_sel_hi:[0,1,1] neg_lo:[0,1,0]
    v_pk_fma_f32 v[94:95], v[92:93], v[90:91], v[98:99] op_sel:[1,1,0] op_sel_hi:[0,1,1] neg_lo:[0,1,0]
    v_pk_fma_f32 v[126:127], v[124:125], v[122:123], v[130:131] op_sel:[1,1,0] op_sel_hi:[0,1,1] neg_lo:[0,1,0]
    v_pk_mul_f32 v[54:55], v[50:51], v[56:57] op_sel_hi:[1,0]
    v_pk_mul_f32 v[86:87], v[82:83], v[88:89] op_sel_hi:[1,0]
    v_pk_mul_f32 v[118:119], v[114:115], v[120:121] op_sel_hi:[1,0]
    v_pk_fma_f32 v[64:65], v[50:51], v[56:57], v[54:55] op_sel:[1,1,0] op_sel_hi:[0,1,1] neg_lo:[0,1,0]
    v_pk_fma_f32 v[96:97], v[82:83], v[88:89], v[86:87] op_sel:[1,1,0] op_sel_hi:[0,1,1] neg_lo:[0,1,0]
    v_pk_fma_f32 v[128:129], v[114:115], v[120:121], v[118:119] op_sel:[1,1,0] op_sel_hi:[0,1,1] neg_lo:[0,1,0]
    v_cvt_pk_bf16_f32 v76, v60, v62
    v_cvt_pk_bf16_f32 v108, v92, v94
    v_cvt_pk_bf16_f32 v140, v124, v126
    v_cvt_pk_bf16_f32 v77, v61, v63
    v_cvt_pk_bf16_f32 v109, v93, v95
    v_cvt_pk_bf16_f32 v141, v125, v127
    v_accvgpr_write_b32 a161, v76
    v_accvgpr_write_b32 a193, v108
    v_accvgpr_write_b32 a225, v140
    v_accvgpr_write_b32 a165, v77
    v_accvgpr_write_b32 a197, v109
    v_accvgpr_write_b32 a229, v141
    buffer_load_dwordx4 v166, s[12:15], s93 offen offset:896 lds
    s_add_u32 m0, s73, 6272
    v_cvt_pk_bf16_f32 v78, v50, v64
    v_cvt_pk_bf16_f32 v110, v82, v96
    v_cvt_pk_bf16_f32 v142, v114, v128
    v_cvt_pk_bf16_f32 v79, -v51, -v65
    v_cvt_pk_bf16_f32 v111, -v83, -v97
    v_cvt_pk_bf16_f32 v143, -v115, -v129
    v_accvgpr_write_b32 a177, v78
    v_accvgpr_write_b32 a209, v110
    v_accvgpr_write_b32 a241, v142
    v_accvgpr_write_b32 a181, v79
    v_accvgpr_write_b32 a213, v111
    v_accvgpr_write_b32 a245, v143
    v_pk_mul_f32 v[66:67], v[62:63], v[58:59] op_sel_hi:[1,0]
    v_pk_mul_f32 v[98:99], v[94:95], v[90:91] op_sel_hi:[1,0]
    v_pk_mul_f32 v[130:131], v[126:127], v[122:123] op_sel_hi:[1,0]
    v_pk_fma_f32 v[60:61], v[62:63], v[58:59], v[66:67] op_sel:[1,1,0] op_sel_hi:[0,1,1] neg_lo:[0,1,0]
    v_pk_fma_f32 v[92:93], v[94:95], v[90:91], v[98:99] op_sel:[1,1,0] op_sel_hi:[0,1,1] neg_lo:[0,1,0]
    v_pk_fma_f32 v[124:125], v[126:127], v[122:123], v[130:131] op_sel:[1,1,0] op_sel_hi:[0,1,1] neg_lo:[0,1,0]
    v_pk_mul_f32 v[54:55], v[64:65], v[56:57] op_sel_hi:[1,0]
    v_pk_mul_f32 v[86:87], v[96:97], v[88:89] op_sel_hi:[1,0]
    v_pk_mul_f32 v[118:119], v[128:129], v[120:121] op_sel_hi:[1,0]
    buffer_load_dwordx4 v165, s[12:15], s94 offen offset:896 lds
    s_add_u32 m0, s73, 15488
    v_pk_fma_f32 v[50:51], v[64:65], v[56:57], v[54:55] op_sel:[1,1,0] op_sel_hi:[0,1,1] neg_lo:[0,1,0]
    v_pk_fma_f32 v[82:83], v[96:97], v[88:89], v[86:87] op_sel:[1,1,0] op_sel_hi:[0,1,1] neg_lo:[0,1,0]
    v_pk_fma_f32 v[114:115], v[128:129], v[120:121], v[118:119] op_sel:[1,1,0] op_sel_hi:[0,1,1] neg_lo:[0,1,0]
    v_pk_mul_f32 v[66:67], v[60:61], v[58:59] op_sel_hi:[1,0]
    v_pk_mul_f32 v[98:99], v[92:93], v[90:91] op_sel_hi:[1,0]
    v_pk_mul_f32 v[130:131], v[124:125], v[122:123] op_sel_hi:[1,0]
    v_pk_fma_f32 v[62:63], v[60:61], v[58:59], v[66:67] op_sel:[1,1,0] op_sel_hi:[0,1,1] neg_lo:[0,1,0]
    v_pk_fma_f32 v[94:95], v[92:93], v[90:91], v[98:99] op_sel:[1,1,0] op_sel_hi:[0,1,1] neg_lo:[0,1,0]
    v_pk_fma_f32 v[126:127], v[124:125], v[122:123], v[130:131] op_sel:[1,1,0] op_sel_hi:[0,1,1] neg_lo:[0,1,0]
    v_pk_mul_f32 v[54:55], v[50:51], v[56:57] op_sel_hi:[1,0]
    v_pk_mul_f32 v[86:87], v[82:83], v[88:89] op_sel_hi:[1,0]
    v_pk_mul_f32 v[118:119], v[114:115], v[120:121] op_sel_hi:[1,0]
    v_pk_fma_f32 v[64:65], v[50:51], v[56:57], v[54:55] op_sel:[1,1,0] op_sel_hi:[0,1,1] neg_lo:[0,1,0]
    v_pk_fma_f32 v[96:97], v[82:83], v[88:89], v[86:87] op_sel:[1,1,0] op_sel_hi:[0,1,1] neg_lo:[0,1,0]
    v_pk_fma_f32 v[128:129], v[114:115], v[120:121], v[118:119] op_sel:[1,1,0] op_sel_hi:[0,1,1] neg_lo:[0,1,0]
    v_cvt_pk_bf16_f32 v76, v60, v62
    v_cvt_pk_bf16_f32 v108, v92, v94
    v_cvt_pk_bf16_f32 v140, v124, v126
    v_cvt_pk_bf16_f32 v77, v61, v63
    v_cvt_pk_bf16_f32 v109, v93, v95
    v_cvt_pk_bf16_f32 v141, v125, v127
    buffer_load_dwordx4 v166, s[12:15], s95 offen offset:896 lds
    s_waitcnt vmcnt(24)
    ds_read_b128 v[16:19], v180 offset:1024
    ds_read_b128 v[20:23], v181 offset:1024
    ds_read_b128 v[24:27], v182 offset:1024
    ds_read_b128 v[28:31], v183 offset:1024
    s_waitcnt lgkmcnt(7)
    v_dot2c_f32_bf16 v196, s100, v0
    v_dot2c_f32_bf16 v198, v0, v0
    v_dot2c_f32_bf16 v197, s100, v1
    v_dot2c_f32_bf16 v199, v1, v1
    v_dot2c_f32_bf16 v196, s100, v2
    v_dot2c_f32_bf16 v198, v2, v2
    v_dot2c_f32_bf16 v197, s100, v3
    v_dot2c_f32_bf16 v199, v3, v3
    s_waitcnt lgkmcnt(6)
    v_dot2c_f32_bf16 v196, s100, v4
    v_dot2c_f32_bf16 v198, v4, v4
    v_dot2c_f32_bf16 v197, s100, v5
    v_dot2c_f32_bf16 v199, v5, v5
    v_dot2c_f32_bf16 v196, s100, v6
    v_dot2c_f32_bf16 v198, v6, v6
    v_dot2c_f32_bf16 v197, s100, v7
    v_dot2c_f32_bf16 v199, v7, v7
    s_waitcnt lgkmcnt(5)
    v_dot2c_f32_bf16 v196, s100, v8
    v_dot2c_f32_bf16 v198, v8, v8
    v_dot2c_f32_bf16 v197, s100, v9
    v_dot2c_f32_bf16 v199, v9, v9
    v_dot2c_f32_bf16 v196, s100, v10
    v_dot2c_f32_bf16 v198, v10, v10
    v_dot2c_f32_bf16 v197, s100, v11
    v_dot2c_f32_bf16 v199, v11, v11
    s_waitcnt lgkmcnt(4)
    v_dot2c_f32_bf16 v196, s100, v12
    v_dot2c_f32_bf16 v198, v12, v12
    v_dot2c_f32_bf16 v197, s100, v13
    v_dot2c_f32_bf16 v199, v13, v13
    v_dot2c_f32_bf16 v196, s100, v14
    v_dot2c_f32_bf16 v198, v14, v14
    v_dot2c_f32_bf16 v197, s100, v15
    v_dot2c_f32_bf16 v199, v15, v15
    s_add_u32 m0, s72, 7168
    v_accvgpr_write_b32 a162, v76
    v_accvgpr_write_b32 a194, v108
    v_accvgpr_write_b32 a226, v140
    v_accvgpr_write_b32 a166, v77
    v_accvgpr_write_b32 a198, v109
    v_accvgpr_write_b32 a230, v141
    v_cvt_pk_bf16_f32 v78, v50, v64
    v_cvt_pk_bf16_f32 v110, v82, v96
    v_cvt_pk_bf16_f32 v142, v114, v128
    v_cvt_pk_bf16_f32 v79, -v51, -v65
    v_cvt_pk_bf16_f32 v111, -v83, -v97
    v_cvt_pk_bf16_f32 v143, -v115, -v129
    v_accvgpr_write_b32 a178, v78
    v_accvgpr_write_b32 a210, v110
    v_accvgpr_write_b32 a242, v142
    v_accvgpr_write_b32 a182, v79
    v_accvgpr_write_b32 a214, v111
    v_accvgpr_write_b32 a246, v143
    v_pk_mul_f32 v[66:67], v[62:63], v[58:59] op_sel_hi:[1,0]
    v_pk_mul_f32 v[98:99], v[94:95], v[90:91] op_sel_hi:[1,0]
    v_pk_mul_f32 v[130:131], v[126:127], v[122:123] op_sel_hi:[1,0]
    buffer_load_dwordx4 v165, s[12:15], s92 offen offset:1024 lds
    s_add_u32 m0, s72, 16384
    v_pk_fma_f32 v[60:61], v[62:63], v[58:59], v[66:67] op_sel:[1,1,0] op_sel_hi:[0,1,1] neg_lo:[0,1,0]
    v_pk_fma_f32 v[92:93], v[94:95], v[90:91], v[98:99] op_sel:[1,1,0] op_sel_hi:[0,1,1] neg_lo:[0,1,0]
    v_pk_fma_f32 v[124:125], v[126:127], v[122:123], v[130:131] op_sel:[1,1,0] op_sel_hi:[0,1,1] neg_lo:[0,1,0]
    v_pk_mul_f32 v[54:55], v[64:65], v[56:57] op_sel_hi:[1,0]
    v_pk_mul_f32 v[86:87], v[96:97], v[88:89] op_sel_hi:[1,0]
    v_pk_mul_f32 v[118:119], v[128:129], v[120:121] op_sel_hi:[1,0]
    v_pk_fma_f32 v[50:51], v[64:65], v[56:57], v[54:55] op_sel:[1,1,0] op_sel_hi:[0,1,1] neg_lo:[0,1,0]
    v_pk_fma_f32 v[82:83], v[96:97], v[88:89], v[86:87] op_sel:[1,1,0] op_sel_hi:[0,1,1] neg_lo:[0,1,0]
    v_pk_fma_f32 v[114:115], v[128:129], v[120:121], v[118:119] op_sel:[1,1,0] op_sel_hi:[0,1,1] neg_lo:[0,1,0]
    v_pk_mul_f32 v[66:67], v[60:61], v[58:59] op_sel_hi:[1,0]
    v_pk_mul_f32 v[98:99], v[92:93], v[90:91] op_sel_hi:[1,0]
    v_pk_mul_f32 v[130:131], v[124:125], v[122:123] op_sel_hi:[1,0]
    v_pk_fma_f32 v[62:63], v[60:61], v[58:59], v[66:67] op_sel:[1,1,0] op_sel_hi:[0,1,1] neg_lo:[0,1,0]
    v_pk_fma_f32 v[94:95], v[92:93], v[90:91], v[98:99] op_sel:[1,1,0] op_sel_hi:[0,1,1] neg_lo:[0,1,0]
    v_pk_fma_f32 v[126:127], v[124:125], v[122:123], v[130:131] op_sel:[1,1,0] op_sel_hi:[0,1,1] neg_lo:[0,1,0]
    v_pk_mul_f32 v[54:55], v[50:51], v[56:57] op_sel_hi:[1,0]
    v_pk_mul_f32 v[86:87], v[82:83], v[88:89] op_sel_hi:[1,0]
    v_pk_mul_f32 v[118:119], v[114:115], v[120:121] op_sel_hi:[1,0]
    v_pk_fma_f32 v[64:65], v[50:51], v[56:57], v[54:55] op_sel:[1,1,0] op_sel_hi:[0,1,1] neg_lo:[0,1,0]
    v_pk_fma_f32 v[96:97], v[82:83], v[88:89], v[86:87] op_sel:[1,1,0] op_sel_hi:[0,1,1] neg_lo:[0,1,0]
    v_pk_fma_f32 v[128:129], v[114:115], v[120:121], v[118:119] op_sel:[1,1,0] op_sel_hi:[0,1,1] neg_lo:[0,1,0]
    buffer_load_dwordx4 v166, s[12:15], s93 offen offset:1024 lds
    s_add_u32 m0, s73, 7168
    v_cvt_pk_bf16_f32 v76, v60, v62
    v_cvt_pk_bf16_f32 v108, v92, v94
    v_cvt_pk_bf16_f32 v140, v124, v126
    v_cvt_pk_bf16_f32 v77, v61, v63
    v_cvt_pk_bf16_f32 v109, v93, v95
    v_cvt_pk_bf16_f32 v141, v125, v127
    v_accvgpr_write_b32 a163, v76
    v_accvgpr_write_b32 a195, v108
    v_accvgpr_write_b32 a227, v140
    v_accvgpr_write_b32 a167, v77
    v_accvgpr_write_b32 a199, v109
    v_accvgpr_write_b32 a231, v141
    v_cvt_pk_bf16_f32 v78, v50, v64
    v_cvt_pk_bf16_f32 v110, v82, v96
    v_cvt_pk_bf16_f32 v142, v114, v128
    v_cvt_pk_bf16_f32 v79, -v51, -v65
    v_cvt_pk_bf16_f32 v111, -v83, -v97
    v_cvt_pk_bf16_f32 v143, -v115, -v129
    v_accvgpr_write_b32 a179, v78
    v_accvgpr_write_b32 a211, v110
    v_accvgpr_write_b32 a243, v142
    buffer_load_dwordx4 v165, s[12:15], s94 offen offset:1024 lds
    s_add_u32 m0, s73, 16384
    v_accvgpr_write_b32 a183, v79
    v_accvgpr_write_b32 a215, v111
    v_accvgpr_write_b32 a247, v143
    buffer_load_dwordx4 v166, s[12:15], s95 offen offset:1024 lds
    s_branch L_iss2
L_iss1:
    s_add_u32 m0, s72, 11904
    s_waitcnt vmcnt(7)
    v_lshlrev_b32 v52, 16, v218
    v_lshlrev_b32 v84, 16, v219
    v_lshlrev_b32 v116, 16, v220
    v_mul_f32 v52, 0x3fb8aa3b, v52
    v_mul_f32 v84, 0x3fb8aa3b, v84
    v_mul_f32 v116, 0x3fb8aa3b, v116
    v_exp_f32 v52, v52
    v_exp_f32 v84, v84
    v_exp_f32 v116, v116
    v_accvgpr_write_b32 a248, v221
    v_accvgpr_write_b32 a249, v222
    v_accvgpr_write_b32 a250, v223
    v_lshlrev_b32 v200, 16, v200
    v_lshlrev_b32 v206, 16, v206
    v_lshlrev_b32 v212, 16, v212
    v_lshlrev_b32 v201, 16, v201
    v_lshlrev_b32 v207, 16, v207
    v_lshlrev_b32 v213, 16, v213
    v_lshlrev_b32 v202, 16, v202
    v_lshlrev_b32 v208, 16, v208
    v_lshlrev_b32 v214, 16, v214
    v_lshlrev_b32 v203, 16, v203
    buffer_load_dwordx4 v166, s[12:15], s93 offen offset:384 lds
    s_add_u32 m0, s73, 2688
    v_lshlrev_b32 v209, 16, v209
    v_lshlrev_b32 v215, 16, v215
    v_lshlrev_b32 v204, 16, v204
    v_lshlrev_b32 v210, 16, v210
    v_lshlrev_b32 v216, 16, v216
    v_lshlrev_b32 v205, 16, v205
    v_lshlrev_b32 v211, 16, v211
    v_lshlrev_b32 v217, 16, v217
    v_cvt_pk_bf16_f32 v52, v52, v52
    v_cvt_pk_bf16_f32 v84, v84, v84
    v_cvt_pk_bf16_f32 v116, v116, v116
    v_and_b32 v52, 0xffff0000, v52
    v_and_b32 v84, 0xffff0000, v84
    v_and_b32 v116, 0xffff0000, v116
    v_pk_mul_f32 v[48:49], v[200:201], v[52:53] op_sel_hi:[1,0]
    v_pk_mul_f32 v[80:81], v[206:207], v[84:85] op_sel_hi:[1,0]
    v_pk_mul_f32 v[112:113], v[212:213], v[116:117] op_sel_hi:[1,0]
    v_pk_mul_f32 v[202:203], v[202:203], v[52:53] op_sel_hi:[1,0]
    v_pk_mul_f32 v[208:209], v[208:209], v[84:85] op_sel_hi:[1,0]
    v_pk_mul_f32 v[214:215], v[214:215], v[116:117] op_sel_hi:[1,0]
    v_mul_f32 v48, 0x3fb8aa3b, v48
    v_mul_f32 v80, 0x3fb8aa3b, v80
    buffer_load_dwordx4 v165, s[12:15], s94 offen offset:384 lds
    s_add_u32 m0, s73, 11904
    v_mul_f32 v112, 0x3fb8aa3b, v112
    v_mul_f32 v49, 0.15915494, v49
    v_mul_f32 v81, 0.15915494, v81
    v_mul_f32 v113, 0.15915494, v113
    v_rndne_f32 v54, v49
    v_rndne_f32 v86, v81
    v_rndne_f32 v118, v113
    v_sub_f32 v49, v49, v54
    v_sub_f32 v81, v81, v86
    v_sub_f32 v113, v113, v118
    v_pk_mul_f32 v[54:55], v[204:205], v[202:203] op_sel_hi:[1,0]
    v_pk_mul_f32 v[86:87], v[210:211], v[208:209] op_sel_hi:[1,0]
    v_pk_mul_f32 v[118:119], v[216:217], v[214:215] op_sel_hi:[1,0]
    v_pk_fma_f32 v[50:51], v[204:205], v[202:203], v[54:55] op_sel:[1,1,0] op_sel_hi:[0,1,1] neg_lo:[0,1,0]
    v_pk_fma_f32 v[82:83], v[210:211], v[208:209], v[86:87] op_sel:[1,1,0] op_sel_hi:[0,1,1] neg_lo:[0,1,0]
    v_pk_fma_f32 v[114:115], v[216:217], v[214:215], v[118:119] op_sel:[1,1,0] op_sel_hi:[0,1,1] neg_lo:[0,1,0]
    v_mul_f32 v54, 0x43800000, v48
    v_mul_f32 v86, 0x43800000, v80
    v_mul_f32 v118, 0x43800000, v112
    v_mul_f32 v55, 0x43800000, v49
    v_mul_f32 v87, 0x43800000, v81
    v_mul_f32 v119, 0x43800000, v113
    buffer_load_dwordx4 v166, s[12:15], s95 offen offset:384 lds
    s_add_u32 m0, s72, 3584
    v_exp_f32 v54, v54
    v_exp_f32 v86, v86
    v_exp_f32 v118, v118
    v_fract_f32 v55, v55
    v_fract_f32 v87, v87
    v_fract_f32 v119, v119
    v_sin_f32 v63, v55
    v_sin_f32 v95, v87
    v_sin_f32 v127, v119
    v_cos_f32 v62, v55
    v_cos_f32 v94, v87
    v_cos_f32 v126, v119
    v_pk_mul_f32 v[62:63], v[62:63], v[54:55] op_sel_hi:[1,0]
    v_pk_mul_f32 v[94:95], v[94:95], v[86:87] op_sel_hi:[1,0]
    v_pk_mul_f32 v[126:127], v[126:127], v[118:119] op_sel_hi:[1,0]
    v_mul_f32 v64, 0x40000000, v48
    v_mul_f32 v96, 0x40000000, v80
    v_mul_f32 v128, 0x40000000, v112
    v_mul_f32 v65, 0x40000000, v49
    v_mul_f32 v97, 0x40000000, v81
    v_mul_f32 v129, 0x40000000, v113
    v_exp_f32 v64, v64
    buffer_load_dwordx4 v165, s[12:15], s92 offen offset:512 lds
    s_add_u32 m0, s72, 12800
    v_exp_f32 v96, v96
    v_exp_f32 v128, v128
    v_fract_f32 v65, v65
    v_fract_f32 v97, v97
    v_fract_f32 v129, v129
    v_sin_f32 v57, v65
    v_sin_f32 v89, v97
    v_sin_f32 v121, v129
    v_cos_f32 v56, v65
    v_cos_f32 v88, v97
    v_cos_f32 v120, v129
    v_pk_mul_f32 v[56:57], v[56:57], v[64:65] op_sel_hi:[1,0]
    v_pk_mul_f32 v[88:89], v[88:89], v[96:97] op_sel_hi:[1,0]
    v_pk_mul_f32 v[120:121], v[120:121], v[128:129] op_sel_hi:[1,0]
    v_pk_mul_f32 v[54:55], v[50:51], v[62:63] op_sel_hi:[1,0]
    v_pk_mul_f32 v[86:87], v[82:83], v[94:95] op_sel_hi:[1,0]
    v_pk_mul_f32 v[118:119], v[114:115], v[126:127] op_sel_hi:[1,0]
    v_pk_fma_f32 v[50:51], v[50:51], v[62:63], v[54:55] op_sel:[1,1,0] op_sel_hi:[0,1,1] neg_lo:[0,1,0]
    v_pk_fma_f32 v[82:83], v[82:83], v[94:95], v[86:87] op_sel:[1,1,0] op_sel_hi:[0,1,1] neg_lo:[0,1,0]
    v_pk_fma_f32 v[114:115], v[114:115], v[126:127], v[118:119] op_sel:[1,1,0] op_sel_hi:[0,1,1] neg_lo:[0,1,0]
    v_pk_mul_f32 v[64:65], v[56:57], v[56:57] op_sel_hi:[1,0]
    v_pk_mul_f32 v[96:97], v[88:89], v[88:89] op_sel_hi:[1,0]
    buffer_load_dwordx4 v166, s[12:15], s93 offen offset:512 lds
    s_add_u32 m0, s73, 3584
    v_pk_mul_f32 v[128:129], v[120:121], v[120:121] op_sel_hi:[1,0]
    v_pk_fma_f32 v[58:59], v[56:57], v[56:57], v[64:65] op_sel:[1,1,0] op_sel_hi:[0,1,1] neg_lo:[0,1,0]
    v_pk_fma_f32 v[90:91], v[88:89], v[88:89], v[96:97] op_sel:[1,1,0] op_sel_hi:[0,1,1] neg_lo:[0,1,0]
    v_pk_fma_f32 v[122:123], v[120:121], v[120:121], v[128:129] op_sel:[1,1,0] op_sel_hi:[0,1,1] neg_lo:[0,1,0]
    v_pk_mul_f32 v[64:65], v[58:59], v[58:59] op_sel_hi:[1,0]
    v_pk_mul_f32 v[96:97], v[90:91], v[90:91] op_sel_hi:[1,0]
    v_pk_mul_f32 v[128:129], v[122:123], v[122:123] op_sel_hi:[1,0]
    v_pk_fma_f32 v[60:61], v[58:59], v[58:59], v[64:65] op_sel:[1,1,0] op_sel_hi:[0,1,1] neg_lo:[0,1,0]
    v_pk_fma_f32 v[92:93], v[90:91], v[90:91], v[96:97] op_sel:[1,1,0] op_sel_hi:[0,1,1] neg_lo:[0,1,0]
    v_pk_fma_f32 v[124:125], v[122:123], v[122:123], v[128:129] op_sel:[1,1,0] op_sel_hi:[0,1,1] neg_lo:[0,1,0]
    v_pk_mul_f32 v[54:55], v[50:51], v[56:57] op_sel_hi:[1,0]
    v_pk_mul_f32 v[86:87], v[82:83], v[88:89] op_sel_hi:[1,0]
    v_pk_mul_f32 v[118:119], v[114:115], v[120:121] op_sel_hi:[1,0]
    v_pk_fma_f32 v[66:67], v[50:51], v[56:57], v[54:55] op_sel:[1,1,0] op_sel_hi:[0,1,1] neg_lo:[0,1,0]
    v_pk_fma_f32 v[98:99], v[82:83], v[88:89], v[86:87] op_sel:[1,1,0] op_sel_hi:[0,1,1] neg_lo:[0,1,0]
    v_pk_fma_f32 v[130:131], v[114:115], v[120:121], v[118:119] op_sel:[1,1,0] op_sel_hi:[0,1,1] neg_lo:[0,1,0]
    v_cvt_pk_bf16_f32 v76, v50, v66
    v_cvt_pk_bf16_f32 v108, v82, v98
    v_cvt_pk_bf16_f32 v140, v114, v130
    v_cvt_pk_bf16_f32 v77, -v51, -v67
    v_cvt_pk_bf16_f32 v109, -v83, -v99
    v_cvt_pk_bf16_f32 v141, -v115, -v131
    buffer_load_dwordx4 v165, s[12:15], s94 offen offset:512 lds
    s_add_u32 m0, s73, 12800
    v_accvgpr_write_b32 a152, v76
    v_accvgpr_write_b32 a184, v108
    v_accvgpr_write_b32 a216, v140
    v_accvgpr_write_b32 a156, v77
    v_accvgpr_write_b32 a188, v109
    v_accvgpr_write_b32 a220, v141
    v_pk_mul_f32 v[54:55], v[66:67], v[56:57] op_sel_hi:[1,0]
    v_pk_mul_f32 v[86:87], v[98:99], v[88:89] op_sel_hi:[1,0]
    v_pk_mul_f32 v[118:119], v[130:131], v[120:121] op_sel_hi:[1,0]
    v_pk_fma_f32 v[64:65], v[66:67], v[56:57], v[54:55] op_sel:[1,1,0] op_sel_hi:[0,1,1] neg_lo:[0,1,0]
    v_pk_fma_f32 v[96:97], v[98:99], v[88:89], v[86:87] op_sel:[1,1,0] op_sel_hi:[0,1,1] neg_lo:[0,1,0]
    v_pk_fma_f32 v[128:129], v[130:131], v[120:121], v[118:119] op_sel:[1,1,0] op_sel_hi:[0,1,1] neg_lo:[0,1,0]
    v_pk_mul_f32 v[54:55], v[64:65], v[56:57] op_sel_hi:[1,0]
    v_pk_mul_f32 v[86:87], v[96:97], v[88:89] op_sel_hi:[1,0]
    v_pk_mul_f32 v[118:119], v[128:129], v[120:121] op_sel_hi:[1,0]
    v_pk_fma_f32 v[66:67], v[64:65], v[56:57], v[54:55] op_sel:[1,1,0] op_sel_hi:[0,1,1] neg_lo:[0,1,0]
    v_pk_fma_f32 v[98:99], v[96:97], v[88:89], v[86:87] op_sel:[1,1,0] op_sel_hi:[0,1,1] neg_lo:[0,1,0]
    v_pk_fma_f32 v[130:131], v[128:129], v[120:121], v[118:119] op_sel:[1,1,0] op_sel_hi:[0,1,1] neg_lo:[0,1,0]
    v_cvt_pk_bf16_f32 v78, v64, v66
    v_cvt_pk_bf16_f32 v110, v96, v98
    v_cvt_pk_bf16_f32 v142, v128, v130
    v_cvt_pk_bf16_f32 v79, -v65, -v67
    buffer_load_dwordx4 v166, s[12:15], s95 offen offset:512 lds
    s_add_u32 m0, s72, 4480
    v_cvt_pk_bf16_f32 v111, -v97, -v99
    v_cvt_pk_bf16_f32 v143, -v129, -v131
    v_accvgpr_write_b32 a153, v78
    v_accvgpr_write_b32 a185, v110
    v_accvgpr_write_b32 a217, v142
    v_accvgpr_write_b32 a157, v79
    v_accvgpr_write_b32 a189, v111
    v_accvgpr_write_b32 a221, v143
    v_pk_mul_f32 v[54:55], v[66:67], v[56:57] op_sel_hi:[1,0]
    v_pk_mul_f32 v[86:87], v[98:99], v[88:89] op_sel_hi:[1,0]
    v_pk_mul_f32 v[118:119], v[130:131], v[120:121] op_sel_hi:[1,0]
    v_pk_fma_f32 v[68:69], v[66:67], v[56:57], v[54:55] op_sel:[1,1,0] op_sel_hi:[0,1,1] neg_lo:[0,1,0]
    v_pk_fma_f32 v[100:101], v[98:99], v[88:89], v[86:87] op_sel:[1,1,0] op_sel_hi:[0,1,1] neg_lo:[0,1,0]
    v_pk_fma_f32 v[132:133], v[130:131], v[120:121], v[118:119] op_sel:[1,1,0] op_sel_hi:[0,1,1] neg_lo:[0,1,0]
    v_pk_mul_f32 v[54:55], v[68:69], v[56:57] op_sel_hi:[1,0]
    v_pk_mul_f32 v[86:87], v[100:101], v[88:89] op_sel_hi:[1,0]
    v_pk_mul_f32 v[118:119], v[132:133], v[120:121] op_sel_hi:[1,0]
    v_pk_fma_f32 v[66:67], v[68:69], v[56:57], v[54:55] op_sel:[1,1,0] op_sel_hi:[0,1,1] neg_lo:[0,1,0]
    v_pk_fma_f32 v[98:99], v[100:101], v[88:89], v[86:87] op_sel:[1,1,0] op_sel_hi:[0,1,1] neg_lo:[0,1,0]
    v_pk_fma_f32 v[130:131], v[132:133], v[120:121], v[118:119] op_sel:[1,1,0] op_sel_hi:[0,1,1] neg_lo:[0,1,0]
    v_cvt_pk_bf16_f32 v76, v68, v66
    v_cvt_pk_bf16_f32 v108, v100, v98
    buffer_load_dwordx4 v165, s[12:15], s92 offen offset:640 lds
    s_add_u32 m0, s72, 13696
    v_cvt_pk_bf16_f32 v140, v132, v130
    v_cvt_pk_bf16_f32 v77, -v69, -v67
    v_cvt_pk_bf16_f32 v109, -v101, -v99
    v_cvt_pk_bf16_f32 v141, -v133, -v131
    v_accvgpr_write_b32 a154, v76
    v_accvgpr_write_b32 a186, v108
    v_accvgpr_write_b32 a218, v140
    v_accvgpr_write_b32 a158, v77
    v_accvgpr_write_b32 a190, v109
    v_accvgpr_write_b32 a222, v141
    v_pk_mul_f32 v[54:55], v[66:67], v[56:57] op_sel_hi:[1,0]
    v_pk_mul_f32 v[86:87], v[98:99], v[88:89] op_sel_hi:[1,0]
    v_pk_mul_f32 v[118:119], v[130:131], v[120:121] op_sel_hi:[1,0]
    v_pk_fma_f32 v[64:65], v[66:67], v[56:57], v[54:55] op_sel:[1,1,0] op_sel_hi:[0,1,1] neg_lo:[0,1,0]
    v_pk_fma_f32 v[96:97], v[98:99], v[88:89], v[86:87] op_sel:[1,1,0] op_sel_hi:[0,1,1] neg_lo:[0,1,0]
    v_pk_fma_f32 v[128:129], v[130:131], v[120:121], v[118:119] op_sel:[1,1,0] op_sel_hi:[0,1,1] neg_lo:[0,1,0]
    v_pk_mul_f32 v[54:55], v[64:65], v[56:57] op_sel_hi:[1,0]
    v_pk_mul_f32 v[86:87], v[96:97], v[88:89] op_sel_hi:[1,0]
    v_pk_mul_f32 v[118:119], v[128:129], v[120:121] op_sel_hi:[1,0]
    v_pk_fma_f32 v[66:67], v[64:65], v[56:57], v[54:55] op_sel:[1,1,0] op_sel_hi:[0,1,1] neg_lo:[0,1,0]
    v_pk_fma_f32 v[98:99], v[96:97], v[88:89], v[86:87] op_sel:[1,1,0] op_sel_hi:[0,1,1] neg_lo:[0,1,0]
    v_pk_fma_f32 v[130:131], v[128:129], v[120:121], v[118:119] op_sel:[1,1,0] op_sel_hi:[0,1,1] neg_lo:[0,1,0]
    buffer_load_dwordx4 v166, s[12:15], s93 offen offset:640 lds
    s_add_u32 m0, s73, 4480
    v_cvt_pk_bf16_f32 v78, v64, v66
    v_cvt_pk_bf16_f32 v110, v96, v98
    v_cvt_pk_bf16_f32 v142, v128, v130
    v_cvt_pk_bf16_f32 v79, -v65, -v67
    v_cvt_pk_bf16_f32 v111, -v97, -v99
    v_cvt_pk_bf16_f32 v143, -v129, -v131
    v_accvgpr_write_b32 a155, v78
    v_accvgpr_write_b32 a187, v110
    v_accvgpr_write_b32 a219, v142
    v_accvgpr_write_b32 a159, v79
    v_accvgpr_write_b32 a191, v111
    v_accvgpr_write_b32 a223, v143
    v_pk_mul_f32 v[54:55], v[66:67], v[56:57] op_sel_hi:[1,0]
    v_pk_mul_f32 v[86:87], v[98:99], v[88:89] op_sel_hi:[1,0]
    v_pk_mul_f32 v[118:119], v[130:131], v[120:121] op_sel_hi:[1,0]
    v_pk_fma_f32 v[70:71], v[66:67], v[56:57], v[54:55] op_sel:[1,1,0] op_sel_hi:[0,1,1] neg_lo:[0,1,0]
    v_pk_fma_f32 v[102:103], v[98:99], v[88:89], v[86:87] op_sel:[1,1,0] op_sel_hi:[0,1,1] neg_lo:[0,1,0]
    v_pk_fma_f32 v[134:135], v[130:131], v[120:121], v[118:119] op_sel:[1,1,0] op_sel_hi:[0,1,1] neg_lo:[0,1,0]
    v_pk_mul_f32 v[54:55], v[50:51], v[62:63] op_sel_hi:[1,0]
    v_pk_mul_f32 v[86:87], v[82:83], v[94:95] op_sel_hi:[1,0]
    v_pk_mul_f32 v[118:119], v[114:115], v[126:127] op_sel_hi:[1,0]
    v_pk_fma_f32 v[50:51], v[50:51], v[62:63], v[54:55] op_sel:[1,1,0] op_sel_hi:[0,1,1] neg_lo:[0,1,0]
    buffer_load_dwordx4 v165, s[12:15], s94 offen offset:640 lds
    s_add_u32 m0, s73, 13696
    v_pk_fma_f32 v[82:83], v[82:83], v[94:95], v[86:87] op_sel:[1,1,0] op_sel_hi:[0,1,1] neg_lo:[0,1,0]
    v_pk_fma_f32 v[114:115], v[114:115], v[126:127], v[118:119] op_sel:[1,1,0] op_sel_hi:[0,1,1] neg_lo:[0,1,0]
    v_pk_mul_f32 v[54:55], v[50:51], v[58:59] op_sel_hi:[1,0]
    v_pk_mul_f32 v[86:87], v[82:83], v[90:91] op_sel_hi:[1,0]
    v_pk_mul_f32 v[118:119], v[114:115], v[122:123] op_sel_hi:[1,0]
    v_pk_fma_f32 v[66:67], v[50:51], v[58:59], v[54:55] op_sel:[1,1,0] op_sel_hi:[0,1,1] neg_lo:[0,1,0]
    v_pk_fma_f32 v[98:99], v[82:83], v[90:91], v[86:87] op_sel:[1,1,0] op_sel_hi:[0,1,1] neg_lo:[0,1,0]
    v_pk_fma_f32 v[130:131], v[114:115], v[122:123], v[118:119] op_sel:[1,1,0] op_sel_hi:[0,1,1] neg_lo:[0,1,0]
    v_cvt_pk_bf16_f32 v76, v50, v66
    v_cvt_pk_bf16_f32 v108, v82, v98
    v_cvt_pk_bf16_f32 v140, v114, v130
    v_cvt_pk_bf16_f32 v77, -v51, -v67
    v_cvt_pk_bf16_f32 v109, -v83, -v99
    v_cvt_pk_bf16_f32 v141, -v115, -v131
    v_accvgpr_write_b32 a160, v76
    v_accvgpr_write_b32 a192, v108
    v_accvgpr_write_b32 a224, v140
    v_accvgpr_write_b32 a164, v77
    v_accvgpr_write_b32 a196, v109
    v_accvgpr_write_b32 a228, v141
    v_pk_mul_f32 v[54:55], v[66:67], v[58:59] op_sel_hi:[1,0]
    v_pk_mul_f32 v[86:87], v[98:99], v[90:91] op_sel_hi:[1,0]
    buffer_load_dwordx4 v166, s[12:15], s95 offen offset:640 lds
    s_add_u32 m0, s72, 5376
    v_pk_mul_f32 v[118:119], v[130:131], v[122:123] op_sel_hi:[1,0]
    v_pk_fma_f32 v[64:65], v[66:67], v[58:59], v[54:55] op_sel:[1,1,0] op_sel_hi:[0,1,1] neg_lo:[0,1,0]
    v_pk_fma_f32 v[96:97], v[98:99], v[90:91], v[86:87] op_sel:[1,1,0] op_sel_hi:[0,1,1] neg_lo:[0,1,0]
    v_pk_fma_f32 v[128:129], v[130:131], v[122:123], v[118:119] op_sel:[1,1,0] op_sel_hi:[0,1,1] neg_lo:[0,1,0]
    v_pk_mul_f32 v[54:55], v[64:65], v[58:59] op_sel_hi:[1,0]
    v_pk_mul_f32 v[86:87], v[96:97], v[90:91] op_sel_hi:[1,0]
    v_pk_mul_f32 v[118:119], v[128:129], v[122:123] op_sel_hi:[1,0]
    v_pk_fma_f32 v[66:67], v[64:65], v[58:59], v[54:55] op_sel:[1,1,0] op_sel_hi:[0,1,1] neg_lo:[0,1,0]
    v_pk_fma_f32 v[98:99], v[96:97], v[90:91], v[86:87] op_sel:[1,1,0] op_sel_hi:[0,1,1] neg_lo:[0,1,0]
    v_pk_fma_f32 v[130:131], v[128:129], v[122:123], v[118:119] op_sel:[1,1,0] op_sel_hi:[0,1,1] neg_lo:[0,1,0]
    v_cvt_pk_bf16_f32 v78, v64, v66
    v_cvt_pk_bf16_f32 v110, v96, v98
    v_cvt_pk_bf16_f32 v142, v128, v130
    v_cvt_pk_bf16_f32 v79, -v65, -v67
    v_cvt_pk_bf16_f32 v111, -v97, -v99
    v_cvt_pk_bf16_f32 v143, -v129, -v131
    v_accvgpr_write_b32 a161, v78
    v_accvgpr_write_b32 a193, v110
    v_accvgpr_write_b32 a225, v142
    v_accvgpr_write_b32 a165, v79
    v_accvgpr_write_b32 a197, v111
    v_accvgpr_write_b32 a229, v143
    buffer_load_dwordx4 v165, s[12:15], s92 offen offset:768 lds
    s_add_u32 m0, s72, 14592
    v_pk_mul_f32 v[54:55], v[66:67], v[58:59] op_sel_hi:[1,0]
    v_pk_mul_f32 v[86:87], v[98:99], v[90:91] op_sel_hi:[1,0]
    v_pk_mul_f32 v[118:119], v[130:131], v[122:123] op_sel_hi:[1,0]
    v_pk_fma_f32 v[72:73], v[66:67], v[58:59], v[54:55] op_sel:[1,1,0] op_sel_hi:[0,1,1] neg_lo:[0,1,0]
    v_pk_fma_f32 v[104:105], v[98:99], v[90:91], v[86:87] op_sel:[1,1,0] op_sel_hi:[0,1,1] neg_lo:[0,1,0]
    v_pk_fma_f32 v[136:137], v[130:131], v[122:123], v[118:119] op_sel:[1,1,0] op_sel_hi:[0,1,1] neg_lo:[0,1,0]
    v_pk_mul_f32 v[54:55], v[50:51], v[62:63] op_sel_hi:[1,0]
    v_pk_mul_f32 v[86:87], v[82:83], v[94:95] op_sel_hi:[1,0]
    v_pk_mul_f32 v[118:119], v[114:115], v[126:127] op_sel_hi:[1,0]
    v_pk_fma_f32 v[50:51], v[50:51], v[62:63], v[54:55] op_sel:[1,1,0] op_sel_hi:[0,1,1] neg_lo:[0,1,0]
    v_pk_fma_f32 v[82:83], v[82:83], v[94:95], v[86:87] op_sel:[1,1,0] op_sel_hi:[0,1,1] neg_lo:[0,1,0]
    v_pk_fma_f32 v[114:115], v[114:115], v[126:127], v[118:119] op_sel:[1,1,0] op_sel_hi:[0,1,1] neg_lo:[0,1,0]
    v_pk_mul_f32 v[54:55], v[50:51], v[58:59] op_sel_hi:[1,0]
    v_pk_mul_f32 v[86:87], v[82:83], v[90:91] op_sel_hi:[1,0]
    v_pk_mul_f32 v[118:119], v[114:115], v[122:123] op_sel_hi:[1,0]
    v_pk_fma_f32 v[66:67], v[50:51], v[58:59], v[54:55] op_sel:[1,1,0] op_sel_hi:[0,1,1] neg_lo:[0,1,0]
    v_pk_fma_f32 v[98:99], v[82:83], v[90:91], v[86:87] op_sel:[1,1,0] op_sel_hi:[0,1,1] neg_lo:[0,1,0]
    v_pk_fma_f32 v[130:131], v[114:115], v[122:123], v[118:119] op_sel:[1,1,0] op_sel_hi:[0,1,1] neg_lo:[0,1,0]
    v_cvt_pk_bf16_f32 v76, v50, v66
    v_cvt_pk_bf16_f32 v108, v82, v98
    v_cvt_pk_bf16_f32 v140, v114, v130
    v_cvt_pk_bf16_f32 v77, -v51, -v67
    buffer_load_dwordx4 v166, s[12:15], s93 offen offset:768 lds
    s_add_u32 m0, s73, 5376
    v_cvt_pk_bf16_f32 v109, -v83, -v99
    v_cvt_pk_bf16_f32 v141, -v115, -v131
    v_accvgpr_write_b32 a162, v76
    v_accvgpr_write_b32 a194, v108
    v_accvgpr_write_b32 a226, v140
    v_accvgpr_write_b32 a166, v77
    v_accvgpr_write_b32 a198, v109
    v_accvgpr_write_b32 a230, v141
    v_pk_mul_f32 v[54:55], v[66:67], v[58:59] op_sel_hi:[1,0]
    v_pk_mul_f32 v[86:87], v[98:99], v[90:91] op_sel_hi:[1,0]
    v_pk_mul_f32 v[118:119], v[130:131], v[122:123] op_sel_hi:[1,0]
    v_pk_fma_f32 v[64:65], v[66:67], v[58:59], v[54:55] op_sel:[1,1,0] op_sel_hi:[0,1,1] neg_lo:[0,1,0]
    v_pk_fma_f32 v[96:97], v[98:99], v[90:91], v[86:87] op_sel:[1,1,0] op_sel_hi:[0,1,1] neg_lo:[0,1,0]
    v_pk_fma_f32 v[128:129], v[130:131], v[122:123], v[118:119] op_sel:[1,1,0] op_sel_hi:[0,1,1] neg_lo:[0,1,0]
    v_pk_mul_f32 v[54:55], v[64:65], v[58:59] op_sel_hi:[1,0]
    v_pk_mul_f32 v[86:87], v[96:97], v[90:91] op_sel_hi:[1,0]
    v_pk_mul_f32 v[118:119], v[128:129], v[122:123] op_sel_hi:[1,0]
    v_pk_fma_f32 v[66:67], v[64:65], v[58:59], v[54:55] op_sel:[1,1,0] op_sel_hi:[0,1,1] neg_lo:[0,1,0]
    v_pk_fma_f32 v[98:99], v[96:97], v[90:91], v[86:87] op_sel:[1,1,0] op_sel_hi:[0,1,1] neg_lo:[0,1,0]
    v_pk_fma_f32 v[130:131], v[128:129], v[122:123], v[118:119] op_sel:[1,1,0] op_sel_hi:[0,1,1] neg_lo:[0,1,0]
    v_cvt_pk_bf16_f32 v78, v64, v66
    v_cvt_pk_bf16_f32 v110, v96, v98
    buffer_load_dwordx4 v165, s[12:15], s94 offen offset:768 lds
    s_add_u32 m0, s73, 14592
    v_cvt_pk_bf16_f32 v142, v128, v130
    v_cvt_pk_bf16_f32 v79, -v65, -v67
    v_cvt_pk_bf16_f32 v111, -v97, -v99
    v_cvt_pk_bf16_f32 v143, -v129, -v131
    v_accvgpr_write_b32 a163, v78
    v_accvgpr_write_b32 a195, v110
    v_accvgpr_write_b32 a227, v142
    v_accvgpr_write_b32 a167, v79
    v_accvgpr_write_b32 a199, v111
    v_accvgpr_write_b32 a231, v143
    v_pk_mul_f32 v[54:55], v[66:67], v[58:59] op_sel_hi:[1,0]
    v_pk_mul_f32 v[86:87], v[98:99], v[90:91] op_sel_hi:[1,0]
    v_pk_mul_f32 v[118:119], v[130:131], v[122:123] op_sel_hi:[1,0]
    v_pk_fma_f32 v[74:75], v[66:67], v[58:59], v[54:55] op_sel:[1,1,0] op_sel_hi:[0,1,1] neg_lo:[0,1,0]
    v_pk_fma_f32 v[106:107], v[98:99], v[90:91], v[86:87] op_sel:[1,1,0] op_sel_hi:[0,1,1] neg_lo:[0,1,0]
    v_pk_fma_f32 v[138:139], v[130:131], v[122:123], v[118:119] op_sel:[1,1,0] op_sel_hi:[0,1,1] neg_lo:[0,1,0]
    v_pk_mul_f32 v[54:55], v[50:51], v[62:63] op_sel_hi:[1,0]
    v_pk_mul_f32 v[86:87], v[82:83], v[94:95] op_sel_hi:[1,0]
    v_pk_mul_f32 v[118:119], v[114:115], v[126:127] op_sel_hi:[1,0]
    v_pk_fma_f32 v[50:51], v[50:51], v[62:63], v[54:55] op_sel:[1,1,0] op_sel_hi:[0,1,1] neg_lo:[0,1,0]
    v_pk_fma_f32 v[82:83], v[82:83], v[94:95], v[86:87] op_sel:[1,1,0] op_sel_hi:[0,1,1] neg_lo:[0,1,0]
    v_pk_fma_f32 v[114:115], v[114:115], v[126:127], v[118:119] op_sel:[1,1,0] op_sel_hi:[0,1,1] neg_lo:[0,1,0]
    buffer_load_dwordx4 v166, s[12:15], s95 offen offset:768 lds
    s_waitcnt vmcnt(48)
    ds_read_b128 v[0:3], v180 offset:0
    ds_read_b128 v[4:7], v181 offset:0
    ds_read_b128 v[8:11], v182 offset:0
    ds_read_b128 v[12:15], v183 offset:0
    s_add_u32 m0, s72, 6272
    v_cvt_pk_bf16_f32 v76, v68, v50
    v_cvt_pk_bf16_f32 v108, v100, v82
    v_cvt_pk_bf16_f32 v140, v132, v114
    v_cvt_pk_bf16_f32 v77, -v69, -v51
    v_cvt_pk_bf16_f32 v109, -v101, -v83
    v_cvt_pk_bf16_f32 v141, -v133, -v115
    v_accvgpr_write_b32 a168, v76
    v_accvgpr_write_b32 a200, v108
    v_accvgpr_write_b32 a232, v140
    v_accvgpr_write_b32 a172, v77
    v_accvgpr_write_b32 a204, v109
    v_accvgpr_write_b32 a236, v141
    v_pk_mul_f32 v[54:55], v[50:51], v[60:61] op_sel_hi:[1,0]
    v_pk_mul_f32 v[86:87], v[82:83], v[92:93] op_sel_hi:[1,0]
    v_pk_mul_f32 v[118:119], v[114:115], v[124:125] op_sel_hi:[1,0]
    v_pk_fma_f32 v[64:65], v[50:51], v[60:61], v[54:55] op_sel:[1,1,0] op_sel_hi:[0,1,1] neg_lo:[0,1,0]
    v_pk_fma_f32 v[96:97], v[82:83], v[92:93], v[86:87] op_sel:[1,1,0] op_sel_hi:[0,1,1] neg_lo:[0,1,0]
    v_pk_fma_f32 v[128:129], v[114:115], v[124:125], v[118:119] op_sel:[1,1,0] op_sel_hi:[0,1,1] neg_lo:[0,1,0]
    v_pk_mul_f32 v[54:55], v[64:65], v[60:61] op_sel_hi:[1,0]
    v_pk_mul_f32 v[86:87], v[96:97], v[92:93] op_sel_hi:[1,0]
    v_pk_mul_f32 v[118:119], v[128:129], v[124:125] op_sel_hi:[1,0]
    v_pk_fma_f32 v[66:67], v[64:65], v[60:61], v[54:55] op_sel:[1,1,0] op_sel_hi:[0,1,1] neg_lo:[0,1,0]
    buffer_load_dwordx4 v165, s[12:15], s92 offen offset:896 lds
    s_add_u32 m0, s72, 15488
    v_pk_fma_f32 v[98:99], v[96:97], v[92:93], v[86:87] op_sel:[1,1,0] op_sel_hi:[0,1,1] neg_lo:[0,1,0]
    v_pk_fma_f32 v[130:131], v[128:129], v[124:125], v[118:119] op_sel:[1,1,0] op_sel_hi:[0,1,1] neg_lo:[0,1,0]
    v_cvt_pk_bf16_f32 v78, v64, v66
    v_cvt_pk_bf16_f32 v110, v96, v98
    v_cvt_pk_bf16_f32 v142, v128, v130
    v_cvt_pk_bf16_f32 v79, -v65, -v67
    v_cvt_pk_bf16_f32 v111, -v97, -v99
    v_cvt_pk_bf16_f32 v143, -v129, -v131
    v_accvgpr_write_b32 a169, v78
    v_accvgpr_write_b32 a201, v110
    v_accvgpr_write_b32 a233, v142
    v_accvgpr_write_b32 a173, v79
    v_accvgpr_write_b32 a205, v111
    v_accvgpr_write_b32 a237, v143
    v_pk_mul_f32 v[54:55], v[50:51], v[62:63] op_sel_hi:[1,0]
    v_pk_mul_f32 v[86:87], v[82:83], v[94:95] op_sel_hi:[1,0]
    v_pk_mul_f32 v[118:119], v[114:115], v[126:127] op_sel_hi:[1,0]
    v_pk_fma_f32 v[50:51], v[50:51], v[62:63], v[54:55] op_sel:[1,1,0] op_sel_hi:[0,1,1] neg_lo:[0,1,0]
    v_pk_fma_f32 v[82:83], v[82:83], v[94:95], v[86:87] op_sel:[1,1,0] op_sel_hi:[0,1,1] neg_lo:[0,1,0]
    v_pk_fma_f32 v[114:115], v[114:115], v[126:127], v[118:119] op_sel:[1,1,0] op_sel_hi:[0,1,1] neg_lo:[0,1,0]
    v_cvt_pk_bf16_f32 v76, v70, v50
    v_cvt_pk_bf16_f32 v108, v102, v82
    buffer_load_dwordx4 v166, s[12:15], s93 offen offset:896 lds
    s_add_u32 m0, s73, 6272
    v_cvt_pk_bf16_f32 v140, v134, v114
    v_cvt_pk_bf16_f32 v77, -v71, -v51
    v_cvt_pk_bf16_f32 v109, -v103, -v83
    v_cvt_pk_bf16_f32 v141, -v135, -v115
    v_accvgpr_write_b32 a170, v76
    v_accvgpr_write_b32 a202, v108
    v_accvgpr_write_b32 a234, v140
    v_accvgpr_write_b32 a174, v77
    v_accvgpr_write_b32 a206, v109
    v_accvgpr_write_b32 a238, v141
    v_pk_mul_f32 v[54:55], v[50:51], v[60:61] op_sel_hi:[1,0]
    v_pk_mul_f32 v[86:87], v[82:83], v[92:93] op_sel_hi:[1,0]
    v_pk_mul_f32 v[118:119], v[114:115], v[124:125] op_sel_hi:[1,0]
    v_pk_fma_f32 v[64:65], v[50:51], v[60:61], v[54:55] op_sel:[1,1,0] op_sel_hi:[0,1,1] neg_lo:[0,1,0]
    v_pk_fma_f32 v[96:97], v[82:83], v[92:93], v[86:87] op_sel:[1,1,0] op_sel_hi:[0,1,1] neg_lo:[0,1,0]
    v_pk_fma_f32 v[128:129], v[114:115], v[124:125], v[118:119] op_sel:[1,1,0] op_sel_hi:[0,1,1] neg_lo:[0,1,0]
    v_pk_mul_f32 v[54:55], v[64:65], v[60:61] op_sel_hi:[1,0]
    v_pk_mul_f32 v[86:87], v[96:97], v[92:93] op_sel_hi:[1,0]
    v_pk_mul_f32 v[118:119], v[128:129], v[124:125] op_sel_hi:[1,0]
    v_pk_fma_f32 v[66:67], v[64:65], v[60:61], v[54:55] op_sel:[1,1,0] op_sel_hi:[0,1,1] neg_lo:[0,1,0]
    v_pk_fma_f32 v[98:99], v[96:97], v[92:93], v[86:87] op_sel:[1,1,0] op_sel_hi:[0,1,1] neg_lo:[0,1,0]
    v_pk_fma_f32 v[130:131], v[128:129], v[124:125], v[118:119] op_sel:[1,1,0] op_sel_hi:[0,1,1] neg_lo:[0,1,0]
    buffer_load_dwordx4 v165, s[12:15], s94 offen offset:896 lds
    s_add_u32 m0, s73, 15488
    v_cvt_pk_bf16_f32 v78, v64, v66
    v_cvt_pk_bf16_f32 v110, v96, v98
    v_cvt_pk_bf16_f32 v142, v128, v130
    v_cvt_pk_bf16_f32 v79, -v65, -v67
    v_cvt_pk_bf16_f32 v111, -v97, -v99
    v_cvt_pk_bf16_f32 v143, -v129, -v131
    v_accvgpr_write_b32 a171, v78
    v_accvgpr_write_b32 a203, v110
    v_accvgpr_write_b32 a235, v142
    v_accvgpr_write_b32 a175, v79
    v_accvgpr_write_b32 a207, v111
    v_accvgpr_write_b32 a239, v143
    v_pk_mul_f32 v[54:55], v[50:51], v[62:63] op_sel_hi:[1,0]
    v_pk_mul_f32 v[86:87], v[82:83], v[94:95] op_sel_hi:[1,0]
    v_pk_mul_f32 v[118:119], v[114:115], v[126:127] op_sel_hi:[1,0]
    v_pk_fma_f32 v[50:51], v[50:51], v[62:63], v[54:55] op_sel:[1,1,0] op_sel_hi:[0,1,1] neg_lo:[0,1,0]
    v_pk_fma_f32 v[82:83], v[82:83], v[94:95], v[86:87] op_sel:[1,1,0] op_sel_hi:[0,1,1] neg_lo:[0,1,0]
    v_pk_fma_f32 v[114:115], v[114:115], v[126:127], v[118:119] op_sel:[1,1,0] op_sel_hi:[0,1,1] neg_lo:[0,1,0]
    v_cvt_pk_bf16_f32 v76, v72, v50
    v_cvt_pk_bf16_f32 v108, v104, v82
    v_cvt_pk_bf16_f32 v140, v136, v114
    v_cvt_pk_bf16_f32 v77, -v73, -v51
    buffer_load_dwordx4 v166, s[12:15], s95 offen offset:896 lds
    s_waitcnt vmcnt(24)
    ds_read_b128 v[16:19], v180 offset:1024
    ds_read_b128 v[20:23], v181 offset:1024
    ds_read_b128 v[24:27], v182 offset:1024
    ds_read_b128 v[28:31], v183 offset:1024
    s_waitcnt lgkmcnt(7)
    v_dot2c_f32_bf16 v196, s100, v0
    v_dot2c_f32_bf16 v198, v0, v0
    v_dot2c_f32_bf16 v197, s100, v1
    v_dot2c_f32_bf16 v199, v1, v1
    v_dot2c_f32_bf16 v196, s100, v2
    v_dot2c_f32_bf16 v198, v2, v2
    v_dot2c_f32_bf16 v197, s100, v3
    v_dot2c_f32_bf16 v199, v3, v3
    s_waitcnt lgkmcnt(6)
    v_dot2c_f32_bf16 v196, s100, v4
    v_dot2c_f32_bf16 v198, v4, v4
    v_dot2c_f32_bf16 v197, s100, v5
    v_dot2c_f32_bf16 v199, v5, v5
    v_dot2c_f32_bf16 v196, s100, v6
    v_dot2c_f32_bf16 v198, v6, v6
    v_dot2c_f32_bf16 v197, s100, v7
    v_dot2c_f32_bf16 v199, v7, v7
    s_waitcnt lgkmcnt(5)
    v_dot2c_f32_bf16 v196, s100, v8
    v_dot2c_f32_bf16 v198, v8, v8
    v_dot2c_f32_bf16 v197, s100, v9
    v_dot2c_f32_bf16 v199, v9, v9
    v_dot2c_f32_bf16 v196, s100, v10
    v_dot2c_f32_bf16 v198, v10, v10
    v_dot2c_f32_bf16 v197, s100, v11
    v_dot2c_f32_bf16 v199, v11, v11
    s_waitcnt lgkmcnt(4)
    v_dot2c_f32_bf16 v196, s100, v12
    v_dot2c_f32_bf16 v198, v12, v12
    v_dot2c_f32_bf16 v197, s100, v13
    v_dot2c_f32_bf16 v199, v13, v13
    v_dot2c_f32_bf16 v196, s100, v14
    v_dot2c_f32_bf16 v198, v14, v14
    v_dot2c_f32_bf16 v197, s100, v15
    v_dot2c_f32_bf16 v199, v15, v15
    s_add_u32 m0, s72, 7168
    v_cvt_pk_bf16_f32 v109, -v105, -v83
    v_cvt_pk_bf16_f32 v141, -v137, -v115
    v_accvgpr_write_b32 a176, v76
    v_accvgpr_write_b32 a208, v108
    v_accvgpr_write_b32 a240, v140
    v_accvgpr_write_b32 a180, v77
    v_accvgpr_write_b32 a212, v109
    v_accvgpr_write_b32 a244, v141
    v_pk_mul_f32 v[54:55], v[50:51], v[60:61] op_sel_hi:[1,0]
    v_pk_mul_f32 v[86:87], v[82:83], v[92:93] op_sel_hi:[1,0]
    v_pk_mul_f32 v[118:119], v[114:115], v[124:125] op_sel_hi:[1,0]
    v_pk_fma_f32 v[64:65], v[50:51], v[60:61], v[54:55] op_sel:[1,1,0] op_sel_hi:[0,1,1] neg_lo:[0,1,0]
    v_pk_fma_f32 v[96:97], v[82:83], v[92:93], v[86:87] op_sel:[1,1,0] op_sel_hi:[0,1,1] neg_lo:[0,1,0]
    v_pk_fma_f32 v[128:129], v[114:115], v[124:125], v[118:119] op_sel:[1,1,0] op_sel_hi:[0,1,1] neg_lo:[0,1,0]
    v_pk_mul_f32 v[54:55], v[64:65], v[60:61] op_sel_hi:[1,0]
    v_pk_mul_f32 v[86:87], v[96:97], v[92:93] op_sel_hi:[1,0]
    v_pk_mul_f32 v[118:119], v[128:129], v[124:125] op_sel_hi:[1,0]
    v_pk_fma_f32 v[66:67], v[64:65], v[60:61], v[54:55] op_sel:[1,1,0] op_sel_hi:[0,1,1] neg_lo:[0,1,0]
    v_pk_fma_f32 v[98:99], v[96:97], v[92:93], v[86:87] op_sel:[1,1,0] op_sel_hi:[0,1,1] neg_lo:[0,1,0]
    v_pk_fma_f32 v[130:131], v[128:129], v[124:125], v[118:119] op_sel:[1,1,0] op_sel_hi:[0,1,1] neg_lo:[0,1,0]
    v_cvt_pk_bf16_f32 v78, v64, v66
    v_cvt_pk_bf16_f32 v110, v96, v98
    buffer_load_dwordx4 v165, s[12:15], s92 offen offset:1024 lds
    s_add_u32 m0, s72, 16384
    v_cvt_pk_bf16_f32 v142, v128, v130
    v_cvt_pk_bf16_f32 v79, -v65, -v67
    v_cvt_pk_bf16_f32 v111, -v97, -v99
    v_cvt_pk_bf16_f32 v143, -v129, -v131
    v_accvgpr_write_b32 a177, v78
    v_accvgpr_write_b32 a209, v110
    v_accvgpr_write_b32 a241, v142
    v_accvgpr_write_b32 a181, v79
    v_accvgpr_write_b32 a213, v111
    v_accvgpr_write_b32 a245, v143
    v_pk_mul_f32 v[54:55], v[50:51], v[62:63] op_sel_hi:[1,0]
    v_pk_mul_f32 v[86:87], v[82:83], v[94:95] op_sel_hi:[1,0]
    v_pk_mul_f32 v[118:119], v[114:115], v[126:127] op_sel_hi:[1,0]
    v_pk_fma_f32 v[50:51], v[50:51], v[62:63], v[54:55] op_sel:[1,1,0] op_sel_hi:[0,1,1] neg_lo:[0,1,0]
    v_pk_fma_f32 v[82:83], v[82:83], v[94:95], v[86:87] op_sel:[1,1,0] op_sel_hi:[0,1,1] neg_lo:[0,1,0]
    v_pk_fma_f32 v[114:115], v[114:115], v[126:127], v[118:119] op_sel:[1,1,0] op_sel_hi:[0,1,1] neg_lo:[0,1,0]
    v_cvt_pk_bf16_f32 v76, v74, v50
    v_cvt_pk_bf16_f32 v108, v106, v82
    v_cvt_pk_bf16_f32 v140, v138, v114
    v_cvt_pk_bf16_f32 v77, -v75, -v51
    v_cvt_pk_bf16_f32 v109, -v107, -v83
    v_cvt_pk_bf16_f32 v141, -v139, -v115
    buffer_load_dwordx4 v166, s[12:15], s93 offen offset:1024 lds
    s_add_u32 m0, s73, 7168
    v_accvgpr_write_b32 a178, v76
    v_accvgpr_write_b32 a210, v108
    v_accvgpr_write_b32 a242, v140
    v_accvgpr_write_b32 a182, v77
    v_accvgpr_write_b32 a214, v109
    v_accvgpr_write_b32 a246, v141
    v_pk_mul_f32 v[54:55], v[50:51], v[60:61] op_sel_hi:[1,0]
    v_pk_mul_f32 v[86:87], v[82:83], v[92:93] op_sel_hi:[1,0]
    v_pk_mul_f32 v[118:119], v[114:115], v[124:125] op_sel_hi:[1,0]
    v_pk_fma_f32 v[64:65], v[50:51], v[60:61], v[54:55] op_sel:[1,1,0] op_sel_hi:[0,1,1] neg_lo:[0,1,0]
    v_pk_fma_f32 v[96:97], v[82:83], v[92:93], v[86:87] op_sel:[1,1,0] op_sel_hi:[0,1,1] neg_lo:[0,1,0]
    v_pk_fma_f32 v[128:129], v[114:115], v[124:125], v[118:119] op_sel:[1,1,0] op_sel_hi:[0,1,1] neg_lo:[0,1,0]
    v_pk_mul_f32 v[54:55], v[64:65], v[60:61] op_sel_hi:[1,0]
    v_pk_mul_f32 v[86:87], v[96:97], v[92:93] op_sel_hi:[1,0]
    v_pk_mul_f32 v[118:119], v[128:129], v[124:125] op_sel_hi:[1,0]
    v_pk_fma_f32 v[66:67], v[64:65], v[60:61], v[54:55] op_sel:[1,1,0] op_sel_hi:[0,1,1] neg_lo:[0,1,0]
    v_pk_fma_f32 v[98:99], v[96:97], v[92:93], v[86:87] op_sel:[1,1,0] op_sel_hi:[0,1,1] neg_lo:[0,1,0]
    v_pk_fma_f32 v[130:131], v[128:129], v[124:125], v[118:119] op_sel:[1,1,0] op_sel_hi:[0,1,1] neg_lo:[0,1,0]
    v_cvt_pk_bf16_f32 v78, v64, v66
    v_cvt_pk_bf16_f32 v110, v96, v98
    v_cvt_pk_bf16_f32 v142, v128, v130
    v_cvt_pk_bf16_f32 v79, -v65, -v67
    buffer_load_dwordx4 v165, s[12:15], s94 offen offset:1024 lds
    s_add_u32 m0, s73, 16384
    v_cvt_pk_bf16_f32 v111, -v97, -v99
    v_cvt_pk_bf16_f32 v143, -v129, -v131
    v_accvgpr_write_b32 a179, v78
    v_accvgpr_write_b32 a211, v110
    v_accvgpr_write_b32 a243, v142
    v_accvgpr_write_b32 a183, v79
    v_accvgpr_write_b32 a215, v111
    v_accvgpr_write_b32 a247, v143
    buffer_load_dwordx4 v166, s[12:15], s95 offen offset:1024 lds
L_iss2:
    s_waitcnt vmcnt(24)
    ds_read_b128 v[32:35], v180 offset:2048
    ds_read_b128 v[36:39], v181 offset:2048
    ds_read_b128 v[40:43], v182 offset:2048
    ds_read_b128 v[44:47], v183 offset:2048
    s_waitcnt lgkmcnt(7)
    v_dot2c_f32_bf16 v196, s100, v16
    v_dot2c_f32_bf16 v198, v16, v16
    v_dot2c_f32_bf16 v197, s100, v17
    v_dot2c_f32_bf16 v199, v17, v17
    v_dot2c_f32_bf16 v196, s100, v18
    v_dot2c_f32_bf16 v198, v18, v18
    v_dot2c_f32_bf16 v197, s100, v19
    v_dot2c_f32_bf16 v199, v19, v19
    s_waitcnt lgkmcnt(6)
    v_dot2c_f32_bf16 v196, s100, v20
    v_dot2c_f32_bf16 v198, v20, v20
    v_dot2c_f32_bf16 v197, s100, v21
    v_dot2c_f32_bf16 v199, v21, v21
    v_dot2c_f32_bf16 v196, s100, v22
    v_dot2c_f32_bf16 v198, v22, v22
    v_dot2c_f32_bf16 v197, s100, v23
    v_dot2c_f32_bf16 v199, v23, v23
    s_waitcnt lgkmcnt(5)
    v_dot2c_f32_bf16 v196, s100, v24
    v_dot2c_f32_bf16 v198, v24, v24
    v_dot2c_f32_bf16 v197, s100, v25
    v_dot2c_f32_bf16 v199, v25, v25
    v_dot2c_f32_bf16 v196, s100, v26
    v_dot2c_f32_bf16 v198, v26, v26
    v_dot2c_f32_bf16 v197, s100, v27
    v_dot2c_f32_bf16 v199, v27, v27
    s_waitcnt lgkmcnt(4)
    v_dot2c_f32_bf16 v196, s100, v28
    v_dot2c_f32_bf16 v198, v28, v28
    v_dot2c_f32_bf16 v197, s100, v29
    v_dot2c_f32_bf16 v199, v29, v29
    v_dot2c_f32_bf16 v196, s100, v30
    v_dot2c_f32_bf16 v198, v30, v30
    v_dot2c_f32_bf16 v197, s100, v31
    v_dot2c_f32_bf16 v199, v31, v31
    s_waitcnt vmcnt(20)
    ds_read_b128 v[48:51], v180 offset:3072
    ds_read_b128 v[52:55], v181 offset:3072
    ds_read_b128 v[56:59], v182 offset:3072
    ds_read_b128 v[60:63], v183 offset:3072
    s_waitcnt lgkmcnt(7)
    v_dot2c_f32_bf16 v196, s100, v32
    v_dot2c_f32_bf16 v198, v32, v32
    v_dot2c_f32_bf16 v197, s100, v33
    v_dot2c_f32_bf16 v199, v33, v33
    v_dot2c_f32_bf16 v196, s100, v34
    v_dot2c_f32_bf16 v198, v34, v34
    v_dot2c_f32_bf16 v197, s100, v35
    v_dot2c_f32_bf16 v199, v35, v35
    s_waitcnt lgkmcnt(6)
    v_dot2c_f32_bf16 v196, s100, v36
    v_dot2c_f32_bf16 v198, v36, v36
    v_dot2c_f32_bf16 v197, s100, v37
    v_dot2c_f32_bf16 v199, v37, v37
    v_dot2c_f32_bf16 v196, s100, v38
    v_dot2c_f32_bf16 v198, v38, v38
    v_dot2c_f32_bf16 v197, s100, v39
    v_dot2c_f32_bf16 v199, v39, v39
    s_waitcnt lgkmcnt(5)
    v_dot2c_f32_bf16 v196, s100, v40
    v_dot2c_f32_bf16 v198, v40, v40
    v_dot2c_f32_bf16 v197, s100, v41
    v_dot2c_f32_bf16 v199, v41, v41
    v_dot2c_f32_bf16 v196, s100, v42
    v_dot2c_f32_bf16 v198, v42, v42
    v_dot2c_f32_bf16 v197, s100, v43
    v_dot2c_f32_bf16 v199, v43, v43
    s_waitcnt lgkmcnt(4)
    v_dot2c_f32_bf16 v196, s100, v44
    v_dot2c_f32_bf16 v198, v44, v44
    v_dot2c_f32_bf16 v197, s100, v45
    v_dot2c_f32_bf16 v199, v45, v45
    v_dot2c_f32_bf16 v196, s100, v46
    v_dot2c_f32_bf16 v198, v46, v46
    v_dot2c_f32_bf16 v197, s100, v47
    v_dot2c_f32_bf16 v199, v47, v47
    s_waitcnt vmcnt(16)
    ds_read_b128 v[64:67], v180 offset:4096
    ds_read_b128 v[68:71], v181 offset:4096
    ds_read_b128 v[72:75], v182 offset:4096
    ds_read_b128 v[76:79], v183 offset:4096
    s_waitcnt lgkmcnt(7)
    v_dot2c_f32_bf16 v196, s100, v48
    v_dot2c_f32_bf16 v198, v48, v48
    v_dot2c_f32_bf16 v197, s100, v49
    v_dot2c_f32_bf16 v199, v49, v49
    v_dot2c_f32_bf16 v196, s100, v50
    v_dot2c_f32_bf16 v198, v50, v50
    v_dot2c_f32_bf16 v197, s100, v51
    v_dot2c_f32_bf16 v199, v51, v51
    s_waitcnt lgkmcnt(6)
    v_dot2c_f32_bf16 v196, s100, v52
    v_dot2c_f32_bf16 v198, v52, v52
    v_dot2c_f32_bf16 v197, s100, v53
    v_dot2c_f32_bf16 v199, v53, v53
    v_dot2c_f32_bf16 v196, s100, v54
    v_dot2c_f32_bf16 v198, v54, v54
    v_dot2c_f32_bf16 v197, s100, v55
    v_dot2c_f32_bf16 v199, v55, v55
    s_waitcnt lgkmcnt(5)
    v_dot2c_f32_bf16 v196, s100, v56
    v_dot2c_f32_bf16 v198, v56, v56
    v_dot2c_f32_bf16 v197, s100, v57
    v_dot2c_f32_bf16 v199, v57, v57
    v_dot2c_f32_bf16 v196, s100, v58
    v_dot2c_f32_bf16 v198, v58, v58
    v_dot2c_f32_bf16 v197, s100, v59
    v_dot2c_f32_bf16 v199, v59, v59
    s_waitcnt lgkmcnt(4)
    v_dot2c_f32_bf16 v196, s100, v60
    v_dot2c_f32_bf16 v198, v60, v60
    v_dot2c_f32_bf16 v197, s100, v61
    v_dot2c_f32_bf16 v199, v61, v61
    v_dot2c_f32_bf16 v196, s100, v62
    v_dot2c_f32_bf16 v198, v62, v62
    v_dot2c_f32_bf16 v197, s100, v63
    v_dot2c_f32_bf16 v199, v63, v63
    s_waitcnt vmcnt(12)
    ds_read_b128 v[80:83], v180 offset:5120
    ds_read_b128 v[84:87], v181 offset:5120
    ds_read_b128 v[88:91], v182 offset:5120
    ds_read_b128 v[92:95], v183 offset:5120
    s_waitcnt lgkmcnt(7)
    v_dot2c_f32_bf16 v196, s100, v64
    v_dot2c_f32_bf16 v198, v64, v64
    v_dot2c_f32_bf16 v197, s100, v65
    v_dot2c_f32_bf16 v199, v65, v65
    v_dot2c_f32_bf16 v196, s100, v66
    v_dot2c_f32_bf16 v198, v66, v66
    v_dot2c_f32_bf16 v197, s100, v67
    v_dot2c_f32_bf16 v199, v67, v67
    s_waitcnt lgkmcnt(6)
    v_dot2c_f32_bf16 v196, s100, v68
    v_dot2c_f32_bf16 v198, v68, v68
    v_dot2c_f32_bf16 v197, s100, v69
    v_dot2c_f32_bf16 v199, v69, v69
    v_dot2c_f32_bf16 v196, s100, v70
    v_dot2c_f32_bf16 v198, v70, v70
    v_dot2c_f32_bf16 v197, s100, v71
    v_dot2c_f32_bf16 v199, v71, v71
    s_waitcnt lgkmcnt(5)
    v_dot2c_f32_bf16 v196, s100, v72
    v_dot2c_f32_bf16 v198, v72, v72
    v_dot2c_f32_bf16 v197, s100, v73
    v_dot2c_f32_bf16 v199, v73, v73
    v_dot2c_f32_bf16 v196, s100, v74
    v_dot2c_f32_bf16 v198, v74, v74
    v_dot2c_f32_bf16 v197, s100, v75
    v_dot2c_f32_bf16 v199, v75, v75
    s_waitcnt lgkmcnt(4)
    v_dot2c_f32_bf16 v196, s100, v76
    v_dot2c_f32_bf16 v198, v76, v76
    v_dot2c_f32_bf16 v197, s100, v77
    v_dot2c_f32_bf16 v199, v77, v77
    v_dot2c_f32_bf16 v196, s100, v78
    v_dot2c_f32_bf16 v198, v78, v78
    v_dot2c_f32_bf16 v197, s100, v79
    v_dot2c_f32_bf16 v199, v79, v79
    s_waitcnt vmcnt(8)
    ds_read_b128 v[96:99], v180 offset:6144
    ds_read_b128 v[100:103], v181 offset:6144
    ds_read_b128 v[104:107], v182 offset:6144
    ds_read_b128 v[108:111], v183 offset:6144
    s_waitcnt lgkmcnt(7)
    v_dot2c_f32_bf16 v196, s100, v80
    v_dot2c_f32_bf16 v198, v80, v80
    v_dot2c_f32_bf16 v197, s100, v81
    v_dot2c_f32_bf16 v199, v81, v81
    v_dot2c_f32_bf16 v196, s100, v82
    v_dot2c_f32_bf16 v198, v82, v82
    v_dot2c_f32_bf16 v197, s100, v83
    v_dot2c_f32_bf16 v199, v83, v83
    s_waitcnt lgkmcnt(6)
    v_dot2c_f32_bf16 v196, s100, v84
    v_dot2c_f32_bf16 v198, v84, v84
    v_dot2c_f32_bf16 v197, s100, v85
    v_dot2c_f32_bf16 v199, v85, v85
    v_dot2c_f32_bf16 v196, s100, v86
    v_dot2c_f32_bf16 v198, v86, v86
    v_dot2c_f32_bf16 v197, s100, v87
    v_dot2c_f32_bf16 v199, v87, v87
    s_waitcnt lgkmcnt(5)
    v_dot2c_f32_bf16 v196, s100, v88
    v_dot2c_f32_bf16 v198, v88, v88
    v_dot2c_f32_bf16 v197, s100, v89
    v_dot2c_f32_bf16 v199, v89, v89
    v_dot2c_f32_bf16 v196, s100, v90
    v_dot2c_f32_bf16 v198, v90, v90
    v_dot2c_f32_bf16 v197, s100, v91
    v_dot2c_f32_bf16 v199, v91, v91
    s_waitcnt lgkmcnt(4)
    v_dot2c_f32_bf16 v196, s100, v92
    v_dot2c_f32_bf16 v198, v92, v92
    v_dot2c_f32_bf16 v197, s100, v93
    v_dot2c_f32_bf16 v199, v93, v93
    v_dot2c_f32_bf16 v196, s100, v94
    v_dot2c_f32_bf16 v198, v94, v94
    v_dot2c_f32_bf16 v197, s100, v95
    v_dot2c_f32_bf16 v199, v95, v95
    s_waitcnt vmcnt(4)
    ds_read_b128 v[112:115], v180 offset:7168
    ds_read_b128 v[116:119], v181 offset:7168
    ds_read_b128 v[120:123], v182 offset:7168
    ds_read_b128 v[124:127], v183 offset:7168
    s_waitcnt lgkmcnt(7)
    v_dot2c_f32_bf16 v196, s100, v96
    v_dot2c_f32_bf16 v198, v96, v96
    v_dot2c_f32_bf16 v197, s100, v97
    v_dot2c_f32_bf16 v199, v97, v97
    v_dot2c_f32_bf16 v196, s100, v98
    v_dot2c_f32_bf16 v198, v98, v98
    v_dot2c_f32_bf16 v197, s100, v99
    v_dot2c_f32_bf16 v199, v99, v99
    s_waitcnt lgkmcnt(6)
    v_dot2c_f32_bf16 v196, s100, v100
    v_dot2c_f32_bf16 v198, v100, v100
    v_dot2c_f32_bf16 v197, s100, v101
    v_dot2c_f32_bf16 v199, v101, v101
    v_dot2c_f32_bf16 v196, s100, v102
    v_dot2c_f32_bf16 v198, v102, v102
    v_dot2c_f32_bf16 v197, s100, v103
    v_dot2c_f32_bf16 v199, v103, v103
    s_waitcnt lgkmcnt(5)
    v_dot2c_f32_bf16 v196, s100, v104
    v_dot2c_f32_bf16 v198, v104, v104
    v_dot2c_f32_bf16 v197, s100, v105
    v_dot2c_f32_bf16 v199, v105, v105
    v_dot2c_f32_bf16 v196, s100, v106
    v_dot2c_f32_bf16 v198, v106, v106
    v_dot2c_f32_bf16 v197, s100, v107
    v_dot2c_f32_bf16 v199, v107, v107
    s_waitcnt lgkmcnt(4)
    v_dot2c_f32_bf16 v196, s100, v108
    v_dot2c_f32_bf16 v198, v108, v108
    v_dot2c_f32_bf16 v197, s100, v109
    v_dot2c_f32_bf16 v199, v109, v109
    v_dot2c_f32_bf16 v196, s100, v110
    v_dot2c_f32_bf16 v198, v110, v110
    v_dot2c_f32_bf16 v197, s100, v111
    v_dot2c_f32_bf16 v199, v111, v111
    s_lshl_b32 s68, s20, 6
    v_add_u32 v163, s68, v253
    v_min_u32 v163, 179, v163
    v_mul_u32_u24 v165, 29128, v163
    v_lshrrev_b32 v165, 20, v165
    v_mul_u32_u24 v164, 36, v165
    v_sub_u32 v164, v163, v164
    v_lshlrev_b32 v163, 7, v165
    v_mul_u32_u24 v165, 9216, v164
    v_mul_u32_u24 v166, 1152, v164
    v_add_u32 v165, v165, v163
    v_add_u32 v166, v166, v163
    buffer_load_dword a253, v165, s[4:7], s51 offen
    v_accvgpr_write_b32 a61, v166
    buffer_load_dword v252, v251, s[16:19], s38 offen sc1
    s_lshl_b32 s40, s20, 8
    s_add_u32 s41, s40, 54919168
    s_lshl_b32 s40, s40, 2
    s_add_u32 s68, s40, 54923264
    s_lshl_b32 s40, s2, 2
    s_add_u32 s69, s40, 54919168
    v_lshlrev_b32 v163, 2, v253
    buffer_load_dword a251, v163, s[16:19], s41 offen sc1
    buffer_load_dword a252, v251, s[16:19], s69 offen sc1
    s_waitcnt vmcnt(4)
    ds_read_b128 v[128:131], v180 offset:8192
    ds_read_b128 v[132:135], v181 offset:8192
    ds_read_b128 v[136:139], v182 offset:8192
    ds_read_b128 v[140:143], v183 offset:8192
    s_waitcnt lgkmcnt(4)
    ds_read_b128 a[44:47], v236 offset:0
    ds_read_b128 a[48:51], v237 offset:0
    ds_read_b64_tr_b16 v[168:169], v194 offset:0
    ds_read_b64_tr_b16 v[170:171], v195 offset:0
    ds_read_b64_tr_b16 v[172:173], v194 offset:4096
    ds_read_b64_tr_b16 v[174:175], v195 offset:4096
    ds_read_b64_tr_b16 v[176:177], v194 offset:8192
    ds_read_b64_tr_b16 v[178:179], v195 offset:8192
    v_dot2c_f32_bf16 v196, s100, v112
    v_dot2c_f32_bf16 v198, v112, v112
    v_dot2c_f32_bf16 v197, s100, v113
    v_dot2c_f32_bf16 v199, v113, v113
    v_dot2c_f32_bf16 v196, s100, v114
    v_dot2c_f32_bf16 v198, v114, v114
    v_dot2c_f32_bf16 v197, s100, v115
    v_dot2c_f32_bf16 v199, v115, v115
    v_dot2c_f32_bf16 v196, s100, v116
    v_dot2c_f32_bf16 v198, v116, v116
    v_dot2c_f32_bf16 v197, s100, v117
    v_dot2c_f32_bf16 v199, v117, v117
    v_dot2c_f32_bf16 v196, s100, v118
    v_dot2c_f32_bf16 v198, v118, v118
    v_dot2c_f32_bf16 v197, s100, v119
    v_dot2c_f32_bf16 v199, v119, v119
    v_dot2c_f32_bf16 v196, s100, v120
    v_dot2c_f32_bf16 v198, v120, v120
    v_dot2c_f32_bf16 v197, s100, v121
    v_dot2c_f32_bf16 v199, v121, v121
    v_dot2c_f32_bf16 v196, s100, v122
    v_dot2c_f32_bf16 v198, v122, v122
    v_dot2c_f32_bf16 v197, s100, v123
    v_dot2c_f32_bf16 v199, v123, v123
    v_dot2c_f32_bf16 v196, s100, v124
    v_dot2c_f32_bf16 v198, v124, v124
    v_dot2c_f32_bf16 v197, s100, v125
    v_dot2c_f32_bf16 v199, v125, v125
    v_dot2c_f32_bf16 v196, s100, v126
    v_dot2c_f32_bf16 v198, v126, v126
    v_dot2c_f32_bf16 v197, s100, v127
    v_dot2c_f32_bf16 v199, v127, v127
    s_waitcnt lgkmcnt(0)
    s_barrier
    s_add_u32 m0, s30, 0
    s_add_u32 s32, s24, 0
    buffer_load_dwordx4 v243, s[4:7], s32 offen lds
    v_dot2c_f32_bf16 v196, s100, v128
    v_dot2c_f32_bf16 v198, v128, v128
    v_dot2c_f32_bf16 v197, s100, v129
    v_dot2c_f32_bf16 v199, v129, v129
    v_dot2c_f32_bf16 v196, s100, v130
    v_dot2c_f32_bf16 v198, v130, v130
    v_dot2c_f32_bf16 v197, s100, v131
    v_dot2c_f32_bf16 v199, v131, v131
    v_dot2c_f32_bf16 v196, s100, v132
    v_dot2c_f32_bf16 v198, v132, v132
    v_dot2c_f32_bf16 v197, s100, v133
    v_dot2c_f32_bf16 v199, v133, v133
    v_dot2c_f32_bf16 v196, s100, v134
    v_dot2c_f32_bf16 v198, v134, v134
    v_dot2c_f32_bf16 v197, s100, v135
    v_dot2c_f32_bf16 v199, v135, v135
    v_dot2c_f32_bf16 v196, s100, v136
    v_dot2c_f32_bf16 v198, v136, v136
    v_dot2c_f32_bf16 v197, s100, v137
    v_dot2c_f32_bf16 v199, v137, v137
    v_dot2c_f32_bf16 v196, s100, v138
    v_dot2c_f32_bf16 v198, v138, v138
    v_dot2c_f32_bf16 v197, s100, v139
    v_dot2c_f32_bf16 v199, v139, v139
    v_dot2c_f32_bf16 v196, s100, v140
    v_dot2c_f32_bf16 v198, v140, v140
    v_dot2c_f32_bf16 v197, s100, v141
    v_dot2c_f32_bf16 v199, v141, v141
    v_dot2c_f32_bf16 v196, s100, v142
    v_dot2c_f32_bf16 v198, v142, v142
    v_dot2c_f32_bf16 v197, s100, v143
    v_dot2c_f32_bf16 v199, v143, v143
    buffer_load_dwordx4 v244, s[4:7], s32 offen offset:1024 lds
    s_nop 1
    v_add_f32 v196, v196, v197
    v_add_f32 v198, v198, v199
    v_mov_b32 v197, v196
    v_mov_b32 v199, v198
    s_nop 1
    v_permlane32_swap_b32 v196, v197
    v_permlane32_swap_b32 v198, v199
    v_add_f32 v196, v196, v197
    v_add_f32 v198, v198, v199
    v_mul_f32 v196, 0x3ae38e39, v196
    v_mul_f32 v198, 0x3ae38e39, v198
    v_cvt_pk_bf16_f32 v163, v196, v196
    v_fma_f32 v198, -v196, v196, v198
    v_and_b32 v254, 0xffff0000, v163
    v_sub_f32 v200, 0, v254
    v_sub_f32 v201, 0, v254
    v_sub_f32 v202, 0, v254
    v_sub_f32 v203, 0, v254
    v_sub_f32 v204, 0, v254
    v_sub_f32 v205, 0, v254
    v_sub_f32 v206, 0, v254
    v_sub_f32 v207, 0, v254
    v_sub_f32 v208, 0, v254
    v_sub_f32 v209, 0, v254
    v_sub_f32 v210, 0, v254
    v_sub_f32 v211, 0, v254
    v_sub_f32 v212, 0, v254
    v_sub_f32 v213, 0, v254
    v_sub_f32 v214, 0, v254
    v_sub_f32 v215, 0, v254
    s_nop 1
    v_mfma_f32_32x32x16_bf16 v[144:159], v[184:187], v[0:3], v[200:215]
    buffer_load_dwordx4 v245, s[4:7], s32 offen offset:2048 lds
    v_max_f32 v198, 0, v198
    v_cvt_pk_bf16_f32 v163, v198, v198
    v_and_b32 v163, 0xffff0000, v163
    v_add_f32 v163, 0x3727c5ac, v163
    v_cvt_pk_bf16_f32 v163, v163, v163
    v_and_b32 v163, 0xffff0000, v163
    v_sqrt_f32 v163, v163
    v_mfma_f32_32x32x16_bf16 v[144:159], v[188:191], v[4:7], v[144:159]
    v_mfma_f32_32x32x16_bf16 v[216:231], v[184:187], v[8:11], v[200:215]
    buffer_load_dwordx4 v246, s[4:7], s32 offen offset:3072 lds
    s_nop 0
    v_cvt_pk_bf16_f32 v163, v163, v163
    v_and_b32 v249, 0xffff0000, v163
    v_rcp_f32 v255, v249
    s_nop 0
    v_mul_f32 v248, 0xbfb8aa3b, v255
    v_mul_f32 v254, v200, v255
    v_mfma_f32_32x32x16_bf16 v[216:231], v[188:191], v[12:15], v[216:231]
    s_nop 1
    v_cvt_pk_bf16_f32 v0, v144, v145
    v_cvt_pk_bf16_f32 v1, v146, v147
    v_cvt_pk_bf16_f32 v2, v148, v149
    v_cvt_pk_bf16_f32 v3, v150, v151
    v_cvt_pk_bf16_f32 v4, v152, v153
    v_cvt_pk_bf16_f32 v5, v154, v155
    v_cvt_pk_bf16_f32 v6, v156, v157
    v_cvt_pk_bf16_f32 v7, v158, v159
    v_mfma_f32_32x32x16_bf16 v[144:159], v[184:187], v[16:19], v[200:215]
    s_add_u32 m0, s31, 0
    s_cbranch_vccz L_x_1
    buffer_load_dwordx4 v247, s[4:7], s32 offen lds
L_x_1:
    v_mov_b32 v232, v255
    v_mov_b32 v233, v254
    ds_write_b64 v192, v[232:233]
    v_mfma_f32_32x32x16_bf16 v[144:159], v[188:191], v[20:23], v[144:159]
    s_nop 0
    v_cvt_pk_bf16_f32 v8, v216, v217
    v_cvt_pk_bf16_f32 v9, v218, v219
    v_cvt_pk_bf16_f32 v10, v220, v221
    v_cvt_pk_bf16_f32 v11, v222, v223
    v_cvt_pk_bf16_f32 v12, v224, v225
    v_cvt_pk_bf16_f32 v13, v226, v227
    v_cvt_pk_bf16_f32 v14, v228, v229
    v_cvt_pk_bf16_f32 v15, v230, v231
    v_mfma_f32_32x32x16_bf16 v[216:231], v[184:187], v[24:27], v[200:215]
    s_add_u32 m0, s30, 18432
    s_add_u32 s32, s24, 1327104
    buffer_load_dwordx4 v243, s[4:7], s32 offen lds
    s_lshl_b32 s92, s2, 2
    s_add_u32 s92, s92, s20
    s_mul_i32 s93, s92, 18432
    v_mfma_f32_32x32x16_bf16 v[216:231], v[188:191], v[28:31], v[216:231]
    s_nop 0
    v_cvt_pk_bf16_f32 v16, v144, v145
    v_cvt_pk_bf16_f32 v17, v146, v147
    v_cvt_pk_bf16_f32 v18, v148, v149
    v_cvt_pk_bf16_f32 v19, v150, v151
    v_cvt_pk_bf16_f32 v20, v152, v153
    v_cvt_pk_bf16_f32 v21, v154, v155
    v_cvt_pk_bf16_f32 v22, v156, v157
    v_cvt_pk_bf16_f32 v23, v158, v159
    v_mfma_f32_32x32x16_bf16 v[144:159], v[184:187], v[32:35], v[200:215]
    buffer_load_dwordx4 v244, s[4:7], s32 offen offset:1024 lds
    s_add_u32 s34, s93, 25165824
    s_xor_b32 s92, s92, 32
    s_mul_i32 s93, s92, 18432
    v_mfma_f32_32x32x16_bf16 v[144:159], v[188:191], v[36:39], v[144:159]
    s_nop 0
    v_cvt_pk_bf16_f32 v24, v216, v217
    v_cvt_pk_bf16_f32 v25, v218, v219
    v_cvt_pk_bf16_f32 v26, v220, v221
    v_cvt_pk_bf16_f32 v27, v222, v223
    v_cvt_pk_bf16_f32 v28, v224, v225
    v_cvt_pk_bf16_f32 v29, v226, v227
    v_cvt_pk_bf16_f32 v30, v228, v229
    v_cvt_pk_bf16_f32 v31, v230, v231
    v_mfma_f32_32x32x16_bf16 v[216:231], v[184:187], v[40:43], v[200:215]
    buffer_load_dwordx4 v245, s[4:7], s32 offen offset:2048 lds
    s_add_u32 s36, s93, 25165824
    s_mul_i32 s94, s23, 576
    s_sub_u32 s94, 512, s94
    v_mfma_f32_32x32x16_bf16 v[216:231], v[188:191], v[44:47], v[216:231]
    s_nop 0
    v_cvt_pk_bf16_f32 v32, v144, v145
    v_cvt_pk_bf16_f32 v33, v146, v147
    v_cvt_pk_bf16_f32 v34, v148, v149
    v_cvt_pk_bf16_f32 v35, v150, v151
    v_cvt_pk_bf16_f32 v36, v152, v153
    v_cvt_pk_bf16_f32 v37, v154, v155
    v_cvt_pk_bf16_f32 v38, v156, v157
    v_cvt_pk_bf16_f32 v39, v158, v159
    v_mfma_f32_32x32x16_bf16 v[144:159], v[184:187], v[48:51], v[200:215]
    buffer_load_dwordx4 v246, s[4:7], s32 offen offset:3072 lds
    v_accvgpr_write_b32 a42, v161
    v_lshrrev_b32 v162, 2, v253
    v_and_b32 v164, 48, v250
    v_mfma_f32_32x32x16_bf16 v[144:159], v[188:191], v[52:55], v[144:159]
    s_nop 0
    v_cvt_pk_bf16_f32 v40, v216, v217
    v_cvt_pk_bf16_f32 v41, v218, v219
    v_cvt_pk_bf16_f32 v42, v220, v221
    v_cvt_pk_bf16_f32 v43, v222, v223
    v_cvt_pk_bf16_f32 v44, v224, v225
    v_cvt_pk_bf16_f32 v45, v226, v227
    v_cvt_pk_bf16_f32 v46, v228, v229
    v_cvt_pk_bf16_f32 v47, v230, v231
    v_mfma_f32_32x32x16_bf16 v[216:231], v[184:187], v[56:59], v[200:215]
    s_add_u32 m0, s31, 18432
    s_cbranch_vccnz L_x_2
    buffer_load_dwordx4 v247, s[4:7], s32 offen lds
L_x_2:
    v_mul_u32_u24 v165, 1152, v162
    v_mul_u32_u24 v162, 9216, v162
    v_add_u32 v165, v165, v164
    v_mfma_f32_32x32x16_bf16 v[216:231], v[188:191], v[60:63], v[216:231]
    s_nop 0
    v_cvt_pk_bf16_f32 v48, v144, v145
    v_cvt_pk_bf16_f32 v49, v146, v147
    v_cvt_pk_bf16_f32 v50, v148, v149
    v_cvt_pk_bf16_f32 v51, v150, v151
    v_cvt_pk_bf16_f32 v52, v152, v153
    v_cvt_pk_bf16_f32 v53, v154, v155
    v_cvt_pk_bf16_f32 v54, v156, v157
    v_cvt_pk_bf16_f32 v55, v158, v159
    v_mfma_f32_32x32x16_bf16 v[144:159], v[184:187], v[64:67], v[200:215]
    s_add_u32 m0, s30, 36864
    s_add_u32 s32, s24, 2654208
    buffer_load_dwordx4 v243, s[4:7], s32 offen lds
    v_add_u32 v162, v162, v164
    v_accvgpr_write_b32 a43, v165
    s_mul_i32 s93, s49, 18432
    v_mfma_f32_32x32x16_bf16 v[144:159], v[188:191], v[68:71], v[144:159]
    s_nop 0
    v_cvt_pk_bf16_f32 v56, v216, v217
    v_cvt_pk_bf16_f32 v57, v218, v219
    v_cvt_pk_bf16_f32 v58, v220, v221
    v_cvt_pk_bf16_f32 v59, v222, v223
    v_cvt_pk_bf16_f32 v60, v224, v225
    v_cvt_pk_bf16_f32 v61, v226, v227
    v_cvt_pk_bf16_f32 v62, v228, v229
    v_cvt_pk_bf16_f32 v63, v230, v231
    v_mfma_f32_32x32x16_bf16 v[216:231], v[184:187], v[72:75], v[200:215]
    buffer_load_dwordx4 v244, s[4:7], s32 offen offset:1024 lds
    s_add_u32 s93, s93, s94
    s_add_u32 s93, s93, 4096
    v_add_u32 v164, s93, v165
    v_mfma_f32_32x32x16_bf16 v[216:231], v[188:191], v[76:79], v[216:231]
    s_nop 0
    v_cvt_pk_bf16_f32 v64, v144, v145
    v_cvt_pk_bf16_f32 v65, v146, v147
    v_cvt_pk_bf16_f32 v66, v148, v149
    v_cvt_pk_bf16_f32 v67, v150, v151
    v_cvt_pk_bf16_f32 v68, v152, v153
    v_cvt_pk_bf16_f32 v69, v154, v155
    v_cvt_pk_bf16_f32 v70, v156, v157
    v_cvt_pk_bf16_f32 v71, v158, v159
    v_mfma_f32_32x32x16_bf16 v[144:159], v[184:187], v[80:83], v[200:215]
    buffer_load_dwordx4 v245, s[4:7], s32 offen offset:2048 lds
    v_accvgpr_write_b32 a41, v164
    s_mul_i32 s92, s20, 9216
    s_add_u32 s93, s92, 4096
    v_mfma_f32_32x32x16_bf16 v[144:159], v[188:191], v[84:87], v[144:159]
    s_nop 0
    v_cvt_pk_bf16_f32 v72, v216, v217
    v_cvt_pk_bf16_f32 v73, v218, v219
    v_cvt_pk_bf16_f32 v74, v220, v221
    v_cvt_pk_bf16_f32 v75, v222, v223
    v_cvt_pk_bf16_f32 v76, v224, v225
    v_cvt_pk_bf16_f32 v77, v226, v227
    v_cvt_pk_bf16_f32 v78, v228, v229
    v_cvt_pk_bf16_f32 v79, v230, v231
    v_mfma_f32_32x32x16_bf16 v[216:231], v[184:187], v[88:91], v[200:215]
    buffer_load_dwordx4 v246, s[4:7], s32 offen offset:3072 lds
    v_add_u32 v164, s93, v161
    v_accvgpr_write_b32 a37, v164
    s_add_u32 s93, s92, 3200
    v_mfma_f32_32x32x16_bf16 v[216:231], v[188:191], v[92:95], v[216:231]
    s_nop 0
    v_cvt_pk_bf16_f32 v80, v144, v145
    v_cvt_pk_bf16_f32 v81, v146, v147
    v_cvt_pk_bf16_f32 v82, v148, v149
    v_cvt_pk_bf16_f32 v83, v150, v151
    v_cvt_pk_bf16_f32 v84, v152, v153
    v_cvt_pk_bf16_f32 v85, v154, v155
    v_cvt_pk_bf16_f32 v86, v156, v157
    v_cvt_pk_bf16_f32 v87, v158, v159
    v_mfma_f32_32x32x16_bf16 v[144:159], v[184:187], v[96:99], v[200:215]
    s_add_u32 m0, s31, 36864
    s_cbranch_vccz L_x_3
    buffer_load_dwordx4 v247, s[4:7], s32 offen lds
L_x_3:
    v_add_u32 v164, s93, v161
    v_accvgpr_write_b32 a38, v164
    s_add_u32 s93, s92, 2304
    v_mfma_f32_32x32x16_bf16 v[144:159], v[188:191], v[100:103], v[144:159]
    s_nop 0
    v_cvt_pk_bf16_f32 v88, v216, v217
    v_cvt_pk_bf16_f32 v89, v218, v219
    v_cvt_pk_bf16_f32 v90, v220, v221
    v_cvt_pk_bf16_f32 v91, v222, v223
    v_cvt_pk_bf16_f32 v92, v224, v225
    v_cvt_pk_bf16_f32 v93, v226, v227
    v_cvt_pk_bf16_f32 v94, v228, v229
    v_cvt_pk_bf16_f32 v95, v230, v231
    v_mfma_f32_32x32x16_bf16 v[216:231], v[184:187], v[104:107], v[200:215]
    s_add_u32 m0, s30, 55296
    s_add_u32 s32, s24, 3981312
    buffer_load_dwordx4 v243, s[4:7], s32 offen lds
    v_add_u32 v164, s93, v161
    v_accvgpr_write_b32 a39, v164
    s_add_u32 s93, s92, 1408
    v_mfma_f32_32x32x16_bf16 v[216:231], v[188:191], v[108:111], v[216:231]
    s_nop 0
    v_cvt_pk_bf16_f32 v96, v144, v145
    v_cvt_pk_bf16_f32 v97, v146, v147
    v_cvt_pk_bf16_f32 v98, v148, v149
    v_cvt_pk_bf16_f32 v99, v150, v151
    v_cvt_pk_bf16_f32 v100, v152, v153
    v_cvt_pk_bf16_f32 v101, v154, v155
    v_cvt_pk_bf16_f32 v102, v156, v157
    v_cvt_pk_bf16_f32 v103, v158, v159
    v_mfma_f32_32x32x16_bf16 v[144:159], v[184:187], v[112:115], v[200:215]
    buffer_load_dwordx4 v244, s[4:7], s32 offen offset:1024 lds
    v_add_u32 v164, s93, v161
    v_accvgpr_write_b32 a40, v164
    s_mul_i32 s92, s20, 589824
    v_mfma_f32_32x32x16_bf16 v[144:159], v[188:191], v[116:119], v[144:159]
    s_nop 0
    v_cvt_pk_bf16_f32 v104, v216, v217
    v_cvt_pk_bf16_f32 v105, v218, v219
    v_cvt_pk_bf16_f32 v106, v220, v221
    v_cvt_pk_bf16_f32 v107, v222, v223
    v_cvt_pk_bf16_f32 v108, v224, v225
    v_cvt_pk_bf16_f32 v109, v226, v227
    v_cvt_pk_bf16_f32 v110, v228, v229
    v_cvt_pk_bf16_f32 v111, v230, v231
    v_mfma_f32_32x32x16_bf16 v[216:231], v[184:187], v[120:123], v[200:215]
    buffer_load_dwordx4 v245, s[4:7], s32 offen offset:2048 lds
    s_add_u32 s93, s92, 0
    v_add_u32 v164, s93, v162
    v_accvgpr_write_b32 a32, v164
    v_mfma_f32_32x32x16_bf16 v[216:231], v[188:191], v[124:127], v[216:231]
    s_nop 0
    v_cvt_pk_bf16_f32 v232, v144, v145
    v_accvgpr_write_b32 a0, v232
    v_cvt_pk_bf16_f32 v233, v146, v147
    v_accvgpr_write_b32 a1, v233
    v_cvt_pk_bf16_f32 v234, v148, v149
    v_accvgpr_write_b32 a2, v234
    v_cvt_pk_bf16_f32 v235, v150, v151
    v_accvgpr_write_b32 a3, v235
    v_cvt_pk_bf16_f32 v236, v152, v153
    v_accvgpr_write_b32 a4, v236
    v_cvt_pk_bf16_f32 v237, v154, v155
    v_accvgpr_write_b32 a5, v237
    v_cvt_pk_bf16_f32 v238, v156, v157
    v_accvgpr_write_b32 a6, v238
    v_cvt_pk_bf16_f32 v239, v158, v159
    v_accvgpr_write_b32 a7, v239
    v_mfma_f32_32x32x16_bf16 v[144:159], v[184:187], v[128:131], v[200:215]
    buffer_load_dwordx4 v246, s[4:7], s32 offen offset:3072 lds
    s_add_u32 s93, s92, 146432
    v_add_u32 v164, s93, v162
    v_accvgpr_write_b32 a33, v164
    v_mfma_f32_32x32x16_bf16 v[144:159], v[188:191], v[132:135], v[144:159]
    s_nop 0
    v_cvt_pk_bf16_f32 v232, v216, v217
    v_accvgpr_write_b32 a8, v232
    v_cvt_pk_bf16_f32 v233, v218, v219
    v_accvgpr_write_b32 a9, v233
    v_cvt_pk_bf16_f32 v234, v220, v221
    v_accvgpr_write_b32 a10, v234
    v_cvt_pk_bf16_f32 v235, v222, v223
    v_accvgpr_write_b32 a11, v235
    v_cvt_pk_bf16_f32 v236, v224, v225
    v_accvgpr_write_b32 a12, v236
    v_cvt_pk_bf16_f32 v237, v226, v227
    v_accvgpr_write_b32 a13, v237
    v_cvt_pk_bf16_f32 v238, v228, v229
    v_accvgpr_write_b32 a14, v238
    v_cvt_pk_bf16_f32 v239, v230, v231
    v_accvgpr_write_b32 a15, v239
    v_mfma_f32_32x32x16_bf16 v[216:231], v[184:187], v[136:139], v[200:215]
    s_add_u32 m0, s31, 55296
    s_cbranch_vccnz L_x_4
    buffer_load_dwordx4 v247, s[4:7], s32 offen lds
L_x_4:
    s_add_u32 s93, s92, 292864
    v_add_u32 v164, s93, v162
    v_accvgpr_write_b32 a34, v164
    v_mfma_f32_32x32x16_bf16 v[216:231], v[188:191], v[140:143], v[216:231]
    s_nop 0
    v_cvt_pk_bf16_f32 v232, v144, v145
    v_accvgpr_write_b32 a16, v232
    v_cvt_pk_bf16_f32 v233, v146, v147
    v_accvgpr_write_b32 a17, v233
    v_cvt_pk_bf16_f32 v234, v148, v149
    v_accvgpr_write_b32 a18, v234
    v_cvt_pk_bf16_f32 v235, v150, v151
    v_accvgpr_write_b32 a19, v235
    v_cvt_pk_bf16_f32 v236, v152, v153
    v_accvgpr_write_b32 a20, v236
    v_cvt_pk_bf16_f32 v237, v154, v155
    v_accvgpr_write_b32 a21, v237
    v_cvt_pk_bf16_f32 v238, v156, v157
    v_accvgpr_write_b32 a22, v238
    v_cvt_pk_bf16_f32 v239, v158, v159
    v_accvgpr_write_b32 a23, v239
    s_nop 3
    s_nop 0
    v_cvt_pk_bf16_f32 v232, v216, v217
    v_accvgpr_write_b32 a24, v232
    v_cvt_pk_bf16_f32 v233, v218, v219
    v_accvgpr_write_b32 a25, v233
    v_cvt_pk_bf16_f32 v234, v220, v221
    v_accvgpr_write_b32 a26, v234
    v_cvt_pk_bf16_f32 v235, v222, v223
    v_accvgpr_write_b32 a27, v235
    v_cvt_pk_bf16_f32 v236, v224, v225
    v_accvgpr_write_b32 a28, v236
    v_cvt_pk_bf16_f32 v237, v226, v227
    v_accvgpr_write_b32 a29, v237
    v_cvt_pk_bf16_f32 v238, v228, v229
    v_accvgpr_write_b32 a30, v238
    v_cvt_pk_bf16_f32 v239, v230, v231
    v_accvgpr_write_b32 a31, v239
    s_waitcnt lgkmcnt(0)
    ds_read_b128 v[200:203], v193 offset:0
    ds_read_b128 v[204:207], v193 offset:16
    ds_read_b128 v[208:211], v193 offset:32
    ds_read_b128 v[212:215], v193 offset:48
    s_mov_b32 s50, 0x9e3779b1
    s_waitcnt vmcnt(9)
    s_barrier
    ds_read_b64_tr_b16 a[64:65], v240 offset:0
    ds_read_b64_tr_b16 a[66:67], v240 offset:512
    s_waitcnt lgkmcnt(2)
    ds_read_b64_tr_b16 a[68:69], v240 offset:2048
    ds_read_b64_tr_b16 a[70:71], v240 offset:2560
    ds_read_b64_tr_b16 a[72:73], v240 offset:4096
    ds_read_b64_tr_b16 a[74:75], v240 offset:4608
    ds_read_b64_tr_b16 a[76:77], v240 offset:6144
    ds_read_b64_tr_b16 a[78:79], v240 offset:6656
    ds_read_b64_tr_b16 a[80:81], v240 offset:8192
    ds_read_b64_tr_b16 a[82:83], v240 offset:8704
    ds_read_b64_tr_b16 a[84:85], v240 offset:10240
    ds_read_b64_tr_b16 a[86:87], v240 offset:10752
    s_waitcnt lgkmcnt(6)
    v_mfma_f32_32x32x16_bf16 v[128:143], a[64:67], v[0:3], 0
    ds_read_b64_tr_b16 a[88:89], v240 offset:12288
    ds_read_b64_tr_b16 a[90:91], v240 offset:12800
    s_add_u32 m0, s30, 73728
    s_add_u32 s32, s24, 128
    buffer_load_dwordx4 v243, s[4:7], s32 offen lds
    v_lshlrev_b32 v232, 16, v168
    v_mfma_f32_32x32x16_bf16 v[128:143], a[68:71], v[4:7], v[128:143]
    ds_read_b64_tr_b16 a[92:93], v240 offset:14336
    ds_read_b64_tr_b16 a[94:95], v240 offset:14848
    buffer_load_dwordx4 v244, s[4:7], s32 offen offset:1024 lds
    s_add_u32 s93, s92, 439296
    v_and_b32 v233, 0xffff0000, v168
    v_add_u32 v164, s93, v162
    v_lshlrev_b32 v234, 16, v169
    v_mfma_f32_32x32x16_bf16 v[128:143], a[72:75], v[8:11], v[128:143]
    ds_read_b64_tr_b16 a[64:65], v240 offset:16384
    ds_read_b64_tr_b16 a[66:67], v240 offset:16896
    v_and_b32 v235, 0xffff0000, v169
    v_accvgpr_write_b32 a35, v164
    v_lshlrev_b32 v236, 16, v170
    s_waitcnt lgkmcnt(6)
    v_mfma_f32_32x32x16_bf16 v[128:143], a[76:79], v[12:15], v[128:143]
    ds_read_b64_tr_b16 a[68:69], v240 offset:18432
    ds_read_b64_tr_b16 a[70:71], v240 offset:18944
    buffer_load_dwordx4 v245, s[4:7], s32 offen offset:2048 lds
    v_and_b32 v237, 0xffff0000, v170
    s_mul_i32 s93, s49, 147456
    v_lshlrev_b32 v238, 16, v171
    v_mfma_f32_32x32x16_bf16 v[128:143], a[80:83], v[16:19], v[128:143]
    ds_read_b64_tr_b16 a[72:73], v240 offset:20480
    ds_read_b64_tr_b16 a[74:75], v240 offset:20992
    buffer_load_dwordx4 v246, s[4:7], s32 offen offset:3072 lds
    v_and_b32 v239, 0xffff0000, v171
    s_add_u32 s93, s93, 2359296
    v_fma_f32 v232, v232, v200, v201
    v_fma_f32 v233, v233, v202, v203
    v_mfma_f32_32x32x16_bf16 v[128:143], a[84:87], v[20:23], v[128:143]
    ds_read_b64_tr_b16 a[76:77], v240 offset:22528
    ds_read_b64_tr_b16 a[78:79], v240 offset:23040
    v_add_u32 v164, s93, v162
    v_fma_f32 v234, v234, v204, v205
    v_fma_f32 v235, v235, v206, v207
    s_waitcnt lgkmcnt(6)
    v_mfma_f32_32x32x16_bf16 v[128:143], a[88:91], v[24:27], v[128:143]
    ds_read_b64_tr_b16 a[80:81], v240 offset:24576
    ds_read_b64_tr_b16 a[82:83], v240 offset:25088
    s_add_u32 m0, s31, 73728
    s_cbranch_vccz L_x_5
    buffer_load_dwordx4 v247, s[4:7], s32 offen lds
L_x_5:
    v_accvgpr_write_b32 a36, v164
    v_fma_f32 v236, v236, v208, v209
    v_mfma_f32_32x32x16_bf16 v[128:143], a[92:95], v[28:31], v[128:143]
    ds_read_b64_tr_b16 a[84:85], v240 offset:26624
    ds_read_b64_tr_b16 a[86:87], v240 offset:27136
    v_fma_f32 v237, v237, v210, v211
    s_lshl_b32 s92, s23, 2
    v_fma_f32 v238, v238, v212, v213
    v_fma_f32 v239, v239, v214, v215
    v_mfma_f32_32x32x16_bf16 v[128:143], a[64:67], v[32:35], v[128:143]
    ds_read_b64_tr_b16 a[88:89], v240 offset:28672
    ds_read_b64_tr_b16 a[90:91], v240 offset:29184
    s_add_u32 m0, s30, 92160
    s_add_u32 s32, s24, 1327232
    buffer_load_dwordx4 v243, s[4:7], s32 offen lds
    s_waitcnt lgkmcnt(6)
    v_mfma_f32_32x32x16_bf16 v[128:143], a[68:71], v[36:39], v[128:143]
    ds_read_b64_tr_b16 a[92:93], v240 offset:30720
    ds_read_b64_tr_b16 a[94:95], v240 offset:31232
    s_add_u32 s74, s38, s92
    v_cvt_pk_bf16_f32 v168, v232, v233
    s_sub_u32 s75, s38, s92
    v_cvt_pk_bf16_f32 v169, v234, v235
    v_cvt_pk_bf16_f32 v170, v236, v237
    v_mfma_f32_32x32x16_bf16 v[128:143], a[72:75], v[40:43], v[128:143]
    ds_read_b64_tr_b16 a[64:65], v240 offset:32768
    ds_read_b64_tr_b16 a[66:67], v240 offset:33280
    buffer_load_dwordx4 v244, s[4:7], s32 offen offset:1024 lds
    s_add_u32 s25, s24, s94
    v_cvt_pk_bf16_f32 v171, v238, v239
    buffer_store_dwordx4 v[168:171], v167, s[16:19], s33 offen sc1
    v_mfma_f32_32x32x16_bf16 v[128:143], a[76:79], v[44:47], v[128:143]
    ds_read_b64_tr_b16 a[68:69], v240 offset:34816
    ds_read_b64_tr_b16 a[70:71], v240 offset:35328
    s_mul_i32 s92, s22, 663552
    v_lshlrev_b32 v232, 16, v172
    s_waitcnt vmcnt(7) lgkmcnt(6)
    v_mfma_f32_32x32x16_bf16 v[128:143], a[80:83], v[48:51], v[128:143]
    s_barrier
    ds_read_b64_tr_b16 a[72:73], v240 offset:36864
    ds_read_b64_tr_b16 a[74:75], v240 offset:37376
    buffer_load_dwordx4 v245, s[4:7], s32 offen offset:2048 lds
    v_and_b32 v233, 0xffff0000, v172
    s_mul_i32 s93, s23, 640
    v_lshlrev_b32 v234, 16, v173
    v_mfma_f32_32x32x16_bf16 v[128:143], a[84:87], v[52:55], v[128:143]
    ds_read_b64_tr_b16 a[76:77], v240 offset:38912
    ds_read_b64_tr_b16 a[78:79], v240 offset:39424
    buffer_load_dwordx4 v246, s[4:7], s32 offen offset:3072 lds
    v_and_b32 v235, 0xffff0000, v173
    s_add_u32 s92, s92, s93
    v_lshlrev_b32 v236, 16, v174
    v_mfma_f32_32x32x16_bf16 v[128:143], a[88:91], v[56:59], v[128:143]
    ds_read_b64_tr_b16 a[80:81], v240 offset:40960
    ds_read_b64_tr_b16 a[82:83], v240 offset:41472
    v_and_b32 v237, 0xffff0000, v174
    s_mul_i32 s93, s23, 368640
    v_lshlrev_b32 v238, 16, v175
    v_and_b32 v239, 0xffff0000, v175
    s_waitcnt lgkmcnt(6)
    v_mfma_f32_32x32x16_bf16 v[128:143], a[92:95], v[60:63], v[128:143]
    ds_read_b64_tr_b16 a[84:85], v240 offset:43008
    ds_read_b64_tr_b16 a[86:87], v240 offset:43520
    s_add_u32 m0, s31, 92160
    s_cbranch_vccnz L_x_6
    buffer_load_dwordx4 v247, s[4:7], s32 offen lds
L_x_6:
    s_add_u32 s26, s92, s93
    v_mfma_f32_32x32x16_bf16 v[128:143], a[64:67], v[64:67], v[128:143]
    ds_read_b64_tr_b16 a[88:89], v240 offset:45056
    ds_read_b64_tr_b16 a[90:91], v240 offset:45568
    v_fma_f32 v232, v232, v200, v201
    v_fma_f32 v233, v233, v202, v203
    s_sub_u32 s93, 368640, s93
    v_fma_f32 v234, v234, v204, v205
    v_mfma_f32_32x32x16_bf16 v[128:143], a[68:71], v[68:71], v[128:143]
    ds_read_b64_tr_b16 a[92:93], v240 offset:47104
    ds_read_b64_tr_b16 a[94:95], v240 offset:47616
    s_add_u32 s28, s92, s93
    v_fma_f32 v235, v235, v206, v207
    v_fma_f32 v236, v236, v208, v209
    s_mul_i32 s93, s23, 36864
    s_waitcnt lgkmcnt(6)
    v_mfma_f32_32x32x16_bf16 v[128:143], a[72:75], v[72:75], v[128:143]
    ds_read_b64_tr_b16 a[64:65], v240 offset:49152
    ds_read_b64_tr_b16 a[66:67], v240 offset:49664
    s_add_u32 m0, s30, 110592
    s_add_u32 s32, s24, 2654336
    buffer_load_dwordx4 v243, s[4:7], s32 offen lds
    v_fma_f32 v237, v237, v210, v211
    v_mfma_f32_32x32x16_bf16 v[128:143], a[76:79], v[76:79], v[128:143]
    ds_read_b64_tr_b16 a[68:69], v240 offset:51200
    ds_read_b64_tr_b16 a[70:71], v240 offset:51712
    buffer_load_dwordx4 v244, s[4:7], s32 offen offset:1024 lds
    v_fma_f32 v238, v238, v212, v213
    s_add_u32 s93, s93, s92
    v_fma_f32 v239, v239, v214, v215
    v_mfma_f32_32x32x16_bf16 v[128:143], a[80:83], v[80:83], v[128:143]
    ds_read_b64_tr_b16 a[72:73], v240 offset:53248
    ds_read_b64_tr_b16 a[74:75], v240 offset:53760
    v_cvt_pk_bf16_f32 v172, v232, v233
    s_add_u32 s27, s93, 294912
    v_cvt_pk_bf16_f32 v173, v234, v235
    v_cvt_pk_bf16_f32 v174, v236, v237
    s_waitcnt lgkmcnt(6)
    v_mfma_f32_32x32x16_bf16 v[128:143], a[84:87], v[84:87], v[128:143]
    ds_read_b64_tr_b16 a[76:77], v240 offset:55296
    ds_read_b64_tr_b16 a[78:79], v240 offset:55808
    buffer_load_dwordx4 v245, s[4:7], s32 offen offset:2048 lds
    s_mul_i32 s93, s23, 331776
    v_cvt_pk_bf16_f32 v175, v238, v239
    s_add_u32 s33, s33, 2097152
    buffer_store_dwordx4 v[172:175], v167, s[16:19], s33 offen sc1
    v_mfma_f32_32x32x16_bf16 v[128:143], a[88:91], v[88:91], v[128:143]
    ds_read_b64_tr_b16 a[80:81], v240 offset:57344
    ds_read_b64_tr_b16 a[82:83], v240 offset:57856
    buffer_load_dwordx4 v246, s[4:7], s32 offen offset:3072 lds
    s_sub_u32 s99, 331776, s93
    v_mfma_f32_32x32x16_bf16 v[128:143], a[92:95], v[92:95], v[128:143]
    ds_read_b64_tr_b16 a[84:85], v240 offset:59392
    ds_read_b64_tr_b16 a[86:87], v240 offset:59904
    s_cmp_lt_u32 s39, 4
    s_cbranch_scc0 L_g3_7
    v_lshlrev_b32 v232, 16, v176
    v_and_b32 v233, 0xffff0000, v176
    v_lshlrev_b32 v234, 16, v177
    v_and_b32 v235, 0xffff0000, v177
    v_lshlrev_b32 v236, 16, v178
    v_and_b32 v237, 0xffff0000, v178
    v_lshlrev_b32 v238, 16, v179
    v_and_b32 v239, 0xffff0000, v179
    v_fma_f32 v232, v232, v200, v201
    v_fma_f32 v233, v233, v202, v203
    v_fma_f32 v234, v234, v204, v205
    v_fma_f32 v235, v235, v206, v207
    v_fma_f32 v236, v236, v208, v209
    v_fma_f32 v237, v237, v210, v211
    v_fma_f32 v238, v238, v212, v213
    v_fma_f32 v239, v239, v214, v215
    v_cvt_pk_bf16_f32 v176, v232, v233
    v_cvt_pk_bf16_f32 v177, v234, v235
    v_cvt_pk_bf16_f32 v178, v236, v237
    v_cvt_pk_bf16_f32 v179, v238, v239
    s_add_u32 s33, s33, 2097152
    buffer_store_dwordx4 v[176:179], v167, s[16:19], s33 offen sc1
L_g3_7:
    s_lshl_b32 s40, s70, 3
    s_sub_u32 s35, s28, s99
    s_waitcnt lgkmcnt(6)
    v_mfma_f32_32x32x16_bf16 v[128:143], a[64:67], v[96:99], v[128:143]
    ds_read_b64_tr_b16 a[88:89], v240 offset:61440
    ds_read_b64_tr_b16 a[90:91], v240 offset:61952
    s_add_u32 m0, s31, 110592
    s_cbranch_vccz L_x_8
    buffer_load_dwordx4 v247, s[4:7], s32 offen lds
L_x_8:
    s_add_u32 s40, s40, s22
    v_mfma_f32_32x32x16_bf16 v[128:143], a[68:71], v[100:103], v[128:143]
    ds_read_b64_tr_b16 a[92:93], v240 offset:63488
    ds_read_b64_tr_b16 a[94:95], v240 offset:64000
    s_lshl_b32 s41, s40, 14
    s_add_u32 s29, s35, s94
    s_lshl_b32 s42, s20, 11
    s_mul_i32 s92, s70, 786432
    s_add_u32 s41, s41, s42
    v_mfma_f32_32x32x16_bf16 v[128:143], a[72:75], v[104:107], v[128:143]
    v_add_u32 v240, 55296, v240
    ds_read_b64_tr_b16 a[64:65], v240 offset:10240
    ds_read_b64_tr_b16 a[66:67], v240 offset:10752
    s_add_u32 m0, s30, 129024
    s_add_u32 s32, s24, 3981440
    buffer_load_dwordx4 v243, s[4:7], s32 offen lds
    s_waitcnt lgkmcnt(6)
    v_mfma_f32_32x32x16_bf16 v[128:143], a[76:79], v[108:111], v[128:143]
    ds_read_b64_tr_b16 a[68:69], v240 offset:12288
    ds_read_b64_tr_b16 a[70:71], v240 offset:12800
    s_add_u32 s41, s41, 50331648
    s_mul_i32 s93, s22, 12288
    v_mov_b32 v236, -1
    v_mov_b32 v237, -1
    v_mfma_f32_32x32x16_bf16 v[128:143], a[80:83], a[0:3], v[128:143]
    ds_read_b64_tr_b16 a[72:73], v240 offset:14336
    ds_read_b64_tr_b16 a[74:75], v240 offset:14848
    buffer_load_dwordx4 v244, s[4:7], s32 offen offset:1024 lds
    s_add_u32 s92, s92, s93
    v_mov_b32 v238, -1
    v_mov_b32 v239, -1
    s_lshl_b32 s93, s20, 11
    v_mfma_f32_32x32x16_bf16 v[128:143], a[84:87], a[4:7], v[128:143]
    ds_read_b64_tr_b16 a[76:77], v240 offset:16384
    ds_read_b64_tr_b16 a[78:79], v240 offset:16896
    buffer_store_dwordx4 v[236:239], v250, s[16:19], s41 offen sc1
    buffer_store_dwordx4 v[236:239], v250, s[16:19], s41 offen offset:1024 sc1
    s_add_u32 s37, s92, s93
    s_waitcnt lgkmcnt(6)
    v_mfma_f32_32x32x16_bf16 v[128:143], a[88:91], a[8:11], v[128:143]
    ds_read_b64_tr_b16 a[80:81], v241 offset:0
    ds_read_b64_tr_b16 a[82:83], v241 offset:512
    buffer_load_dwordx4 v245, s[4:7], s32 offen offset:2048 lds
    v_mov_b32 v232, 0
    v_mov_b32 v233, 0
    s_lshl_b32 s93, s20, 10
    v_mfma_f32_32x32x16_bf16 v[128:143], a[92:95], a[12:15], v[128:143]
    ds_read_b64_tr_b16 a[84:85], v241 offset:2048
    ds_read_b64_tr_b16 a[86:87], v241 offset:2560
    buffer_load_dwordx4 v246, s[4:7], s32 offen offset:3072 lds
    v_mov_b32 v234, 0
    v_mov_b32 v235, 0
    s_add_u32 s92, s92, s93
    v_mfma_f32_32x32x16_bf16 v[128:143], a[64:67], a[16:19], v[128:143]
    ds_read_b64_tr_b16 a[88:89], v241 offset:4096
    ds_read_b64_tr_b16 a[90:91], v241 offset:4608
    s_cmp_ge_u32 s22, 6
    s_cbranch_scc0 L_po_9
    s_lshr_b32 s42, s42, 1
    s_sub_u32 s41, s41, s42
    s_add_u32 s41, s41, 8192
    buffer_store_dwordx4 v[236:239], v250, s[16:19], s41 offen sc1
L_po_9:
    s_waitcnt lgkmcnt(6)
    v_mfma_f32_32x32x16_bf16 v[128:143], a[68:71], a[20:23], v[128:143]
    ds_read_b64_tr_b16 a[92:93], v241 offset:6144
    ds_read_b64_tr_b16 a[94:95], v241 offset:6656
    s_add_u32 m0, s31, 129024
    s_cbranch_vccnz L_x_10
    buffer_load_dwordx4 v247, s[4:7], s32 offen lds
L_x_10:
    v_mfma_f32_32x32x16_bf16 v[128:143], a[72:75], a[24:27], v[128:143]
    ds_read_b64_tr_b16 a[64:65], v241 offset:8192
    ds_read_b64_tr_b16 a[66:67], v241 offset:8704
    s_lshl_b32 s40, s70, 12
    s_lshl_b32 s41, s20, 10
    s_add_u32 s40, s40, s41
    s_lshl_b32 s41, s22, 7
    s_add_u32 s40, s40, s41
    s_add_u32 s40, s40, 54657024
    s_mov_b64 exec, 1
    buffer_store_dword v251, v251, s[16:19], s40 offen sc1
    s_mov_b64 exec, -1
    v_mfma_f32_32x32x16_bf16 v[128:143], a[76:79], a[28:31], v[128:143]
    ds_read_b64_tr_b16 a[68:69], v241 offset:10240
    ds_read_b64_tr_b16 a[70:71], v241 offset:10752
    s_add_u32 s71, s92, 598016
    s_waitcnt lgkmcnt(6)
    v_mfma_f32_32x32x16_bf16 v[144:159], a[80:83], v[0:3], 0
    ds_read_b64_tr_b16 a[72:73], v241 offset:12288
    ds_read_b64_tr_b16 a[74:75], v241 offset:12800
    s_lshl_b32 s40, s20, 4
    s_add_u32 s40, s40, s39
    s_cmp_lt_u32 s40, 36
    s_cbranch_scc0 L_zp_11
    s_lshl_b32 s40, s40, 17
    s_lshl_b32 s41, s21, 5
    s_add_u32 s40, s40, s41
    s_add_u32 s40, s40, 44040192
    s_mov_b64 exec, 0xffffffff
    buffer_store_dwordx4 v[232:235], v167, s[16:19], s40 offen sc1
    s_mov_b64 exec, -1
L_zp_11:
    v_mfma_f32_32x32x16_bf16 v[144:159], a[84:87], v[4:7], v[144:159]
    ds_read_b64_tr_b16 a[76:77], v241 offset:14336
    ds_read_b64_tr_b16 a[78:79], v241 offset:14848
    v_mfma_f32_32x32x16_bf16 v[144:159], a[88:91], v[8:11], v[144:159]
    ds_read_b64_tr_b16 a[80:81], v241 offset:16384
    ds_read_b64_tr_b16 a[82:83], v241 offset:16896
    v_mul_f32 v232, v248, v128
    v_mul_f32 v233, v248, v129
    s_waitcnt lgkmcnt(6)
    v_mfma_f32_32x32x16_bf16 v[144:159], a[92:95], v[12:15], v[144:159]
    ds_read_b64_tr_b16 a[84:85], v241 offset:18432
    ds_read_b64_tr_b16 a[86:87], v241 offset:18944
    v_exp_f32 v232, v232
    v_exp_f32 v233, v233
    v_mfma_f32_32x32x16_bf16 v[144:159], a[64:67], v[16:19], v[144:159]
    ds_read_b64_tr_b16 a[88:89], v241 offset:20480
    ds_read_b64_tr_b16 a[90:91], v241 offset:20992
    v_fma_f32 v232, v232, v249, v249
    v_fma_f32 v233, v233, v249, v249
    v_mul_f32 v234, v248, v130
    v_mul_f32 v235, v248, v131
    v_mfma_f32_32x32x16_bf16 v[144:159], a[68:71], v[20:23], v[144:159]
    ds_read_b64_tr_b16 a[92:93], v241 offset:22528
    ds_read_b64_tr_b16 a[94:95], v241 offset:23040
    v_rcp_f32 v232, v232
    v_mul_f32 v236, v248, v132
    s_waitcnt lgkmcnt(6)
    v_mfma_f32_32x32x16_bf16 v[144:159], a[72:75], v[24:27], v[144:159]
    ds_read_b64_tr_b16 a[64:65], v241 offset:24576
    ds_read_b64_tr_b16 a[66:67], v241 offset:25088
    v_rcp_f32 v233, v233
    v_mul_f32 v232, v232, v128
    v_mul_f32 v237, v248, v133
    v_mfma_f32_32x32x16_bf16 v[144:159], a[76:79], v[28:31], v[144:159]
    ds_read_b64_tr_b16 a[68:69], v241 offset:26624
    ds_read_b64_tr_b16 a[70:71], v241 offset:27136
    v_mul_f32 v233, v233, v129
    v_mul_f32 v238, v248, v134
    v_mul_f32 v239, v248, v135
    v_mfma_f32_32x32x16_bf16 v[144:159], a[80:83], v[32:35], v[144:159]
    ds_read_b64_tr_b16 a[72:73], v241 offset:28672
    ds_read_b64_tr_b16 a[74:75], v241 offset:29184
    v_exp_f32 v234, v234
    v_cvt_pk_bf16_f32 v160, v232, v233
    s_waitcnt lgkmcnt(6)
    v_mfma_f32_32x32x16_bf16 v[144:159], a[84:87], v[36:39], v[144:159]
    ds_read_b64_tr_b16 a[76:77], v241 offset:30720
    ds_read_b64_tr_b16 a[78:79], v241 offset:31232
    v_exp_f32 v235, v235
    v_fma_f32 v234, v234, v249, v249
    v_mul_f32 v232, v248, v136
    v_mfma_f32_32x32x16_bf16 v[144:159], a[88:91], v[40:43], v[144:159]
    ds_read_b64_tr_b16 a[80:81], v241 offset:32768
    ds_read_b64_tr_b16 a[82:83], v241 offset:33280
    v_rcp_f32 v234, v234
    v_exp_f32 v236, v236
    v_mfma_f32_32x32x16_bf16 v[144:159], a[92:95], v[44:47], v[144:159]
    ds_read_b64_tr_b16 a[84:85], v241 offset:34816
    ds_read_b64_tr_b16 a[86:87], v241 offset:35328
    v_mul_f32 v234, v234, v130
    v_fma_f32 v235, v235, v249, v249
    v_fma_f32 v236, v236, v249, v249
    s_waitcnt lgkmcnt(6)
    v_mfma_f32_32x32x16_bf16 v[144:159], a[64:67], v[48:51], v[144:159]
    ds_read_b64_tr_b16 a[88:89], v241 offset:36864
    ds_read_b64_tr_b16 a[90:91], v241 offset:37376
    v_rcp_f32 v235, v235
    v_rcp_f32 v236, v236
    v_mfma_f32_32x32x16_bf16 v[144:159], a[68:71], v[52:55], v[144:159]
    ds_read_b64_tr_b16 a[92:93], v241 offset:38912
    ds_read_b64_tr_b16 a[94:95], v241 offset:39424
    v_mul_f32 v235, v235, v131
    v_mul_f32 v236, v236, v132
    v_mul_f32 v233, v248, v137
    v_mfma_f32_32x32x16_bf16 v[144:159], a[72:75], v[56:59], v[144:159]
    ds_read_b64_tr_b16 a[64:65], v241 offset:40960
    ds_read_b64_tr_b16 a[66:67], v241 offset:41472
    v_exp_f32 v237, v237
    v_cvt_pk_bf16_f32 v161, v234, v235
    s_waitcnt lgkmcnt(6)
    v_mfma_f32_32x32x16_bf16 v[144:159], a[76:79], v[60:63], v[144:159]
    ds_read_b64_tr_b16 a[68:69], v241 offset:43008
    ds_read_b64_tr_b16 a[70:71], v241 offset:43520
    v_exp_f32 v238, v238
    v_fma_f32 v237, v237, v249, v249
    v_mul_f32 v234, v248, v138
    v_mfma_f32_32x32x16_bf16 v[144:159], a[80:83], v[64:67], v[144:159]
    ds_read_b64_tr_b16 a[72:73], v241 offset:45056
    ds_read_b64_tr_b16 a[74:75], v241 offset:45568
    v_rcp_f32 v237, v237
    v_fma_f32 v238, v238, v249, v249
    v_mfma_f32_32x32x16_bf16 v[144:159], a[84:87], v[68:71], v[144:159]
    ds_read_b64_tr_b16 a[76:77], v241 offset:47104
    ds_read_b64_tr_b16 a[78:79], v241 offset:47616
    v_rcp_f32 v238, v238
    v_mul_f32 v237, v237, v133
    s_waitcnt lgkmcnt(6)
    v_mfma_f32_32x32x16_bf16 v[144:159], a[88:91], v[72:75], v[144:159]
    ds_read_b64_tr_b16 a[80:81], v241 offset:49152
    ds_read_b64_tr_b16 a[82:83], v241 offset:49664
    v_exp_f32 v239, v239
    v_cvt_pk_bf16_f32 v162, v236, v237
    v_mul_f32 v238, v238, v134
    v_mfma_f32_32x32x16_bf16 v[144:159], a[92:95], v[76:79], v[144:159]
    ds_read_b64_tr_b16 a[84:85], v241 offset:51200
    ds_read_b64_tr_b16 a[86:87], v241 offset:51712
    v_fma_f32 v239, v239, v249, v249
    v_mul_f32 v235, v248, v139
    v_mul_f32 v236, v248, v140
    v_mfma_f32_32x32x16_bf16 v[144:159], a[64:67], v[80:83], v[144:159]
    ds_read_b64_tr_b16 a[88:89], v241 offset:53248
    ds_read_b64_tr_b16 a[90:91], v241 offset:53760
    v_rcp_f32 v239, v239
    v_mul_f32 v237, v248, v141
    s_waitcnt lgkmcnt(6)
    v_mfma_f32_32x32x16_bf16 v[144:159], a[68:71], v[84:87], v[144:159]
    ds_read_b64_tr_b16 a[92:93], v241 offset:55296
    ds_read_b64_tr_b16 a[94:95], v241 offset:55808
    v_exp_f32 v232, v232
    v_exp_f32 v233, v233
    v_mfma_f32_32x32x16_bf16 v[144:159], a[72:75], v[88:91], v[144:159]
    ds_read_b64_tr_b16 a[64:65], v241 offset:57344
    ds_read_b64_tr_b16 a[66:67], v241 offset:57856
    v_exp_f32 v234, v234
    v_mul_f32 v239, v239, v135
    v_fma_f32 v232, v232, v249, v249
    v_mfma_f32_32x32x16_bf16 v[144:159], a[76:79], v[92:95], v[144:159]
    ds_read_b64_tr_b16 a[68:69], v241 offset:59392
    ds_read_b64_tr_b16 a[70:71], v241 offset:59904
    v_cvt_pk_bf16_f32 v163, v238, v239
    v_fma_f32 v233, v233, v249, v249
    v_fma_f32 v234, v234, v249, v249
    s_waitcnt lgkmcnt(6)
    v_mfma_f32_32x32x16_bf16 v[144:159], a[80:83], v[96:99], v[144:159]
    ds_read_b64_tr_b16 a[72:73], v241 offset:61440
    ds_read_b64_tr_b16 a[74:75], v241 offset:61952
    buffer_store_dwordx4 v[160:163], v250, s[16:19], s34 offen offset:0 sc1
    v_mul_f32 v238, v248, v142
    v_mul_f32 v239, v248, v143
    v_mfma_f32_32x32x16_bf16 v[144:159], a[84:87], v[100:103], v[144:159]
    ds_read_b64_tr_b16 a[76:77], v241 offset:63488
    ds_read_b64_tr_b16 a[78:79], v241 offset:64000
    v_rcp_f32 v232, v232
    v_rcp_f32 v233, v233
    v_mfma_f32_32x32x16_bf16 v[144:159], a[88:91], v[104:107], v[144:159]
    v_add_u32 v241, 55296, v241
    ds_read_b64_tr_b16 a[80:81], v241 offset:10240
    ds_read_b64_tr_b16 a[82:83], v241 offset:10752
    v_rcp_f32 v234, v234
    v_mul_f32 v232, v232, v136
    s_waitcnt lgkmcnt(6)
    v_mfma_f32_32x32x16_bf16 v[144:159], a[92:95], v[108:111], v[144:159]
    ds_read_b64_tr_b16 a[84:85], v241 offset:12288
    ds_read_b64_tr_b16 a[86:87], v241 offset:12800
    v_exp_f32 v235, v235
    v_exp_f32 v236, v236
    v_mfma_f32_32x32x16_bf16 v[144:159], a[64:67], a[0:3], v[144:159]
    ds_read_b64_tr_b16 a[88:89], v241 offset:14336
    ds_read_b64_tr_b16 a[90:91], v241 offset:14848
    v_mul_f32 v233, v233, v137
    v_mul_f32 v234, v234, v138
    v_fma_f32 v235, v235, v249, v249
    v_mfma_f32_32x32x16_bf16 v[144:159], a[68:71], a[4:7], v[144:159]
    ds_read_b64_tr_b16 a[92:93], v241 offset:16384
    ds_read_b64_tr_b16 a[94:95], v241 offset:16896
    v_rcp_f32 v235, v235
    v_cvt_pk_bf16_f32 v164, v232, v233
    s_waitcnt vmcnt(11) lgkmcnt(6)
    v_mfma_f32_32x32x16_bf16 v[144:159], a[72:75], a[8:11], v[144:159]
    s_barrier
    ds_read_b64_tr_b16 a[64:65], v240 offset:18432
    ds_read_b64_tr_b16 a[66:67], v240 offset:18944
    v_exp_f32 v237, v237
    v_mul_f32 v235, v235, v139
    v_mfma_f32_32x32x16_bf16 v[144:159], a[76:79], a[12:15], v[144:159]
    ds_read_b64_tr_b16 a[68:69], v240 offset:20480
    ds_read_b64_tr_b16 a[70:71], v240 offset:20992
    v_exp_f32 v238, v238
    v_cvt_pk_bf16_f32 v165, v234, v235
    v_fma_f32 v236, v236, v249, v249
    v_mfma_f32_32x32x16_bf16 v[144:159], a[80:83], a[16:19], v[144:159]
    ds_read_b64_tr_b16 a[72:73], v240 offset:22528
    ds_read_b64_tr_b16 a[74:75], v240 offset:23040
    v_rcp_f32 v236, v236
    v_fma_f32 v237, v237, v249, v249
    s_waitcnt lgkmcnt(6)
    v_mfma_f32_32x32x16_bf16 v[144:159], a[84:87], a[20:23], v[144:159]
    ds_read_b64_tr_b16 a[76:77], v240 offset:24576
    ds_read_b64_tr_b16 a[78:79], v240 offset:25088
    v_rcp_f32 v237, v237
    v_exp_f32 v239, v239
    v_mfma_f32_32x32x16_bf16 v[144:159], a[88:91], a[24:27], v[144:159]
    ds_read_b64_tr_b16 a[80:81], v240 offset:26624
    ds_read_b64_tr_b16 a[82:83], v240 offset:27136
    v_mul_f32 v236, v236, v140
    v_mul_f32 v237, v237, v141
    v_fma_f32 v238, v238, v249, v249
    v_fma_f32 v239, v239, v249, v249
    v_mfma_f32_32x32x16_bf16 v[144:159], a[92:95], a[28:31], v[144:159]
    ds_read_b64_tr_b16 a[84:85], v240 offset:28672
    ds_read_b64_tr_b16 a[86:87], v240 offset:29184
    v_rcp_f32 v238, v238
    v_cvt_pk_bf16_f32 v166, v236, v237
    s_waitcnt lgkmcnt(6)
    v_mfma_f32_32x32x16_bf16 v[112:127], a[64:67], v[0:3], 0
    ds_read_b64_tr_b16 a[88:89], v240 offset:30720
    ds_read_b64_tr_b16 a[90:91], v240 offset:31232
    s_add_u32 m0, s30, 0
    s_add_u32 s32, s24, 256
    buffer_load_dwordx4 v243, s[4:7], s32 offen lds
    v_mul_f32 v238, v238, v142
    v_mfma_f32_32x32x16_bf16 v[112:127], a[68:71], v[4:7], v[112:127]
    ds_read_b64_tr_b16 a[92:93], v240 offset:32768
    ds_read_b64_tr_b16 a[94:95], v240 offset:33280
    buffer_load_dwordx4 v244, s[4:7], s32 offen offset:1024 lds
    v_rcp_f32 v239, v239
    v_mfma_f32_32x32x16_bf16 v[112:127], a[72:75], v[8:11], v[112:127]
    ds_read_b64_tr_b16 a[64:65], v240 offset:34816
    ds_read_b64_tr_b16 a[66:67], v240 offset:35328
    v_mul_f32 v239, v239, v143
    v_mul_f32 v232, v248, v144
    v_mul_f32 v233, v248, v145
    s_waitcnt lgkmcnt(6)
    v_mfma_f32_32x32x16_bf16 v[112:127], a[76:79], v[12:15], v[112:127]
    ds_read_b64_tr_b16 a[68:69], v240 offset:36864
    ds_read_b64_tr_b16 a[70:71], v240 offset:37376
    buffer_load_dwordx4 v245, s[4:7], s32 offen offset:2048 lds
    v_cvt_pk_bf16_f32 v167, v238, v239
    v_mul_f32 v234, v248, v146
    v_mul_f32 v235, v248, v147
    v_mfma_f32_32x32x16_bf16 v[112:127], a[80:83], v[16:19], v[112:127]
    ds_read_b64_tr_b16 a[72:73], v240 offset:38912
    ds_read_b64_tr_b16 a[74:75], v240 offset:39424
    buffer_load_dwordx4 v246, s[4:7], s32 offen offset:3072 lds
    buffer_store_dwordx4 v[164:167], v250, s[16:19], s34 offen offset:1024 sc1
    v_mul_f32 v236, v248, v148
    v_mul_f32 v237, v248, v149
    v_mfma_f32_32x32x16_bf16 v[112:127], a[84:87], v[20:23], v[112:127]
    ds_read_b64_tr_b16 a[76:77], v240 offset:40960
    ds_read_b64_tr_b16 a[78:79], v240 offset:41472
    v_exp_f32 v232, v232
    v_mul_f32 v238, v248, v150
    s_waitcnt lgkmcnt(6)
    v_mfma_f32_32x32x16_bf16 v[112:127], a[88:91], v[24:27], v[112:127]
    ds_read_b64_tr_b16 a[80:81], v240 offset:43008
    ds_read_b64_tr_b16 a[82:83], v240 offset:43520
    s_add_u32 m0, s31, 0
    s_cbranch_vccz L_x_12
    buffer_load_dwordx4 v247, s[4:7], s32 offen lds
L_x_12:
    v_fma_f32 v232, v232, v249, v249
    v_mfma_f32_32x32x16_bf16 v[112:127], a[92:95], v[28:31], v[112:127]
    ds_read_b64_tr_b16 a[84:85], v240 offset:45056
    ds_read_b64_tr_b16 a[86:87], v240 offset:45568
    v_rcp_f32 v232, v232
    v_exp_f32 v233, v233
    v_mfma_f32_32x32x16_bf16 v[112:127], a[64:67], v[32:35], v[112:127]
    ds_read_b64_tr_b16 a[88:89], v240 offset:47104
    ds_read_b64_tr_b16 a[90:91], v240 offset:47616
    s_add_u32 m0, s30, 18432
    s_add_u32 s32, s24, 1327360
    buffer_load_dwordx4 v243, s[4:7], s32 offen lds
    s_waitcnt lgkmcnt(6)
    v_mfma_f32_32x32x16_bf16 v[112:127], a[68:71], v[36:39], v[112:127]
    ds_read_b64_tr_b16 a[92:93], v240 offset:49152
    ds_read_b64_tr_b16 a[94:95], v240 offset:49664
    v_exp_f32 v234, v234
    v_mul_f32 v232, v232, v144
    v_fma_f32 v233, v233, v249, v249
    v_mfma_f32_32x32x16_bf16 v[112:127], a[72:75], v[40:43], v[112:127]
    ds_read_b64_tr_b16 a[64:65], v240 offset:51200
    ds_read_b64_tr_b16 a[66:67], v240 offset:51712
    buffer_load_dwordx4 v244, s[4:7], s32 offen offset:1024 lds
    v_rcp_f32 v233, v233
    v_fma_f32 v234, v234, v249, v249
    v_mfma_f32_32x32x16_bf16 v[112:127], a[76:79], v[44:47], v[112:127]
    ds_read_b64_tr_b16 a[68:69], v240 offset:53248
    ds_read_b64_tr_b16 a[70:71], v240 offset:53760
    v_rcp_f32 v234, v234
    v_mul_f32 v233, v233, v145
    s_waitcnt vmcnt(8) lgkmcnt(6)
    v_mfma_f32_32x32x16_bf16 v[112:127], a[80:83], v[48:51], v[112:127]
    s_barrier
    ds_read_b64_tr_b16 a[72:73], v240 offset:55296
    ds_read_b64_tr_b16 a[74:75], v240 offset:55808
    buffer_load_dwordx4 v245, s[4:7], s32 offen offset:2048 lds
    v_cvt_pk_bf16_f32 v168, v232, v233
    v_mul_f32 v234, v234, v146
    v_mfma_f32_32x32x16_bf16 v[112:127], a[84:87], v[52:55], v[112:127]
    ds_read_b64_tr_b16 a[76:77], v240 offset:57344
    ds_read_b64_tr_b16 a[78:79], v240 offset:57856
    buffer_load_dwordx4 v246, s[4:7], s32 offen offset:3072 lds
    v_exp_f32 v235, v235
    v_mul_f32 v239, v248, v151
    v_mfma_f32_32x32x16_bf16 v[112:127], a[88:91], v[56:59], v[112:127]
    ds_read_b64_tr_b16 a[80:81], v240 offset:59392
    ds_read_b64_tr_b16 a[82:83], v240 offset:59904
    v_fma_f32 v235, v235, v249, v249
    v_mul_f32 v232, v248, v152
    v_mul_f32 v233, v248, v153
    s_waitcnt lgkmcnt(6)
    v_mfma_f32_32x32x16_bf16 v[112:127], a[92:95], v[60:63], v[112:127]
    ds_read_b64_tr_b16 a[84:85], v240 offset:61440
    ds_read_b64_tr_b16 a[86:87], v240 offset:61952
    s_add_u32 m0, s31, 18432
    s_cbranch_vccnz L_x_13
    buffer_load_dwordx4 v247, s[4:7], s32 offen lds
L_x_13:
    v_mfma_f32_32x32x16_bf16 v[112:127], a[64:67], v[64:67], v[112:127]
    ds_read_b64_tr_b16 a[88:89], v240 offset:63488
    ds_read_b64_tr_b16 a[90:91], v240 offset:64000
    v_rcp_f32 v235, v235
    v_exp_f32 v236, v236
    v_mfma_f32_32x32x16_bf16 v[112:127], a[68:71], v[68:71], v[112:127]
    v_add_u32 v240, 55296, v240
    ds_read_b64_tr_b16 a[92:93], v240 offset:10240
    ds_read_b64_tr_b16 a[94:95], v240 offset:10752
    v_exp_f32 v237, v237
    v_mul_f32 v235, v235, v147
    s_waitcnt lgkmcnt(6)
    v_mfma_f32_32x32x16_bf16 v[112:127], a[72:75], v[72:75], v[112:127]
    ds_read_b64_tr_b16 a[64:65], v240 offset:12288
    ds_read_b64_tr_b16 a[66:67], v240 offset:12800
    s_add_u32 m0, s30, 36864
    s_add_u32 s32, s24, 2654464
    buffer_load_dwordx4 v243, s[4:7], s32 offen lds
    v_cvt_pk_bf16_f32 v169, v234, v235
    v_mfma_f32_32x32x16_bf16 v[112:127], a[76:79], v[76:79], v[112:127]
    ds_read_b64_tr_b16 a[68:69], v240 offset:14336
    ds_read_b64_tr_b16 a[70:71], v240 offset:14848
    buffer_load_dwordx4 v244, s[4:7], s32 offen offset:1024 lds
    v_fma_f32 v236, v236, v249, v249
    v_fma_f32 v237, v237, v249, v249
    v_mul_f32 v234, v248, v154
    v_mfma_f32_32x32x16_bf16 v[112:127], a[80:83], v[80:83], v[112:127]
    ds_read_b64_tr_b16 a[72:73], v240 offset:16384
    ds_read_b64_tr_b16 a[74:75], v240 offset:16896
    v_rcp_f32 v236, v236
    v_mul_f32 v235, v248, v155
    s_waitcnt lgkmcnt(6)
    v_mfma_f32_32x32x16_bf16 v[112:127], a[84:87], v[84:87], v[112:127]
    ds_read_b64_tr_b16 a[76:77], v240 offset:18432
    ds_read_b64_tr_b16 a[78:79], v240 offset:18944
    buffer_load_dwordx4 v245, s[4:7], s32 offen offset:2048 lds
    v_rcp_f32 v237, v237
    v_mul_f32 v236, v236, v148
    v_mfma_f32_32x32x16_bf16 v[112:127], a[88:91], v[88:91], v[112:127]
    ds_read_b64_tr_b16 a[80:81], v240 offset:20480
    ds_read_b64_tr_b16 a[82:83], v240 offset:20992
    buffer_load_dwordx4 v246, s[4:7], s32 offen offset:3072 lds
    v_exp_f32 v238, v238
    v_mul_f32 v237, v237, v149
    v_mfma_f32_32x32x16_bf16 v[112:127], a[92:95], v[92:95], v[112:127]
    ds_read_b64_tr_b16 a[84:85], v240 offset:22528
    ds_read_b64_tr_b16 a[86:87], v240 offset:23040
    v_exp_f32 v239, v239
    v_cvt_pk_bf16_f32 v170, v236, v237
    s_waitcnt lgkmcnt(6)
    v_mfma_f32_32x32x16_bf16 v[112:127], a[64:67], v[96:99], v[112:127]
    ds_read_b64_tr_b16 a[88:89], v240 offset:24576
    ds_read_b64_tr_b16 a[90:91], v240 offset:25088
    s_add_u32 m0, s31, 36864
    s_cbranch_vccz L_x_14
    buffer_load_dwordx4 v247, s[4:7], s32 offen lds
L_x_14:
    v_fma_f32 v238, v238, v249, v249
    v_mfma_f32_32x32x16_bf16 v[112:127], a[68:71], v[100:103], v[112:127]
    ds_read_b64_tr_b16 a[92:93], v240 offset:26624
    ds_read_b64_tr_b16 a[94:95], v240 offset:27136
    v_rcp_f32 v238, v238
    v_fma_f32 v239, v239, v249, v249
    v_mul_f32 v236, v248, v156
    v_mfma_f32_32x32x16_bf16 v[112:127], a[72:75], v[104:107], v[112:127]
    ds_read_b64_tr_b16 a[64:65], v240 offset:28672
    ds_read_b64_tr_b16 a[66:67], v240 offset:29184
    s_add_u32 m0, s30, 55296
    s_add_u32 s32, s24, 3981568
    buffer_load_dwordx4 v243, s[4:7], s32 offen lds
    s_waitcnt lgkmcnt(6)
    v_mfma_f32_32x32x16_bf16 v[112:127], a[76:79], v[108:111], v[112:127]
    ds_read_b64_tr_b16 a[68:69], v240 offset:30720
    ds_read_b64_tr_b16 a[70:71], v240 offset:31232
    v_rcp_f32 v239, v239
    v_exp_f32 v232, v232
    v_mfma_f32_32x32x16_bf16 v[112:127], a[80:83], a[0:3], v[112:127]
    ds_read_b64_tr_b16 a[72:73], v240 offset:32768
    ds_read_b64_tr_b16 a[74:75], v240 offset:33280
    buffer_load_dwordx4 v244, s[4:7], s32 offen offset:1024 lds
    v_mul_f32 v238, v238, v150
    v_mul_f32 v239, v239, v151
    v_fma_f32 v232, v232, v249, v249
    v_mfma_f32_32x32x16_bf16 v[112:127], a[84:87], a[4:7], v[112:127]
    ds_read_b64_tr_b16 a[76:77], v240 offset:34816
    ds_read_b64_tr_b16 a[78:79], v240 offset:35328
    v_rcp_f32 v232, v232
    v_cvt_pk_bf16_f32 v171, v238, v239
    s_waitcnt lgkmcnt(6)
    v_mfma_f32_32x32x16_bf16 v[112:127], a[88:91], a[8:11], v[112:127]
    ds_read_b64_tr_b16 a[80:81], v241 offset:18432
    ds_read_b64_tr_b16 a[82:83], v241 offset:18944
    buffer_load_dwordx4 v245, s[4:7], s32 offen offset:2048 lds
    buffer_store_dwordx4 v[168:171], v250, s[16:19], s34 offen offset:2048 sc1
    v_mul_f32 v232, v232, v152
    v_mul_f32 v237, v248, v157
    v_mfma_f32_32x32x16_bf16 v[112:127], a[92:95], a[12:15], v[112:127]
    ds_read_b64_tr_b16 a[84:85], v241 offset:20480
    ds_read_b64_tr_b16 a[86:87], v241 offset:20992
    buffer_load_dwordx4 v246, s[4:7], s32 offen offset:3072 lds
    v_exp_f32 v233, v233
    v_mul_f32 v238, v248, v158
    v_mfma_f32_32x32x16_bf16 v[112:127], a[64:67], a[16:19], v[112:127]
    ds_read_b64_tr_b16 a[88:89], v241 offset:22528
    ds_read_b64_tr_b16 a[90:91], v241 offset:23040
    v_exp_f32 v234, v234
    v_fma_f32 v233, v233, v249, v249
    s_waitcnt lgkmcnt(6)
    v_mfma_f32_32x32x16_bf16 v[112:127], a[68:71], a[20:23], v[112:127]
    ds_read_b64_tr_b16 a[92:93], v241 offset:24576
    ds_read_b64_tr_b16 a[94:95], v241 offset:25088
    s_add_u32 m0, s31, 55296
    s_cbranch_vccnz L_x_15
    buffer_load_dwordx4 v247, s[4:7], s32 offen lds
L_x_15:
    v_fma_f32 v234, v234, v249, v249
    v_mfma_f32_32x32x16_bf16 v[112:127], a[72:75], a[24:27], v[112:127]
    ds_read_b64_tr_b16 a[64:65], v241 offset:26624
    ds_read_b64_tr_b16 a[66:67], v241 offset:27136
    v_rcp_f32 v233, v233
    v_rcp_f32 v234, v234
    v_mfma_f32_32x32x16_bf16 v[112:127], a[76:79], a[28:31], v[112:127]
    ds_read_b64_tr_b16 a[68:69], v241 offset:28672
    ds_read_b64_tr_b16 a[70:71], v241 offset:29184
    v_accvgpr_read_b32 v255, a61
    buffer_load_dword a253, v255, s[8:11], s3 offen
    v_mul_f32 v233, v233, v153
    s_waitcnt lgkmcnt(6)
    v_mfma_f32_32x32x16_bf16 v[128:143], a[80:83], v[0:3], 0
    ds_read_b64_tr_b16 a[72:73], v241 offset:30720
    ds_read_b64_tr_b16 a[74:75], v241 offset:31232
    v_exp_f32 v235, v235
    v_cvt_pk_bf16_f32 v172, v232, v233
    v_mul_f32 v234, v234, v154
    v_mfma_f32_32x32x16_bf16 v[128:143], a[84:87], v[4:7], v[128:143]
    ds_read_b64_tr_b16 a[76:77], v241 offset:32768
    ds_read_b64_tr_b16 a[78:79], v241 offset:33280
    v_exp_f32 v236, v236
    v_exp_f32 v237, v237
    v_mfma_f32_32x32x16_bf16 v[128:143], a[88:91], v[8:11], v[128:143]
    ds_read_b64_tr_b16 a[80:81], v241 offset:34816
    ds_read_b64_tr_b16 a[82:83], v241 offset:35328
    v_fma_f32 v235, v235, v249, v249
    v_fma_f32 v236, v236, v249, v249
    v_fma_f32 v237, v237, v249, v249
    s_waitcnt lgkmcnt(6)
    v_mfma_f32_32x32x16_bf16 v[128:143], a[92:95], v[12:15], v[128:143]
    ds_read_b64_tr_b16 a[84:85], v241 offset:36864
    ds_read_b64_tr_b16 a[86:87], v241 offset:37376
    v_rcp_f32 v235, v235
    v_rcp_f32 v236, v236
    v_mfma_f32_32x32x16_bf16 v[128:143], a[64:67], v[16:19], v[128:143]
    ds_read_b64_tr_b16 a[88:89], v241 offset:38912
    ds_read_b64_tr_b16 a[90:91], v241 offset:39424
    v_mul_f32 v235, v235, v155
    v_mul_f32 v236, v236, v156
    v_mul_f32 v239, v248, v159
    v_mul_f32 v232, v248, v112
    v_mfma_f32_32x32x16_bf16 v[128:143], a[68:71], v[20:23], v[128:143]
    ds_read_b64_tr_b16 a[92:93], v241 offset:40960
    ds_read_b64_tr_b16 a[94:95], v241 offset:41472
    v_rcp_f32 v237, v237
    v_cvt_pk_bf16_f32 v173, v234, v235
    s_waitcnt lgkmcnt(6)
    v_mfma_f32_32x32x16_bf16 v[128:143], a[72:75], v[24:27], v[128:143]
    ds_read_b64_tr_b16 a[64:65], v241 offset:43008
    ds_read_b64_tr_b16 a[66:67], v241 offset:43520
    v_exp_f32 v238, v238
    v_mul_f32 v237, v237, v157
    v_mul_f32 v233, v248, v113
    v_mfma_f32_32x32x16_bf16 v[128:143], a[76:79], v[28:31], v[128:143]
    ds_read_b64_tr_b16 a[68:69], v241 offset:45056
    ds_read_b64_tr_b16 a[70:71], v241 offset:45568
    v_cvt_pk_bf16_f32 v174, v236, v237
    v_fma_f32 v238, v238, v249, v249
    v_mul_f32 v234, v248, v114
    v_mul_f32 v235, v248, v115
    v_mfma_f32_32x32x16_bf16 v[128:143], a[80:83], v[32:35], v[128:143]
    ds_read_b64_tr_b16 a[72:73], v241 offset:47104
    ds_read_b64_tr_b16 a[74:75], v241 offset:47616
    v_rcp_f32 v238, v238
    v_mul_f32 v236, v248, v116
    s_waitcnt lgkmcnt(6)
    v_mfma_f32_32x32x16_bf16 v[128:143], a[84:87], v[36:39], v[128:143]
    ds_read_b64_tr_b16 a[76:77], v241 offset:49152
    ds_read_b64_tr_b16 a[78:79], v241 offset:49664
    v_exp_f32 v239, v239
    v_exp_f32 v232, v232
    v_mfma_f32_32x32x16_bf16 v[128:143], a[88:91], v[40:43], v[128:143]
    ds_read_b64_tr_b16 a[80:81], v241 offset:51200
    ds_read_b64_tr_b16 a[82:83], v241 offset:51712
    v_mul_f32 v238, v238, v158
    v_fma_f32 v239, v239, v249, v249
    v_fma_f32 v232, v232, v249, v249
    v_mul_f32 v237, v248, v117
    v_mfma_f32_32x32x16_bf16 v[128:143], a[92:95], v[44:47], v[128:143]
    ds_read_b64_tr_b16 a[84:85], v241 offset:53248
    ds_read_b64_tr_b16 a[86:87], v241 offset:53760
    v_rcp_f32 v239, v239
    s_waitcnt lgkmcnt(6)
    v_mfma_f32_32x32x16_bf16 v[128:143], a[64:67], v[48:51], v[128:143]
    ds_read_b64_tr_b16 a[88:89], v241 offset:55296
    ds_read_b64_tr_b16 a[90:91], v241 offset:55808
    v_rcp_f32 v232, v232
    v_exp_f32 v233, v233
    v_mfma_f32_32x32x16_bf16 v[128:143], a[68:71], v[52:55], v[128:143]
    ds_read_b64_tr_b16 a[92:93], v241 offset:57344
    ds_read_b64_tr_b16 a[94:95], v241 offset:57856
    v_exp_f32 v234, v234
    v_mul_f32 v239, v239, v159
    v_mul_f32 v232, v232, v112
    v_mfma_f32_32x32x16_bf16 v[128:143], a[72:75], v[56:59], v[128:143]
    ds_read_b64_tr_b16 a[64:65], v241 offset:59392
    ds_read_b64_tr_b16 a[66:67], v241 offset:59904
    v_cvt_pk_bf16_f32 v175, v238, v239
    v_fma_f32 v233, v233, v249, v249
    v_fma_f32 v234, v234, v249, v249
    s_waitcnt lgkmcnt(6)
    v_mfma_f32_32x32x16_bf16 v[128:143], a[76:79], v[60:63], v[128:143]
    ds_read_b64_tr_b16 a[68:69], v241 offset:61440
    ds_read_b64_tr_b16 a[70:71], v241 offset:61952
    buffer_store_dwordx4 v[172:175], v250, s[16:19], s34 offen offset:3072 sc1
    v_rcp_f32 v233, v233
    v_mul_f32 v238, v248, v118
    v_mfma_f32_32x32x16_bf16 v[128:143], a[80:83], v[64:67], v[128:143]
    ds_read_b64_tr_b16 a[72:73], v241 offset:63488
    ds_read_b64_tr_b16 a[74:75], v241 offset:64000
    v_rcp_f32 v234, v234
    v_exp_f32 v235, v235
    v_mfma_f32_32x32x16_bf16 v[128:143], a[84:87], v[68:71], v[128:143]
    v_add_u32 v241, 55296, v241
    ds_read_b64_tr_b16 a[76:77], v241 offset:10240
    ds_read_b64_tr_b16 a[78:79], v241 offset:10752
    v_mul_f32 v233, v233, v113
    v_mul_f32 v234, v234, v114
    v_fma_f32 v235, v235, v249, v249
    s_waitcnt lgkmcnt(6)
    v_mfma_f32_32x32x16_bf16 v[128:143], a[88:91], v[72:75], v[128:143]
    ds_read_b64_tr_b16 a[80:81], v241 offset:12288
    ds_read_b64_tr_b16 a[82:83], v241 offset:12800
    v_rcp_f32 v235, v235
    v_exp_f32 v236, v236
    v_mfma_f32_32x32x16_bf16 v[128:143], a[92:95], v[76:79], v[128:143]
    ds_read_b64_tr_b16 a[84:85], v241 offset:14336
    ds_read_b64_tr_b16 a[86:87], v241 offset:14848
    v_cvt_pk_bf16_f32 v176, v232, v233
    v_mul_f32 v235, v235, v115
    v_fma_f32 v236, v236, v249, v249
    v_mul_f32 v239, v248, v119
    v_mfma_f32_32x32x16_bf16 v[128:143], a[64:67], v[80:83], v[128:143]
    ds_read_b64_tr_b16 a[88:89], v241 offset:16384
    ds_read_b64_tr_b16 a[90:91], v241 offset:16896
    v_cvt_pk_bf16_f32 v177, v234, v235
    v_mul_f32 v232, v248, v120
    v_mul_f32 v233, v248, v121
    s_waitcnt lgkmcnt(6)
    v_mfma_f32_32x32x16_bf16 v[128:143], a[68:71], v[84:87], v[128:143]
    ds_read_b64_tr_b16 a[92:93], v241 offset:18432
    ds_read_b64_tr_b16 a[94:95], v241 offset:18944
    v_rcp_f32 v236, v236
    v_exp_f32 v237, v237
    v_mfma_f32_32x32x16_bf16 v[128:143], a[72:75], v[88:91], v[128:143]
    ds_read_b64_tr_b16 a[64:65], v241 offset:20480
    ds_read_b64_tr_b16 a[66:67], v241 offset:20992
    v_mul_f32 v236, v236, v116
    v_fma_f32 v237, v237, v249, v249
    v_mul_f32 v234, v248, v122
    v_mul_f32 v235, v248, v123
    v_mfma_f32_32x32x16_bf16 v[128:143], a[76:79], v[92:95], v[128:143]
    ds_read_b64_tr_b16 a[68:69], v241 offset:22528
    ds_read_b64_tr_b16 a[70:71], v241 offset:23040
    v_rcp_f32 v237, v237
    s_waitcnt lgkmcnt(6)
    v_mfma_f32_32x32x16_bf16 v[128:143], a[80:83], v[96:99], v[128:143]
    ds_read_b64_tr_b16 a[72:73], v241 offset:24576
    ds_read_b64_tr_b16 a[74:75], v241 offset:25088
    v_exp_f32 v238, v238
    v_exp_f32 v239, v239
    v_mfma_f32_32x32x16_bf16 v[128:143], a[84:87], v[100:103], v[128:143]
    ds_read_b64_tr_b16 a[76:77], v241 offset:26624
    ds_read_b64_tr_b16 a[78:79], v241 offset:27136
    v_exp_f32 v232, v232
    v_mul_f32 v237, v237, v117
    v_fma_f32 v238, v238, v249, v249
    v_mfma_f32_32x32x16_bf16 v[128:143], a[88:91], v[104:107], v[128:143]
    ds_read_b64_tr_b16 a[80:81], v241 offset:28672
    ds_read_b64_tr_b16 a[82:83], v241 offset:29184
    v_cvt_pk_bf16_f32 v178, v236, v237
    v_fma_f32 v239, v239, v249, v249
    v_fma_f32 v232, v232, v249, v249
    s_waitcnt lgkmcnt(6)
    v_mfma_f32_32x32x16_bf16 v[128:143], a[92:95], v[108:111], v[128:143]
    ds_read_b64_tr_b16 a[84:85], v241 offset:30720
    ds_read_b64_tr_b16 a[86:87], v241 offset:31232
    v_rcp_f32 v238, v238
    v_rcp_f32 v239, v239
    v_mfma_f32_32x32x16_bf16 v[128:143], a[64:67], a[0:3], v[128:143]
    ds_read_b64_tr_b16 a[88:89], v241 offset:32768
    ds_read_b64_tr_b16 a[90:91], v241 offset:33280
    v_mul_f32 v238, v238, v118
    v_mul_f32 v239, v239, v119
    v_mul_f32 v236, v248, v124
    v_mul_f32 v237, v248, v125
    v_mfma_f32_32x32x16_bf16 v[128:143], a[68:71], a[4:7], v[128:143]
    ds_read_b64_tr_b16 a[92:93], v241 offset:34816
    ds_read_b64_tr_b16 a[94:95], v241 offset:35328
    v_rcp_f32 v232, v232
    v_cvt_pk_bf16_f32 v179, v238, v239
    s_waitcnt vmcnt(12) lgkmcnt(6)
    v_mfma_f32_32x32x16_bf16 v[128:143], a[72:75], a[8:11], v[128:143]
    s_barrier
    v_add_u32 v240, 4294856704, v240
    ds_read_b64_tr_b16 a[64:65], v240 offset:0
    ds_read_b64_tr_b16 a[66:67], v240 offset:512
    v_mul_f32 v232, v232, v120
    v_mul_f32 v238, v248, v126
    v_mul_f32 v239, v248, v127
    v_mfma_f32_32x32x16_bf16 v[128:143], a[76:79], a[12:15], v[128:143]
    ds_read_b64_tr_b16 a[68:69], v240 offset:2048
    ds_read_b64_tr_b16 a[70:71], v240 offset:2560
    s_add_u32 s34, s34, 4096
    buffer_store_dwordx4 v[176:179], v250, s[16:19], s34 offen offset:0 sc1
    v_exp_f32 v233, v233
    v_mfma_f32_32x32x16_bf16 v[128:143], a[80:83], a[16:19], v[128:143]
    ds_read_b64_tr_b16 a[72:73], v240 offset:4096
    ds_read_b64_tr_b16 a[74:75], v240 offset:4608
    v_exp_f32 v234, v234
    v_fma_f32 v233, v233, v249, v249
    s_waitcnt lgkmcnt(6)
    v_mfma_f32_32x32x16_bf16 v[128:143], a[84:87], a[20:23], v[128:143]
    ds_read_b64_tr_b16 a[76:77], v240 offset:6144
    ds_read_b64_tr_b16 a[78:79], v240 offset:6656
    v_rcp_f32 v233, v233
    v_exp_f32 v235, v235
    v_mfma_f32_32x32x16_bf16 v[128:143], a[88:91], a[24:27], v[128:143]
    ds_read_b64_tr_b16 a[80:81], v240 offset:8192
    ds_read_b64_tr_b16 a[82:83], v240 offset:8704
    v_exp_f32 v236, v236
    v_mul_f32 v233, v233, v121
    v_fma_f32 v234, v234, v249, v249
    v_mfma_f32_32x32x16_bf16 v[128:143], a[92:95], a[28:31], v[128:143]
    ds_read_b64_tr_b16 a[84:85], v240 offset:10240
    ds_read_b64_tr_b16 a[86:87], v240 offset:10752
    v_cvt_pk_bf16_f32 v180, v232, v233
    v_fma_f32 v235, v235, v249, v249
    v_fma_f32 v236, v236, v249, v249
    s_waitcnt lgkmcnt(6)
    v_mfma_f32_32x32x16_bf16 v[144:159], a[64:67], v[0:3], 0
    ds_read_b64_tr_b16 a[88:89], v240 offset:12288
    ds_read_b64_tr_b16 a[90:91], v240 offset:12800
    s_add_u32 m0, s30, 73728
    s_add_u32 s32, s24, 384
    buffer_load_dwordx4 v243, s[4:7], s32 offen lds
    v_mfma_f32_32x32x16_bf16 v[144:159], a[68:71], v[4:7], v[144:159]
    ds_read_b64_tr_b16 a[92:93], v240 offset:14336
    ds_read_b64_tr_b16 a[94:95], v240 offset:14848
    buffer_load_dwordx4 v244, s[4:7], s32 offen offset:1024 lds
    v_rcp_f32 v234, v234
    v_mfma_f32_32x32x16_bf16 v[144:159], a[72:75], v[8:11], v[144:159]
    ds_read_b64_tr_b16 a[64:65], v240 offset:16384
    ds_read_b64_tr_b16 a[66:67], v240 offset:16896
    v_mul_f32 v234, v234, v122
    v_mul_f32 v232, v248, v128
    v_mul_f32 v233, v248, v129
    s_waitcnt lgkmcnt(6)
    v_mfma_f32_32x32x16_bf16 v[144:159], a[76:79], v[12:15], v[144:159]
    ds_read_b64_tr_b16 a[68:69], v240 offset:18432
    ds_read_b64_tr_b16 a[70:71], v240 offset:18944
    buffer_load_dwordx4 v245, s[4:7], s32 offen offset:2048 lds
    v_rcp_f32 v235, v235
    v_mfma_f32_32x32x16_bf16 v[144:159], a[80:83], v[16:19], v[144:159]
    ds_read_b64_tr_b16 a[72:73], v240 offset:20480
    ds_read_b64_tr_b16 a[74:75], v240 offset:20992
    buffer_load_dwordx4 v246, s[4:7], s32 offen offset:3072 lds
    v_rcp_f32 v236, v236
    v_mul_f32 v235, v235, v123
    v_mfma_f32_32x32x16_bf16 v[144:159], a[84:87], v[20:23], v[144:159]
    ds_read_b64_tr_b16 a[76:77], v240 offset:22528
    ds_read_b64_tr_b16 a[78:79], v240 offset:23040
    v_exp_f32 v237, v237
    v_cvt_pk_bf16_f32 v181, v234, v235
    s_waitcnt lgkmcnt(6)
    v_mfma_f32_32x32x16_bf16 v[144:159], a[88:91], v[24:27], v[144:159]
    ds_read_b64_tr_b16 a[80:81], v240 offset:24576
    ds_read_b64_tr_b16 a[82:83], v240 offset:25088
    s_add_u32 m0, s31, 73728
    s_cbranch_vccz L_x_16
    buffer_load_dwordx4 v247, s[4:7], s32 offen lds
L_x_16:
    v_mul_f32 v236, v236, v124
    v_mfma_f32_32x32x16_bf16 v[144:159], a[92:95], v[28:31], v[144:159]
    ds_read_b64_tr_b16 a[84:85], v240 offset:26624
    ds_read_b64_tr_b16 a[86:87], v240 offset:27136
    v_exp_f32 v238, v238
    v_fma_f32 v237, v237, v249, v249
    v_mul_f32 v234, v248, v130
    v_mfma_f32_32x32x16_bf16 v[144:159], a[64:67], v[32:35], v[144:159]
    ds_read_b64_tr_b16 a[88:89], v240 offset:28672
    ds_read_b64_tr_b16 a[90:91], v240 offset:29184
    s_add_u32 m0, s30, 92160
    s_add_u32 s32, s24, 1327488
    buffer_load_dwordx4 v243, s[4:7], s32 offen lds
    s_waitcnt lgkmcnt(6)
    v_mfma_f32_32x32x16_bf16 v[144:159], a[68:71], v[36:39], v[144:159]
    ds_read_b64_tr_b16 a[92:93], v240 offset:30720
    ds_read_b64_tr_b16 a[94:95], v240 offset:31232
    v_rcp_f32 v237, v237
    v_exp_f32 v239, v239
    v_mfma_f32_32x32x16_bf16 v[144:159], a[72:75], v[40:43], v[144:159]
    ds_read_b64_tr_b16 a[64:65], v240 offset:32768
    ds_read_b64_tr_b16 a[66:67], v240 offset:33280
    buffer_load_dwordx4 v244, s[4:7], s32 offen offset:1024 lds
    v_mul_f32 v237, v237, v125
    v_fma_f32 v238, v238, v249, v249
    v_fma_f32 v239, v239, v249, v249
    v_mfma_f32_32x32x16_bf16 v[144:159], a[76:79], v[44:47], v[144:159]
    ds_read_b64_tr_b16 a[68:69], v240 offset:34816
    ds_read_b64_tr_b16 a[70:71], v240 offset:35328
    v_rcp_f32 v238, v238
    v_cvt_pk_bf16_f32 v182, v236, v237
    s_waitcnt vmcnt(9) lgkmcnt(6)
    v_mfma_f32_32x32x16_bf16 v[144:159], a[80:83], v[48:51], v[144:159]
    s_barrier
    ds_read_b64_tr_b16 a[72:73], v240 offset:36864
    ds_read_b64_tr_b16 a[74:75], v240 offset:37376
    buffer_load_dwordx4 v245, s[4:7], s32 offen offset:2048 lds
    v_mul_f32 v238, v238, v126
    v_mul_f32 v235, v248, v131
    v_mfma_f32_32x32x16_bf16 v[144:159], a[84:87], v[52:55], v[144:159]
    ds_read_b64_tr_b16 a[76:77], v240 offset:38912
    ds_read_b64_tr_b16 a[78:79], v240 offset:39424
    buffer_load_dwordx4 v246, s[4:7], s32 offen offset:3072 lds
    v_rcp_f32 v239, v239
    v_mul_f32 v236, v248, v132
    v_mfma_f32_32x32x16_bf16 v[144:159], a[88:91], v[56:59], v[144:159]
    ds_read_b64_tr_b16 a[80:81], v240 offset:40960
    ds_read_b64_tr_b16 a[82:83], v240 offset:41472
    v_exp_f32 v232, v232
    v_mul_f32 v239, v239, v127
    s_waitcnt lgkmcnt(6)
    v_mfma_f32_32x32x16_bf16 v[144:159], a[92:95], v[60:63], v[144:159]
    ds_read_b64_tr_b16 a[84:85], v240 offset:43008
    ds_read_b64_tr_b16 a[86:87], v240 offset:43520
    s_add_u32 m0, s31, 92160
    s_cbranch_vccnz L_x_17
    buffer_load_dwordx4 v247, s[4:7], s32 offen lds
L_x_17:
    v_cvt_pk_bf16_f32 v183, v238, v239
    v_mfma_f32_32x32x16_bf16 v[144:159], a[64:67], v[64:67], v[144:159]
    ds_read_b64_tr_b16 a[88:89], v240 offset:45056
    ds_read_b64_tr_b16 a[90:91], v240 offset:45568
    buffer_store_dwordx4 v[180:183], v250, s[16:19], s34 offen offset:1024 sc1
    v_fma_f32 v232, v232, v249, v249
    v_mul_f32 v237, v248, v133
    v_mul_f32 v238, v248, v134
    v_mfma_f32_32x32x16_bf16 v[144:159], a[68:71], v[68:71], v[144:159]
    ds_read_b64_tr_b16 a[92:93], v240 offset:47104
    ds_read_b64_tr_b16 a[94:95], v240 offset:47616
    v_rcp_f32 v232, v232
    v_mul_f32 v239, v248, v135
    s_waitcnt lgkmcnt(6)
    v_mfma_f32_32x32x16_bf16 v[144:159], a[72:75], v[72:75], v[144:159]
    ds_read_b64_tr_b16 a[64:65], v240 offset:49152
    ds_read_b64_tr_b16 a[66:67], v240 offset:49664
    s_add_u32 m0, s30, 110592
    s_add_u32 s32, s24, 2654592
    buffer_load_dwordx4 v243, s[4:7], s32 offen lds
    v_mul_f32 v232, v232, v128
    v_mfma_f32_32x32x16_bf16 v[144:159], a[76:79], v[76:79], v[144:159]
    ds_read_b64_tr_b16 a[68:69], v240 offset:51200
    ds_read_b64_tr_b16 a[70:71], v240 offset:51712
    buffer_load_dwordx4 v244, s[4:7], s32 offen offset:1024 lds
    v_exp_f32 v233, v233
    v_mfma_f32_32x32x16_bf16 v[144:159], a[80:83], v[80:83], v[144:159]
    ds_read_b64_tr_b16 a[72:73], v240 offset:53248
    ds_read_b64_tr_b16 a[74:75], v240 offset:53760
    v_exp_f32 v234, v234
    v_fma_f32 v233, v233, v249, v249
    s_waitcnt lgkmcnt(6)
    v_mfma_f32_32x32x16_bf16 v[144:159], a[84:87], v[84:87], v[144:159]
    ds_read_b64_tr_b16 a[76:77], v240 offset:55296
    ds_read_b64_tr_b16 a[78:79], v240 offset:55808
    buffer_load_dwordx4 v245, s[4:7], s32 offen offset:2048 lds
    v_rcp_f32 v233, v233
    v_fma_f32 v234, v234, v249, v249
    v_mfma_f32_32x32x16_bf16 v[144:159], a[88:91], v[88:91], v[144:159]
    ds_read_b64_tr_b16 a[80:81], v240 offset:57344
    ds_read_b64_tr_b16 a[82:83], v240 offset:57856
    buffer_load_dwordx4 v246, s[4:7], s32 offen offset:3072 lds
    v_rcp_f32 v234, v234
    v_mul_f32 v233, v233, v129
    v_mfma_f32_32x32x16_bf16 v[144:159], a[92:95], v[92:95], v[144:159]
    ds_read_b64_tr_b16 a[84:85], v240 offset:59392
    ds_read_b64_tr_b16 a[86:87], v240 offset:59904
    v_exp_f32 v235, v235
    v_cvt_pk_bf16_f32 v184, v232, v233
    s_waitcnt lgkmcnt(6)
    v_mfma_f32_32x32x16_bf16 v[144:159], a[64:67], v[96:99], v[144:159]
    ds_read_b64_tr_b16 a[88:89], v240 offset:61440
    ds_read_b64_tr_b16 a[90:91], v240 offset:61952
    s_add_u32 m0, s31, 110592
    s_cbranch_vccz L_x_18
    buffer_load_dwordx4 v247, s[4:7], s32 offen lds
L_x_18:
    v_mul_f32 v234, v234, v130
    v_mfma_f32_32x32x16_bf16 v[144:159], a[68:71], v[100:103], v[144:159]
    ds_read_b64_tr_b16 a[92:93], v240 offset:63488
    ds_read_b64_tr_b16 a[94:95], v240 offset:64000
    v_exp_f32 v236, v236
    v_fma_f32 v235, v235, v249, v249
    v_mul_f32 v232, v248, v136
    v_mfma_f32_32x32x16_bf16 v[144:159], a[72:75], v[104:107], v[144:159]
    v_add_u32 v240, 55296, v240
    ds_read_b64_tr_b16 a[64:65], v240 offset:10240
    ds_read_b64_tr_b16 a[66:67], v240 offset:10752
    s_add_u32 m0, s30, 129024
    s_add_u32 s32, s24, 3981696
    buffer_load_dwordx4 v243, s[4:7], s32 offen lds
    s_waitcnt lgkmcnt(6)
    v_mfma_f32_32x32x16_bf16 v[144:159], a[76:79], v[108:111], v[144:159]
    ds_read_b64_tr_b16 a[68:69], v240 offset:12288
    ds_read_b64_tr_b16 a[70:71], v240 offset:12800
    v_rcp_f32 v235, v235
    v_exp_f32 v237, v237
    v_mfma_f32_32x32x16_bf16 v[144:159], a[80:83], a[0:3], v[144:159]
    ds_read_b64_tr_b16 a[72:73], v240 offset:14336
    ds_read_b64_tr_b16 a[74:75], v240 offset:14848
    buffer_load_dwordx4 v244, s[4:7], s32 offen offset:1024 lds
    v_mul_f32 v235, v235, v131
    v_fma_f32 v236, v236, v249, v249
    v_fma_f32 v237, v237, v249, v249
    v_mfma_f32_32x32x16_bf16 v[144:159], a[84:87], a[4:7], v[144:159]
    ds_read_b64_tr_b16 a[76:77], v240 offset:16384
    ds_read_b64_tr_b16 a[78:79], v240 offset:16896
    v_rcp_f32 v236, v236
    v_cvt_pk_bf16_f32 v185, v234, v235
    s_waitcnt lgkmcnt(6)
    v_mfma_f32_32x32x16_bf16 v[144:159], a[88:91], a[8:11], v[144:159]
    v_add_u32 v241, 4294856704, v241
    ds_read_b64_tr_b16 a[80:81], v241 offset:0
    ds_read_b64_tr_b16 a[82:83], v241 offset:512
    buffer_load_dwordx4 v245, s[4:7], s32 offen offset:2048 lds
    v_mul_f32 v236, v236, v132
    v_mul_f32 v233, v248, v137
    v_mul_f32 v234, v248, v138
    v_mfma_f32_32x32x16_bf16 v[144:159], a[92:95], a[12:15], v[144:159]
    ds_read_b64_tr_b16 a[84:85], v241 offset:2048
    ds_read_b64_tr_b16 a[86:87], v241 offset:2560
    buffer_load_dwordx4 v246, s[4:7], s32 offen offset:3072 lds
    s_cmp_eq_u32 s20, 0
    s_cbranch_scc0 L_cnt_19
    v_accvgpr_read_b32 v254, a252
    v_mul_lo_u32 v254, v254, s50
    v_add_u32 v254, 0x7f4a7c15, v254
    s_lshl_b32 s40, s2, 4
    s_add_u32 s40, s40, 54923264
    s_mov_b64 exec, 1
    buffer_store_dword v254, v251, s[16:19], s40 offen sc1
    s_mov_b64 exec, -1
L_cnt_19:
    v_mul_f32 v235, v248, v139
    v_mfma_f32_32x32x16_bf16 v[144:159], a[64:67], a[16:19], v[144:159]
    ds_read_b64_tr_b16 a[88:89], v241 offset:4096
    ds_read_b64_tr_b16 a[90:91], v241 offset:4608
    v_rcp_f32 v237, v237
    s_waitcnt lgkmcnt(6)
    v_mfma_f32_32x32x16_bf16 v[144:159], a[68:71], a[20:23], v[144:159]
    ds_read_b64_tr_b16 a[92:93], v241 offset:6144
    ds_read_b64_tr_b16 a[94:95], v241 offset:6656
    s_add_u32 m0, s31, 129024
    s_cbranch_vccnz L_x_20
    buffer_load_dwordx4 v247, s[4:7], s32 offen lds
L_x_20:
    v_mul_f32 v237, v237, v133
    v_mfma_f32_32x32x16_bf16 v[144:159], a[72:75], a[24:27], v[144:159]
    ds_read_b64_tr_b16 a[64:65], v241 offset:8192
    ds_read_b64_tr_b16 a[66:67], v241 offset:8704
    v_exp_f32 v238, v238
    v_exp_f32 v239, v239
    v_mfma_f32_32x32x16_bf16 v[144:159], a[76:79], a[28:31], v[144:159]
    ds_read_b64_tr_b16 a[68:69], v241 offset:10240
    ds_read_b64_tr_b16 a[70:71], v241 offset:10752
    v_cvt_pk_bf16_f32 v186, v236, v237
    v_fma_f32 v238, v238, v249, v249
    v_fma_f32 v239, v239, v249, v249
    s_waitcnt lgkmcnt(6)
    v_mfma_f32_32x32x16_bf16 v[112:127], a[80:83], v[0:3], 0
    ds_read_b64_tr_b16 a[72:73], v241 offset:12288
    ds_read_b64_tr_b16 a[74:75], v241 offset:12800
    v_rcp_f32 v238, v238
    v_rcp_f32 v239, v239
    v_mfma_f32_32x32x16_bf16 v[112:127], a[84:87], v[4:7], v[112:127]
    ds_read_b64_tr_b16 a[76:77], v241 offset:14336
    ds_read_b64_tr_b16 a[78:79], v241 offset:14848
    v_mul_f32 v238, v238, v134
    v_mul_f32 v239, v239, v135
    v_mul_f32 v236, v248, v140
    v_mul_f32 v237, v248, v141
    v_mfma_f32_32x32x16_bf16 v[112:127], a[88:91], v[8:11], v[112:127]
    ds_read_b64_tr_b16 a[80:81], v241 offset:16384
    ds_read_b64_tr_b16 a[82:83], v241 offset:16896
    v_exp_f32 v232, v232
    v_cvt_pk_bf16_f32 v187, v238, v239
    s_waitcnt lgkmcnt(6)
    v_mfma_f32_32x32x16_bf16 v[112:127], a[92:95], v[12:15], v[112:127]
    ds_read_b64_tr_b16 a[84:85], v241 offset:18432
    ds_read_b64_tr_b16 a[86:87], v241 offset:18944
    buffer_store_dwordx4 v[184:187], v250, s[16:19], s34 offen offset:2048 sc1
    v_fma_f32 v232, v232, v249, v249
    v_mul_f32 v238, v248, v142
    v_mul_f32 v239, v248, v143
    v_mfma_f32_32x32x16_bf16 v[112:127], a[64:67], v[16:19], v[112:127]
    ds_read_b64_tr_b16 a[88:89], v241 offset:20480
    ds_read_b64_tr_b16 a[90:91], v241 offset:20992
    v_rcp_f32 v232, v232
    v_exp_f32 v233, v233
    v_mfma_f32_32x32x16_bf16 v[112:127], a[68:71], v[20:23], v[112:127]
    ds_read_b64_tr_b16 a[92:93], v241 offset:22528
    ds_read_b64_tr_b16 a[94:95], v241 offset:23040
    v_exp_f32 v234, v234
    v_mul_f32 v232, v232, v136
    s_waitcnt lgkmcnt(6)
    v_mfma_f32_32x32x16_bf16 v[112:127], a[72:75], v[24:27], v[112:127]
    ds_read_b64_tr_b16 a[64:65], v241 offset:24576
    ds_read_b64_tr_b16 a[66:67], v241 offset:25088
    v_exp_f32 v235, v235
    v_exp_f32 v236, v236
    v_mfma_f32_32x32x16_bf16 v[112:127], a[76:79], v[28:31], v[112:127]
    ds_read_b64_tr_b16 a[68:69], v241 offset:26624
    ds_read_b64_tr_b16 a[70:71], v241 offset:27136
    v_fma_f32 v233, v233, v249, v249
    v_fma_f32 v234, v234, v249, v249
    v_fma_f32 v235, v235, v249, v249
    v_fma_f32 v236, v236, v249, v249
    v_mfma_f32_32x32x16_bf16 v[112:127], a[80:83], v[32:35], v[112:127]
    ds_read_b64_tr_b16 a[72:73], v241 offset:28672
    ds_read_b64_tr_b16 a[74:75], v241 offset:29184
    v_rcp_f32 v233, v233
    s_waitcnt lgkmcnt(6)
    v_mfma_f32_32x32x16_bf16 v[112:127], a[84:87], v[36:39], v[112:127]
    ds_read_b64_tr_b16 a[76:77], v241 offset:30720
    ds_read_b64_tr_b16 a[78:79], v241 offset:31232
    v_rcp_f32 v234, v234
    v_rcp_f32 v235, v235
    v_mfma_f32_32x32x16_bf16 v[112:127], a[88:91], v[40:43], v[112:127]
    ds_read_b64_tr_b16 a[80:81], v241 offset:32768
    ds_read_b64_tr_b16 a[82:83], v241 offset:33280
    v_rcp_f32 v236, v236
    v_mul_f32 v233, v233, v137
    v_mul_f32 v234, v234, v138
    v_mfma_f32_32x32x16_bf16 v[112:127], a[92:95], v[44:47], v[112:127]
    ds_read_b64_tr_b16 a[84:85], v241 offset:34816
    ds_read_b64_tr_b16 a[86:87], v241 offset:35328
    v_cvt_pk_bf16_f32 v188, v232, v233
    v_mul_f32 v235, v235, v139
    v_mul_f32 v236, v236, v140
    s_waitcnt lgkmcnt(6)
    v_mfma_f32_32x32x16_bf16 v[112:127], a[64:67], v[48:51], v[112:127]
    ds_read_b64_tr_b16 a[88:89], v241 offset:36864
    ds_read_b64_tr_b16 a[90:91], v241 offset:37376
    v_exp_f32 v237, v237
    v_cvt_pk_bf16_f32 v189, v234, v235
    v_mul_f32 v232, v248, v144
    v_mfma_f32_32x32x16_bf16 v[112:127], a[68:71], v[52:55], v[112:127]
    ds_read_b64_tr_b16 a[92:93], v241 offset:38912
    ds_read_b64_tr_b16 a[94:95], v241 offset:39424
    v_exp_f32 v238, v238
    v_fma_f32 v237, v237, v249, v249
    v_mul_f32 v233, v248, v145
    v_mfma_f32_32x32x16_bf16 v[112:127], a[72:75], v[56:59], v[112:127]
    ds_read_b64_tr_b16 a[64:65], v241 offset:40960
    ds_read_b64_tr_b16 a[66:67], v241 offset:41472
    v_fma_f32 v238, v238, v249, v249
    v_mul_f32 v234, v248, v146
    v_mul_f32 v235, v248, v147
    s_waitcnt lgkmcnt(6)
    v_mfma_f32_32x32x16_bf16 v[112:127], a[76:79], v[60:63], v[112:127]
    ds_read_b64_tr_b16 a[68:69], v241 offset:43008
    ds_read_b64_tr_b16 a[70:71], v241 offset:43520
    v_rcp_f32 v237, v237
    v_rcp_f32 v238, v238
    v_mfma_f32_32x32x16_bf16 v[112:127], a[80:83], v[64:67], v[112:127]
    ds_read_b64_tr_b16 a[72:73], v241 offset:45056
    ds_read_b64_tr_b16 a[74:75], v241 offset:45568
    v_exp_f32 v239, v239
    v_exp_f32 v232, v232
    v_mfma_f32_32x32x16_bf16 v[112:127], a[84:87], v[68:71], v[112:127]
    ds_read_b64_tr_b16 a[76:77], v241 offset:47104
    ds_read_b64_tr_b16 a[78:79], v241 offset:47616
    v_mul_f32 v237, v237, v141
    v_mul_f32 v238, v238, v142
    v_fma_f32 v239, v239, v249, v249
    s_waitcnt lgkmcnt(6)
    v_mfma_f32_32x32x16_bf16 v[112:127], a[88:91], v[72:75], v[112:127]
    ds_read_b64_tr_b16 a[80:81], v241 offset:49152
    ds_read_b64_tr_b16 a[82:83], v241 offset:49664
    v_rcp_f32 v239, v239
    v_exp_f32 v233, v233
    v_mfma_f32_32x32x16_bf16 v[112:127], a[92:95], v[76:79], v[112:127]
    ds_read_b64_tr_b16 a[84:85], v241 offset:51200
    ds_read_b64_tr_b16 a[86:87], v241 offset:51712
    v_cvt_pk_bf16_f32 v190, v236, v237
    v_mul_f32 v239, v239, v143
    v_fma_f32 v232, v232, v249, v249
    v_fma_f32 v233, v233, v249, v249
    v_mfma_f32_32x32x16_bf16 v[112:127], a[64:67], v[80:83], v[112:127]
    ds_read_b64_tr_b16 a[88:89], v241 offset:53248
    ds_read_b64_tr_b16 a[90:91], v241 offset:53760
    v_cvt_pk_bf16_f32 v191, v238, v239
    v_mul_f32 v236, v248, v148
    v_mul_f32 v237, v248, v149
    s_waitcnt lgkmcnt(6)
    v_mfma_f32_32x32x16_bf16 v[112:127], a[68:71], v[84:87], v[112:127]
    ds_read_b64_tr_b16 a[92:93], v241 offset:55296
    ds_read_b64_tr_b16 a[94:95], v241 offset:55808
    buffer_store_dwordx4 v[188:191], v250, s[16:19], s34 offen offset:3072 sc1
    v_rcp_f32 v232, v232
    v_mul_f32 v238, v248, v150
    v_mfma_f32_32x32x16_bf16 v[112:127], a[72:75], v[88:91], v[112:127]
    ds_read_b64_tr_b16 a[64:65], v241 offset:57344
    ds_read_b64_tr_b16 a[66:67], v241 offset:57856
    v_rcp_f32 v233, v233
    v_exp_f32 v234, v234
    v_mfma_f32_32x32x16_bf16 v[112:127], a[76:79], v[92:95], v[112:127]
    ds_read_b64_tr_b16 a[68:69], v241 offset:59392
    ds_read_b64_tr_b16 a[70:71], v241 offset:59904
    v_mul_f32 v232, v232, v144
    v_mul_f32 v233, v233, v145
    v_fma_f32 v234, v234, v249, v249
    s_waitcnt lgkmcnt(6)
    v_mfma_f32_32x32x16_bf16 v[112:127], a[80:83], v[96:99], v[112:127]
    ds_read_b64_tr_b16 a[72:73], v241 offset:61440
    ds_read_b64_tr_b16 a[74:75], v241 offset:61952
    v_rcp_f32 v234, v234
    v_exp_f32 v235, v235
    v_mfma_f32_32x32x16_bf16 v[112:127], a[84:87], v[100:103], v[112:127]
    ds_read_b64_tr_b16 a[76:77], v241 offset:63488
    ds_read_b64_tr_b16 a[78:79], v241 offset:64000
    v_cvt_pk_bf16_f32 v192, v232, v233
    v_mul_f32 v234, v234, v146
    v_fma_f32 v235, v235, v249, v249
    v_mul_f32 v239, v248, v151
    v_mfma_f32_32x32x16_bf16 v[112:127], a[88:91], v[104:107], v[112:127]
    v_add_u32 v241, 55296, v241
    ds_read_b64_tr_b16 a[80:81], v241 offset:10240
    ds_read_b64_tr_b16 a[82:83], v241 offset:10752
    v_rcp_f32 v235, v235
    v_mul_f32 v232, v248, v152
    s_waitcnt lgkmcnt(6)
    v_mfma_f32_32x32x16_bf16 v[112:127], a[92:95], v[108:111], v[112:127]
    ds_read_b64_tr_b16 a[84:85], v241 offset:12288
    ds_read_b64_tr_b16 a[86:87], v241 offset:12800
    v_exp_f32 v236, v236
    v_exp_f32 v237, v237
    v_mfma_f32_32x32x16_bf16 v[112:127], a[64:67], a[0:3], v[112:127]
    ds_read_b64_tr_b16 a[88:89], v241 offset:14336
    ds_read_b64_tr_b16 a[90:91], v241 offset:14848
    v_mul_f32 v235, v235, v147
    v_fma_f32 v236, v236, v249, v249
    v_fma_f32 v237, v237, v249, v249
    v_mul_f32 v233, v248, v153
    v_mfma_f32_32x32x16_bf16 v[112:127], a[68:71], a[4:7], v[112:127]
    ds_read_b64_tr_b16 a[92:93], v241 offset:16384
    ds_read_b64_tr_b16 a[94:95], v241 offset:16896
    v_rcp_f32 v236, v236
    v_cvt_pk_bf16_f32 v193, v234, v235
    s_waitcnt vmcnt(12) lgkmcnt(6)
    v_mfma_f32_32x32x16_bf16 v[112:127], a[72:75], a[8:11], v[112:127]
    s_barrier
    ds_read_b64_tr_b16 a[64:65], v240 offset:18432
    ds_read_b64_tr_b16 a[66:67], v240 offset:18944
    v_mul_f32 v236, v236, v148
    v_mul_f32 v234, v248, v154
    v_mul_f32 v235, v248, v155
    v_mfma_f32_32x32x16_bf16 v[112:127], a[76:79], a[12:15], v[112:127]
    ds_read_b64_tr_b16 a[68:69], v240 offset:20480
    ds_read_b64_tr_b16 a[70:71], v240 offset:20992
    v_rcp_f32 v237, v237
    v_exp_f32 v238, v238
    v_mfma_f32_32x32x16_bf16 v[112:127], a[80:83], a[16:19], v[112:127]
    ds_read_b64_tr_b16 a[72:73], v240 offset:22528
    ds_read_b64_tr_b16 a[74:75], v240 offset:23040
    v_exp_f32 v239, v239
    v_mul_f32 v237, v237, v149
    s_waitcnt lgkmcnt(6)
    v_mfma_f32_32x32x16_bf16 v[112:127], a[84:87], a[20:23], v[112:127]
    ds_read_b64_tr_b16 a[76:77], v240 offset:24576
    ds_read_b64_tr_b16 a[78:79], v240 offset:25088
    v_exp_f32 v232, v232
    v_cvt_pk_bf16_f32 v194, v236, v237
    v_fma_f32 v238, v238, v249, v249
    v_mfma_f32_32x32x16_bf16 v[112:127], a[88:91], a[24:27], v[112:127]
    ds_read_b64_tr_b16 a[80:81], v240 offset:26624
    ds_read_b64_tr_b16 a[82:83], v240 offset:27136
    v_fma_f32 v239, v239, v249, v249
    v_fma_f32 v232, v232, v249, v249
    v_mul_f32 v236, v248, v156
    v_mul_f32 v237, v248, v157
    v_mfma_f32_32x32x16_bf16 v[112:127], a[92:95], a[28:31], v[112:127]
    ds_read_b64_tr_b16 a[84:85], v240 offset:28672
    ds_read_b64_tr_b16 a[86:87], v240 offset:29184
    v_rcp_f32 v238, v238
    s_waitcnt lgkmcnt(6)
    v_mfma_f32_32x32x16_bf16 v[128:143], a[64:67], v[0:3], 0
    ds_read_b64_tr_b16 a[88:89], v240 offset:30720
    ds_read_b64_tr_b16 a[90:91], v240 offset:31232
    v_accvgpr_read_b32 v243, a32
    v_accvgpr_read_b32 v244, a33
    v_accvgpr_read_b32 v245, a34
    v_accvgpr_read_b32 v246, a35
    v_accvgpr_read_b32 v247, a36
    s_add_u32 m0, s30, 0
    s_add_u32 s32, s25, 0
    buffer_load_dwordx4 v243, s[4:7], s32 offen lds
    v_mfma_f32_32x32x16_bf16 v[128:143], a[68:71], v[4:7], v[128:143]
    ds_read_b64_tr_b16 a[92:93], v240 offset:32768
    ds_read_b64_tr_b16 a[94:95], v240 offset:33280
    buffer_load_dwordx4 v244, s[4:7], s32 offen offset:1024 lds
    v_rcp_f32 v239, v239
    v_mul_f32 v238, v238, v150
    v_mfma_f32_32x32x16_bf16 v[128:143], a[72:75], v[8:11], v[128:143]
    ds_read_b64_tr_b16 a[64:65], v240 offset:34816
    ds_read_b64_tr_b16 a[66:67], v240 offset:35328
    v_rcp_f32 v232, v232
    v_mul_f32 v239, v239, v151
    s_waitcnt lgkmcnt(6)
    v_mfma_f32_32x32x16_bf16 v[128:143], a[76:79], v[12:15], v[128:143]
    ds_read_b64_tr_b16 a[68:69], v240 offset:36864
    ds_read_b64_tr_b16 a[70:71], v240 offset:37376
    buffer_load_dwordx4 v245, s[4:7], s32 offen offset:2048 lds
    v_exp_f32 v233, v233
    v_cvt_pk_bf16_f32 v195, v238, v239
    v_mfma_f32_32x32x16_bf16 v[128:143], a[80:83], v[16:19], v[128:143]
    ds_read_b64_tr_b16 a[72:73], v240 offset:38912
    ds_read_b64_tr_b16 a[74:75], v240 offset:39424
    buffer_load_dwordx4 v246, s[4:7], s32 offen offset:3072 lds
    v_mul_f32 v232, v232, v152
    v_fma_f32 v233, v233, v249, v249
    v_mul_f32 v238, v248, v158
    v_mfma_f32_32x32x16_bf16 v[128:143], a[84:87], v[20:23], v[128:143]
    ds_read_b64_tr_b16 a[76:77], v240 offset:40960
    ds_read_b64_tr_b16 a[78:79], v240 offset:41472
    s_add_u32 s34, s34, 4096
    buffer_store_dwordx4 v[192:195], v250, s[16:19], s34 offen offset:0 sc1
    v_mul_f32 v239, v248, v159
    s_waitcnt lgkmcnt(6)
    v_mfma_f32_32x32x16_bf16 v[128:143], a[88:91], v[24:27], v[128:143]
    ds_read_b64_tr_b16 a[80:81], v240 offset:43008
    ds_read_b64_tr_b16 a[82:83], v240 offset:43520
    s_add_u32 m0, s31, 0
    s_cbranch_vccz L_x_21
    buffer_load_dwordx4 v247, s[4:7], s32 offen lds
L_x_21:
    v_mfma_f32_32x32x16_bf16 v[128:143], a[92:95], v[28:31], v[128:143]
    ds_read_b64_tr_b16 a[84:85], v240 offset:45056
    ds_read_b64_tr_b16 a[86:87], v240 offset:45568
    v_rcp_f32 v233, v233
    v_exp_f32 v234, v234
    v_mfma_f32_32x32x16_bf16 v[128:143], a[64:67], v[32:35], v[128:143]
    ds_read_b64_tr_b16 a[88:89], v240 offset:47104
    ds_read_b64_tr_b16 a[90:91], v240 offset:47616
    s_add_u32 m0, s30, 18432
    s_add_u32 s32, s25, 2654208
    buffer_load_dwordx4 v243, s[4:7], s32 offen lds
    s_waitcnt lgkmcnt(6)
    v_mfma_f32_32x32x16_bf16 v[128:143], a[68:71], v[36:39], v[128:143]
    ds_read_b64_tr_b16 a[92:93], v240 offset:49152
    ds_read_b64_tr_b16 a[94:95], v240 offset:49664
    v_exp_f32 v235, v235
    v_exp_f32 v236, v236
    v_mfma_f32_32x32x16_bf16 v[128:143], a[72:75], v[40:43], v[128:143]
    ds_read_b64_tr_b16 a[64:65], v240 offset:51200
    ds_read_b64_tr_b16 a[66:67], v240 offset:51712
    buffer_load_dwordx4 v244, s[4:7], s32 offen offset:1024 lds
    v_mul_f32 v233, v233, v153
    v_fma_f32 v234, v234, v249, v249
    v_fma_f32 v235, v235, v249, v249
    v_mfma_f32_32x32x16_bf16 v[128:143], a[76:79], v[44:47], v[128:143]
    ds_read_b64_tr_b16 a[68:69], v240 offset:53248
    ds_read_b64_tr_b16 a[70:71], v240 offset:53760
    v_rcp_f32 v234, v234
    v_cvt_pk_bf16_f32 v196, v232, v233
    s_waitcnt vmcnt(9) lgkmcnt(6)
    v_mfma_f32_32x32x16_bf16 v[128:143], a[80:83], v[48:51], v[128:143]
    s_barrier
    ds_read_b64_tr_b16 a[72:73], v240 offset:55296
    ds_read_b64_tr_b16 a[74:75], v240 offset:55808
    buffer_load_dwordx4 v245, s[4:7], s32 offen offset:2048 lds
    v_mul_f32 v234, v234, v154
    v_fma_f32 v236, v236, v249, v249
    v_mfma_f32_32x32x16_bf16 v[128:143], a[84:87], v[52:55], v[128:143]
    ds_read_b64_tr_b16 a[76:77], v240 offset:57344
    ds_read_b64_tr_b16 a[78:79], v240 offset:57856
    buffer_load_dwordx4 v246, s[4:7], s32 offen offset:3072 lds
    v_rcp_f32 v235, v235
    v_mul_f32 v232, v248, v112
    v_mfma_f32_32x32x16_bf16 v[128:143], a[88:91], v[56:59], v[128:143]
    ds_read_b64_tr_b16 a[80:81], v240 offset:59392
    ds_read_b64_tr_b16 a[82:83], v240 offset:59904
    v_rcp_f32 v236, v236
    v_mul_f32 v235, v235, v155
    s_waitcnt lgkmcnt(6)
    v_mfma_f32_32x32x16_bf16 v[128:143], a[92:95], v[60:63], v[128:143]
    ds_read_b64_tr_b16 a[84:85], v240 offset:61440
    ds_read_b64_tr_b16 a[86:87], v240 offset:61952
    s_add_u32 m0, s31, 18432
    s_cbranch_vccnz L_x_22
    buffer_load_dwordx4 v247, s[4:7], s32 offen lds
L_x_22:
    v_cvt_pk_bf16_f32 v197, v234, v235
    v_mfma_f32_32x32x16_bf16 v[128:143], a[64:67], v[64:67], v[128:143]
    ds_read_b64_tr_b16 a[88:89], v240 offset:63488
    ds_read_b64_tr_b16 a[90:91], v240 offset:64000
    v_exp_f32 v237, v237
    v_mul_f32 v236, v236, v156
    v_mul_f32 v233, v248, v113
    v_mfma_f32_32x32x16_bf16 v[128:143], a[68:71], v[68:71], v[128:143]
    v_add_u32 v240, 55296, v240
    ds_read_b64_tr_b16 a[92:93], v240 offset:10240
    ds_read_b64_tr_b16 a[94:95], v240 offset:10752
    v_fma_f32 v237, v237, v249, v249
    v_mul_f32 v234, v248, v114
    v_mul_f32 v235, v248, v115
    s_waitcnt lgkmcnt(6)
    v_mfma_f32_32x32x16_bf16 v[128:143], a[72:75], v[72:75], v[128:143]
    ds_read_b64_tr_b16 a[64:65], v240 offset:12288
    ds_read_b64_tr_b16 a[66:67], v240 offset:12800
    v_accvgpr_read_b32 v243, a37
    v_accvgpr_read_b32 v244, a38
    v_accvgpr_read_b32 v245, a39
    v_accvgpr_read_b32 v246, a40
    v_accvgpr_read_b32 v247, a41
    s_add_u32 m0, s30, 36864
    s_add_u32 s32, s26, 0
    buffer_load_dwordx4 v243, s[8:11], s32 offen lds
    v_mfma_f32_32x32x16_bf16 v[128:143], a[76:79], v[76:79], v[128:143]
    ds_read_b64_tr_b16 a[68:69], v240 offset:14336
    ds_read_b64_tr_b16 a[70:71], v240 offset:14848
    buffer_load_dwordx4 v244, s[8:11], s32 offen offset:1024 lds
    v_rcp_f32 v237, v237
    v_mfma_f32_32x32x16_bf16 v[128:143], a[80:83], v[80:83], v[128:143]
    ds_read_b64_tr_b16 a[72:73], v240 offset:16384
    ds_read_b64_tr_b16 a[74:75], v240 offset:16896
    v_exp_f32 v238, v238
    v_mul_f32 v237, v237, v157
    s_waitcnt lgkmcnt(6)
    v_mfma_f32_32x32x16_bf16 v[128:143], a[84:87], v[84:87], v[128:143]
    ds_read_b64_tr_b16 a[76:77], v240 offset:18432
    ds_read_b64_tr_b16 a[78:79], v240 offset:18944
    buffer_load_dwordx4 v245, s[8:11], s32 offen offset:2048 lds
    v_exp_f32 v239, v239
    v_cvt_pk_bf16_f32 v198, v236, v237
    v_mfma_f32_32x32x16_bf16 v[128:143], a[88:91], v[88:91], v[128:143]
    ds_read_b64_tr_b16 a[80:81], v240 offset:20480
    ds_read_b64_tr_b16 a[82:83], v240 offset:20992
    buffer_load_dwordx4 v246, s[8:11], s32 offen offset:3072 lds
    v_fma_f32 v238, v238, v249, v249
    v_fma_f32 v239, v239, v249, v249
    v_mul_f32 v236, v248, v116
    v_mfma_f32_32x32x16_bf16 v[128:143], a[92:95], v[92:95], v[128:143]
    ds_read_b64_tr_b16 a[84:85], v240 offset:22528
    ds_read_b64_tr_b16 a[86:87], v240 offset:23040
    v_rcp_f32 v238, v238
    v_mul_f32 v237, v248, v117
    s_waitcnt lgkmcnt(6)
    v_mfma_f32_32x32x16_bf16 v[128:143], a[64:67], v[96:99], v[128:143]
    ds_read_b64_tr_b16 a[88:89], v240 offset:24576
    ds_read_b64_tr_b16 a[90:91], v240 offset:25088
    s_add_u32 m0, s31, 36864
    s_cbranch_vccz L_x_23
    buffer_load_dwordx4 v247, s[8:11], s32 offen lds
L_x_23:
    v_mul_f32 v238, v238, v158
    v_mfma_f32_32x32x16_bf16 v[128:143], a[68:71], v[100:103], v[128:143]
    ds_read_b64_tr_b16 a[92:93], v240 offset:26624
    ds_read_b64_tr_b16 a[94:95], v240 offset:27136
    v_rcp_f32 v239, v239
    v_exp_f32 v232, v232
    v_mfma_f32_32x32x16_bf16 v[128:143], a[72:75], v[104:107], v[128:143]
    ds_read_b64_tr_b16 a[64:65], v240 offset:28672
    ds_read_b64_tr_b16 a[66:67], v240 offset:29184
    s_add_u32 m0, s30, 55296
    s_add_u32 s32, s26, 36864
    buffer_load_dwordx4 v243, s[8:11], s32 offen lds
    s_waitcnt lgkmcnt(6)
    v_mfma_f32_32x32x16_bf16 v[128:143], a[76:79], v[108:111], v[128:143]
    ds_read_b64_tr_b16 a[68:69], v240 offset:30720
    ds_read_b64_tr_b16 a[70:71], v240 offset:31232
    v_exp_f32 v233, v233
    v_exp_f32 v234, v234
    v_mfma_f32_32x32x16_bf16 v[128:143], a[80:83], a[0:3], v[128:143]
    ds_read_b64_tr_b16 a[72:73], v240 offset:32768
    ds_read_b64_tr_b16 a[74:75], v240 offset:33280
    buffer_load_dwordx4 v244, s[8:11], s32 offen offset:1024 lds
    v_mul_f32 v239, v239, v159
    v_fma_f32 v232, v232, v249, v249
    v_fma_f32 v233, v233, v249, v249
    v_mfma_f32_32x32x16_bf16 v[128:143], a[84:87], a[4:7], v[128:143]
    ds_read_b64_tr_b16 a[76:77], v240 offset:34816
    ds_read_b64_tr_b16 a[78:79], v240 offset:35328
    v_rcp_f32 v232, v232
    v_cvt_pk_bf16_f32 v199, v238, v239
    s_waitcnt lgkmcnt(6)
    v_mfma_f32_32x32x16_bf16 v[128:143], a[88:91], a[8:11], v[128:143]
    ds_read_b64_tr_b16 a[80:81], v241 offset:18432
    ds_read_b64_tr_b16 a[82:83], v241 offset:18944
    buffer_load_dwordx4 v245, s[8:11], s32 offen offset:2048 lds
    buffer_store_dwordx4 v[196:199], v250, s[16:19], s34 offen offset:1024 sc1
    v_mul_f32 v232, v232, v112
    v_fma_f32 v234, v234, v249, v249
    v_mfma_f32_32x32x16_bf16 v[128:143], a[92:95], a[12:15], v[128:143]
    ds_read_b64_tr_b16 a[84:85], v241 offset:20480
    ds_read_b64_tr_b16 a[86:87], v241 offset:20992
    buffer_load_dwordx4 v246, s[8:11], s32 offen offset:3072 lds
    v_rcp_f32 v233, v233
    v_mul_f32 v238, v248, v118
    v_mfma_f32_32x32x16_bf16 v[128:143], a[64:67], a[16:19], v[128:143]
    ds_read_b64_tr_b16 a[88:89], v241 offset:22528
    ds_read_b64_tr_b16 a[90:91], v241 offset:23040
    v_rcp_f32 v234, v234
    v_mul_f32 v233, v233, v113
    s_waitcnt lgkmcnt(6)
    v_mfma_f32_32x32x16_bf16 v[128:143], a[68:71], a[20:23], v[128:143]
    ds_read_b64_tr_b16 a[92:93], v241 offset:24576
    ds_read_b64_tr_b16 a[94:95], v241 offset:25088
    s_add_u32 m0, s31, 55296
    s_cbranch_vccnz L_x_24
    buffer_load_dwordx4 v247, s[8:11], s32 offen lds
L_x_24:
    v_cvt_pk_bf16_f32 v200, v232, v233
    v_mfma_f32_32x32x16_bf16 v[128:143], a[72:75], a[24:27], v[128:143]
    ds_read_b64_tr_b16 a[64:65], v241 offset:26624
    ds_read_b64_tr_b16 a[66:67], v241 offset:27136
    v_exp_f32 v235, v235
    v_mul_f32 v234, v234, v114
    v_mul_f32 v239, v248, v119
    v_mfma_f32_32x32x16_bf16 v[128:143], a[76:79], a[28:31], v[128:143]
    ds_read_b64_tr_b16 a[68:69], v241 offset:28672
    ds_read_b64_tr_b16 a[70:71], v241 offset:29184
    v_fma_f32 v235, v235, v249, v249
    v_mul_f32 v232, v248, v120
    v_mul_f32 v233, v248, v121
    s_waitcnt lgkmcnt(6)
    v_mfma_f32_32x32x16_bf16 v[144:159], a[80:83], v[0:3], 0
    ds_read_b64_tr_b16 a[72:73], v241 offset:30720
    ds_read_b64_tr_b16 a[74:75], v241 offset:31232
    v_rcp_f32 v235, v235
    v_exp_f32 v236, v236
    v_mfma_f32_32x32x16_bf16 v[144:159], a[84:87], v[4:7], v[144:159]
    ds_read_b64_tr_b16 a[76:77], v241 offset:32768
    ds_read_b64_tr_b16 a[78:79], v241 offset:33280
    v_exp_f32 v237, v237
    v_exp_f32 v238, v238
    v_mfma_f32_32x32x16_bf16 v[144:159], a[88:91], v[8:11], v[144:159]
    ds_read_b64_tr_b16 a[80:81], v241 offset:34816
    ds_read_b64_tr_b16 a[82:83], v241 offset:35328
    v_mul_f32 v235, v235, v115
    v_fma_f32 v236, v236, v249, v249
    v_fma_f32 v237, v237, v249, v249
    s_waitcnt lgkmcnt(6)
    v_mfma_f32_32x32x16_bf16 v[144:159], a[92:95], v[12:15], v[144:159]
    ds_read_b64_tr_b16 a[84:85], v241 offset:36864
    ds_read_b64_tr_b16 a[86:87], v241 offset:37376
    v_rcp_f32 v236, v236
    v_rcp_f32 v237, v237
    v_mfma_f32_32x32x16_bf16 v[144:159], a[64:67], v[16:19], v[144:159]
    ds_read_b64_tr_b16 a[88:89], v241 offset:38912
    ds_read_b64_tr_b16 a[90:91], v241 offset:39424
    v_cvt_pk_bf16_f32 v201, v234, v235
    v_mul_f32 v236, v236, v116
    v_mul_f32 v237, v237, v117
    v_fma_f32 v238, v238, v249, v249
    v_mfma_f32_32x32x16_bf16 v[144:159], a[68:71], v[20:23], v[144:159]
    ds_read_b64_tr_b16 a[92:93], v241 offset:40960
    ds_read_b64_tr_b16 a[94:95], v241 offset:41472
    v_cvt_pk_bf16_f32 v202, v236, v237
    v_mul_f32 v234, v248, v122
    v_mul_f32 v235, v248, v123
    s_waitcnt lgkmcnt(6)
    v_mfma_f32_32x32x16_bf16 v[144:159], a[72:75], v[24:27], v[144:159]
    ds_read_b64_tr_b16 a[64:65], v241 offset:43008
    ds_read_b64_tr_b16 a[66:67], v241 offset:43520
    v_rcp_f32 v238, v238
    v_exp_f32 v239, v239
    v_mfma_f32_32x32x16_bf16 v[144:159], a[76:79], v[28:31], v[144:159]
    ds_read_b64_tr_b16 a[68:69], v241 offset:45056
    ds_read_b64_tr_b16 a[70:71], v241 offset:45568
    v_mul_f32 v238, v238, v118
    v_fma_f32 v239, v239, v249, v249
    v_mul_f32 v236, v248, v124
    v_mul_f32 v237, v248, v125
    v_mfma_f32_32x32x16_bf16 v[144:159], a[80:83], v[32:35], v[144:159]
    ds_read_b64_tr_b16 a[72:73], v241 offset:47104
    ds_read_b64_tr_b16 a[74:75], v241 offset:47616
    v_rcp_f32 v239, v239
    s_waitcnt lgkmcnt(6)
    v_mfma_f32_32x32x16_bf16 v[144:159], a[84:87], v[36:39], v[144:159]
    ds_read_b64_tr_b16 a[76:77], v241 offset:49152
    ds_read_b64_tr_b16 a[78:79], v241 offset:49664
    v_exp_f32 v232, v232
    v_exp_f32 v233, v233
    v_mfma_f32_32x32x16_bf16 v[144:159], a[88:91], v[40:43], v[144:159]
    ds_read_b64_tr_b16 a[80:81], v241 offset:51200
    ds_read_b64_tr_b16 a[82:83], v241 offset:51712
    v_exp_f32 v234, v234
    v_mul_f32 v239, v239, v119
    v_fma_f32 v232, v232, v249, v249
    v_mfma_f32_32x32x16_bf16 v[144:159], a[92:95], v[44:47], v[144:159]
    ds_read_b64_tr_b16 a[84:85], v241 offset:53248
    ds_read_b64_tr_b16 a[86:87], v241 offset:53760
    v_cvt_pk_bf16_f32 v203, v238, v239
    v_fma_f32 v233, v233, v249, v249
    v_fma_f32 v234, v234, v249, v249
    s_waitcnt lgkmcnt(6)
    v_mfma_f32_32x32x16_bf16 v[144:159], a[64:67], v[48:51], v[144:159]
    ds_read_b64_tr_b16 a[88:89], v241 offset:55296
    ds_read_b64_tr_b16 a[90:91], v241 offset:55808
    buffer_store_dwordx4 v[200:203], v250, s[16:19], s34 offen offset:2048 sc1
    v_rcp_f32 v232, v232
    v_mul_f32 v238, v248, v126
    v_mfma_f32_32x32x16_bf16 v[144:159], a[68:71], v[52:55], v[144:159]
    ds_read_b64_tr_b16 a[92:93], v241 offset:57344
    ds_read_b64_tr_b16 a[94:95], v241 offset:57856
    v_rcp_f32 v233, v233
    v_rcp_f32 v234, v234
    v_mfma_f32_32x32x16_bf16 v[144:159], a[72:75], v[56:59], v[144:159]
    ds_read_b64_tr_b16 a[64:65], v241 offset:59392
    ds_read_b64_tr_b16 a[66:67], v241 offset:59904
    v_mul_f32 v232, v232, v120
    v_mul_f32 v233, v233, v121
    v_mul_f32 v234, v234, v122
    s_waitcnt lgkmcnt(6)
    v_mfma_f32_32x32x16_bf16 v[144:159], a[76:79], v[60:63], v[144:159]
    ds_read_b64_tr_b16 a[68:69], v241 offset:61440
    ds_read_b64_tr_b16 a[70:71], v241 offset:61952
    v_exp_f32 v235, v235
    v_exp_f32 v236, v236
    v_mfma_f32_32x32x16_bf16 v[144:159], a[80:83], v[64:67], v[144:159]
    ds_read_b64_tr_b16 a[72:73], v241 offset:63488
    ds_read_b64_tr_b16 a[74:75], v241 offset:64000
    v_cvt_pk_bf16_f32 v204, v232, v233
    v_fma_f32 v235, v235, v249, v249
    v_fma_f32 v236, v236, v249, v249
    v_mul_f32 v239, v248, v127
    v_mfma_f32_32x32x16_bf16 v[144:159], a[84:87], v[68:71], v[144:159]
    v_add_u32 v241, 55296, v241
    ds_read_b64_tr_b16 a[76:77], v241 offset:10240
    ds_read_b64_tr_b16 a[78:79], v241 offset:10752
    v_rcp_f32 v235, v235
    v_mul_f32 v232, v248, v128
    s_waitcnt lgkmcnt(6)
    v_mfma_f32_32x32x16_bf16 v[144:159], a[88:91], v[72:75], v[144:159]
    ds_read_b64_tr_b16 a[80:81], v241 offset:12288
    ds_read_b64_tr_b16 a[82:83], v241 offset:12800
    v_rcp_f32 v236, v236
    v_exp_f32 v237, v237
    v_mfma_f32_32x32x16_bf16 v[144:159], a[92:95], v[76:79], v[144:159]
    ds_read_b64_tr_b16 a[84:85], v241 offset:14336
    ds_read_b64_tr_b16 a[86:87], v241 offset:14848
    v_mul_f32 v235, v235, v123
    v_mul_f32 v236, v236, v124
    v_fma_f32 v237, v237, v249, v249
    v_mul_f32 v233, v248, v129
    v_mfma_f32_32x32x16_bf16 v[144:159], a[64:67], v[80:83], v[144:159]
    ds_read_b64_tr_b16 a[88:89], v241 offset:16384
    ds_read_b64_tr_b16 a[90:91], v241 offset:16896
    v_rcp_f32 v237, v237
    v_cvt_pk_bf16_f32 v205, v234, v235
    s_waitcnt lgkmcnt(6)
    v_mfma_f32_32x32x16_bf16 v[144:159], a[68:71], v[84:87], v[144:159]
    ds_read_b64_tr_b16 a[92:93], v241 offset:18432
    ds_read_b64_tr_b16 a[94:95], v241 offset:18944
    v_exp_f32 v238, v238
    v_mul_f32 v237, v237, v125
    v_mul_f32 v234, v248, v130
    v_mfma_f32_32x32x16_bf16 v[144:159], a[72:75], v[88:91], v[144:159]
    ds_read_b64_tr_b16 a[64:65], v241 offset:20480
    ds_read_b64_tr_b16 a[66:67], v241 offset:20992
    v_exp_f32 v239, v239
    v_cvt_pk_bf16_f32 v206, v236, v237
    v_fma_f32 v238, v238, v249, v249
    v_mfma_f32_32x32x16_bf16 v[144:159], a[76:79], v[92:95], v[144:159]
    ds_read_b64_tr_b16 a[68:69], v241 offset:22528
    ds_read_b64_tr_b16 a[70:71], v241 offset:23040
    v_fma_f32 v239, v239, v249, v249
    v_mul_f32 v235, v248, v131
    v_mul_f32 v236, v248, v132
    s_waitcnt lgkmcnt(6)
    v_mfma_f32_32x32x16_bf16 v[144:159], a[80:83], v[96:99], v[144:159]
    ds_read_b64_tr_b16 a[72:73], v241 offset:24576
    ds_read_b64_tr_b16 a[74:75], v241 offset:25088
    v_rcp_f32 v238, v238
    v_rcp_f32 v239, v239
    v_mfma_f32_32x32x16_bf16 v[144:159], a[84:87], v[100:103], v[144:159]
    ds_read_b64_tr_b16 a[76:77], v241 offset:26624
    ds_read_b64_tr_b16 a[78:79], v241 offset:27136
    v_exp_f32 v232, v232
    v_mul_f32 v238, v238, v126
    v_mul_f32 v239, v239, v127
    v_mfma_f32_32x32x16_bf16 v[144:159], a[88:91], v[104:107], v[144:159]
    ds_read_b64_tr_b16 a[80:81], v241 offset:28672
    ds_read_b64_tr_b16 a[82:83], v241 offset:29184
    v_cvt_pk_bf16_f32 v207, v238, v239
    v_fma_f32 v232, v232, v249, v249
    v_mul_f32 v237, v248, v133
    s_waitcnt lgkmcnt(6)
    v_mfma_f32_32x32x16_bf16 v[144:159], a[92:95], v[108:111], v[144:159]
    ds_read_b64_tr_b16 a[84:85], v241 offset:30720
    ds_read_b64_tr_b16 a[86:87], v241 offset:31232
    buffer_store_dwordx4 v[204:207], v250, s[16:19], s34 offen offset:3072 sc1
    v_rcp_f32 v232, v232
    v_mul_f32 v238, v248, v134
    v_mfma_f32_32x32x16_bf16 v[144:159], a[64:67], a[0:3], v[144:159]
    ds_read_b64_tr_b16 a[88:89], v241 offset:32768
    ds_read_b64_tr_b16 a[90:91], v241 offset:33280
    v_exp_f32 v233, v233
    v_exp_f32 v234, v234
    v_mfma_f32_32x32x16_bf16 v[144:159], a[68:71], a[4:7], v[144:159]
    ds_read_b64_tr_b16 a[92:93], v241 offset:34816
    ds_read_b64_tr_b16 a[94:95], v241 offset:35328
    v_mul_f32 v232, v232, v128
    v_fma_f32 v233, v233, v249, v249
    v_fma_f32 v234, v234, v249, v249
    s_waitcnt vmcnt(16) lgkmcnt(6)
    v_mfma_f32_32x32x16_bf16 v[144:159], a[72:75], a[8:11], v[144:159]
    s_barrier
    ds_read_b64_tr_b16 a[64:65], v242 offset:0
    ds_read_b64_tr_b16 a[66:67], v242 offset:256
    v_rcp_f32 v233, v233
    v_mul_f32 v239, v248, v135
    v_mfma_f32_32x32x16_bf16 v[144:159], a[76:79], a[12:15], v[144:159]
    ds_read_b64_tr_b16 a[68:69], v242 offset:1024
    ds_read_b64_tr_b16 a[70:71], v242 offset:1280
    v_rcp_f32 v234, v234
    v_exp_f32 v235, v235
    v_mfma_f32_32x32x16_bf16 v[144:159], a[80:83], a[16:19], v[144:159]
    ds_read_b64_tr_b16 a[72:73], v242 offset:2048
    ds_read_b64_tr_b16 a[74:75], v242 offset:2304
    v_mul_f32 v233, v233, v129
    v_mul_f32 v234, v234, v130
    v_fma_f32 v235, v235, v249, v249
    s_waitcnt lgkmcnt(6)
    v_mfma_f32_32x32x16_bf16 v[144:159], a[84:87], a[20:23], v[144:159]
    ds_read_b64_tr_b16 a[76:77], v242 offset:3072
    ds_read_b64_tr_b16 a[78:79], v242 offset:3328
    v_rcp_f32 v235, v235
    v_exp_f32 v236, v236
    v_mfma_f32_32x32x16_bf16 v[144:159], a[88:91], a[24:27], v[144:159]
    ds_read_b64_tr_b16 a[80:81], v242 offset:4096
    ds_read_b64_tr_b16 a[82:83], v242 offset:4352
    v_exp_f32 v237, v237
    v_cvt_pk_bf16_f32 v208, v232, v233
    v_mul_f32 v235, v235, v131
    v_mfma_f32_32x32x16_bf16 v[144:159], a[92:95], a[28:31], v[144:159]
    ds_read_b64_tr_b16 a[84:85], v242 offset:5120
    ds_read_b64_tr_b16 a[86:87], v242 offset:5376
    v_cvt_pk_bf16_f32 v209, v234, v235
    v_fma_f32 v236, v236, v249, v249
    v_fma_f32 v237, v237, v249, v249
    s_waitcnt lgkmcnt(6)
    v_mfma_f32_32x32x16_bf16 v[112:127], a[64:67], v[0:3], 0
    ds_read_b64_tr_b16 a[88:89], v242 offset:6144
    ds_read_b64_tr_b16 a[90:91], v242 offset:6400
    s_add_u32 m0, s30, 73728
    s_add_u32 s32, s26, 73728
    buffer_load_dwordx4 v243, s[8:11], s32 offen lds
    v_mul_f32 v232, v248, v136
    v_mfma_f32_32x32x16_bf16 v[112:127], a[68:71], v[4:7], v[112:127]
    ds_read_b64_tr_b16 a[92:93], v242 offset:7168
    ds_read_b64_tr_b16 a[94:95], v242 offset:7424
    buffer_load_dwordx4 v244, s[8:11], s32 offen offset:1024 lds
    v_rcp_f32 v236, v236
    v_mul_f32 v233, v248, v137
    v_mfma_f32_32x32x16_bf16 v[112:127], a[72:75], v[8:11], v[112:127]
    ds_read_b64_tr_b16 a[64:65], v242 offset:8192
    ds_read_b64_tr_b16 a[66:67], v242 offset:8448
    v_mul_f32 v236, v236, v132
    v_mul_f32 v234, v248, v138
    v_mul_f32 v235, v248, v139
    s_waitcnt lgkmcnt(6)
    v_mfma_f32_32x32x16_bf16 v[112:127], a[76:79], v[12:15], v[112:127]
    ds_read_b64_tr_b16 a[68:69], v242 offset:9216
    ds_read_b64_tr_b16 a[70:71], v242 offset:9472
    buffer_load_dwordx4 v245, s[8:11], s32 offen offset:2048 lds
    v_rcp_f32 v237, v237
    v_mfma_f32_32x32x16_bf16 v[112:127], a[80:83], v[16:19], v[112:127]
    ds_read_b64_tr_b16 a[72:73], v242 offset:10240
    ds_read_b64_tr_b16 a[74:75], v242 offset:10496
    buffer_load_dwordx4 v246, s[8:11], s32 offen offset:3072 lds
    v_exp_f32 v238, v238
    v_mul_f32 v237, v237, v133
    v_mfma_f32_32x32x16_bf16 v[112:127], a[84:87], v[20:23], v[112:127]
    ds_read_b64_tr_b16 a[76:77], v242 offset:11264
    ds_read_b64_tr_b16 a[78:79], v242 offset:11520
    v_exp_f32 v239, v239
    v_cvt_pk_bf16_f32 v210, v236, v237
    s_waitcnt lgkmcnt(6)
    v_mfma_f32_32x32x16_bf16 v[112:127], a[88:91], v[24:27], v[112:127]
    ds_read_b64_tr_b16 a[80:81], v242 offset:12288
    ds_read_b64_tr_b16 a[82:83], v242 offset:12544
    s_add_u32 m0, s31, 73728
    s_cbranch_vccz L_x_25
    buffer_load_dwordx4 v247, s[8:11], s32 offen lds
L_x_25:
    v_fma_f32 v238, v238, v249, v249
    v_mfma_f32_32x32x16_bf16 v[112:127], a[92:95], v[28:31], v[112:127]
    ds_read_b64_tr_b16 a[84:85], v242 offset:13312
    ds_read_b64_tr_b16 a[86:87], v242 offset:13568
    v_rcp_f32 v238, v238
    v_fma_f32 v239, v239, v249, v249
    v_mul_f32 v236, v248, v140
    v_mfma_f32_32x32x16_bf16 v[112:127], a[64:67], v[32:35], v[112:127]
    ds_read_b64_tr_b16 a[88:89], v242 offset:14336
    ds_read_b64_tr_b16 a[90:91], v242 offset:14592
    s_add_u32 m0, s30, 92160
    s_add_u32 s32, s26, 110592
    buffer_load_dwordx4 v243, s[8:11], s32 offen lds
    s_waitcnt lgkmcnt(6)
    v_mfma_f32_32x32x16_bf16 v[112:127], a[68:71], v[36:39], v[112:127]
    ds_read_b64_tr_b16 a[92:93], v242 offset:15360
    ds_read_b64_tr_b16 a[94:95], v242 offset:15616
    v_rcp_f32 v239, v239
    v_exp_f32 v232, v232
    v_mfma_f32_32x32x16_bf16 v[112:127], a[72:75], v[40:43], v[112:127]
    ds_read_b64_tr_b16 a[64:65], v242 offset:16384
    ds_read_b64_tr_b16 a[66:67], v242 offset:16640
    buffer_load_dwordx4 v244, s[8:11], s32 offen offset:1024 lds
    v_mul_f32 v238, v238, v134
    v_mul_f32 v239, v239, v135
    v_fma_f32 v232, v232, v249, v249
    v_mfma_f32_32x32x16_bf16 v[112:127], a[76:79], v[44:47], v[112:127]
    ds_read_b64_tr_b16 a[68:69], v242 offset:17408
    ds_read_b64_tr_b16 a[70:71], v242 offset:17664
    v_rcp_f32 v232, v232
    v_cvt_pk_bf16_f32 v211, v238, v239
    s_waitcnt vmcnt(18) lgkmcnt(6)
    v_mfma_f32_32x32x16_bf16 v[112:127], a[80:83], v[48:51], v[112:127]
    s_barrier
    ds_read_b64_tr_b16 a[72:73], v242 offset:18432
    ds_read_b64_tr_b16 a[74:75], v242 offset:18688
    buffer_load_dwordx4 v245, s[8:11], s32 offen offset:2048 lds
    v_mul_f32 v232, v232, v136
    v_mul_f32 v237, v248, v141
    v_mfma_f32_32x32x16_bf16 v[112:127], a[84:87], v[52:55], v[112:127]
    ds_read_b64_tr_b16 a[76:77], v242 offset:19456
    ds_read_b64_tr_b16 a[78:79], v242 offset:19712
    buffer_load_dwordx4 v246, s[8:11], s32 offen offset:3072 lds
    s_add_u32 s34, s34, 4096
    buffer_store_dwordx4 v[208:211], v250, s[16:19], s34 offen offset:0 sc1
    v_mul_f32 v238, v248, v142
    v_mfma_f32_32x32x16_bf16 v[112:127], a[88:91], v[56:59], v[112:127]
    ds_read_b64_tr_b16 a[80:81], v242 offset:20480
    ds_read_b64_tr_b16 a[82:83], v242 offset:20736
    v_exp_f32 v233, v233
    v_mul_f32 v239, v248, v143
    s_waitcnt lgkmcnt(6)
    v_mfma_f32_32x32x16_bf16 v[112:127], a[92:95], v[60:63], v[112:127]
    ds_read_b64_tr_b16 a[84:85], v242 offset:21504
    ds_read_b64_tr_b16 a[86:87], v242 offset:21760
    s_add_u32 m0, s31, 92160
    s_cbranch_vccnz L_x_26
    buffer_load_dwordx4 v247, s[8:11], s32 offen lds
L_x_26:
    v_fma_f32 v233, v233, v249, v249
    v_mfma_f32_32x32x16_bf16 v[112:127], a[64:67], v[64:67], v[112:127]
    ds_read_b64_tr_b16 a[88:89], v242 offset:22528
    ds_read_b64_tr_b16 a[90:91], v242 offset:22784
    v_rcp_f32 v233, v233
    v_exp_f32 v234, v234
    v_mfma_f32_32x32x16_bf16 v[112:127], a[68:71], v[68:71], v[112:127]
    ds_read_b64_tr_b16 a[92:93], v242 offset:23552
    ds_read_b64_tr_b16 a[94:95], v242 offset:23808
    v_exp_f32 v235, v235
    v_mul_f32 v233, v233, v137
    s_waitcnt lgkmcnt(6)
    v_mfma_f32_32x32x16_bf16 v[112:127], a[72:75], v[72:75], v[112:127]
    ds_read_b64_tr_b16 a[64:65], v242 offset:24576
    ds_read_b64_tr_b16 a[66:67], v242 offset:24832
    s_add_u32 m0, s30, 110592
    s_add_u32 s32, s26, 147456
    buffer_load_dwordx4 v243, s[8:11], s32 offen lds
    v_cvt_pk_bf16_f32 v212, v232, v233
    v_mfma_f32_32x32x16_bf16 v[112:127], a[76:79], v[76:79], v[112:127]
    ds_read_b64_tr_b16 a[68:69], v242 offset:25600
    ds_read_b64_tr_b16 a[70:71], v242 offset:25856
    s_waitcnt vmcnt(11)
    v_mul_lo_u32 v252, v252, s50
    v_add_u32 v252, 0x7f4a7c15, v252
    s_mov_b64 exec, 1
    buffer_store_dword v252, v251, s[16:19], s74 offen offset:4 sc1
    s_mov_b64 exec, -1
    buffer_load_dwordx4 v244, s[8:11], s32 offen offset:1024 lds
    v_mfma_f32_32x32x16_bf16 v[112:127], a[80:83], v[80:83], v[112:127]
    ds_read_b64_tr_b16 a[72:73], v242 offset:26624
    ds_read_b64_tr_b16 a[74:75], v242 offset:26880
    v_fma_f32 v234, v234, v249, v249
    v_fma_f32 v235, v235, v249, v249
    v_mul_f32 v232, v248, v144
    s_waitcnt lgkmcnt(6)
    v_mfma_f32_32x32x16_bf16 v[112:127], a[84:87], v[84:87], v[112:127]
    ds_read_b64_tr_b16 a[76:77], v242 offset:27648
    ds_read_b64_tr_b16 a[78:79], v242 offset:27904
    buffer_load_dwordx4 v245, s[8:11], s32 offen offset:2048 lds
    v_rcp_f32 v234, v234
    v_mul_f32 v233, v248, v145
    v_mfma_f32_32x32x16_bf16 v[112:127], a[88:91], v[88:91], v[112:127]
    ds_read_b64_tr_b16 a[80:81], v242 offset:28672
    ds_read_b64_tr_b16 a[82:83], v242 offset:28928
    buffer_load_dwordx4 v246, s[8:11], s32 offen offset:3072 lds
    v_rcp_f32 v235, v235
    v_mul_f32 v234, v234, v138
    v_mfma_f32_32x32x16_bf16 v[112:127], a[92:95], v[92:95], v[112:127]
    ds_read_b64_tr_b16 a[84:85], v242 offset:29696
    ds_read_b64_tr_b16 a[86:87], v242 offset:29952
    v_exp_f32 v236, v236
    v_mul_f32 v235, v235, v139
    s_waitcnt lgkmcnt(6)
    v_mfma_f32_32x32x16_bf16 v[112:127], a[64:67], v[96:99], v[112:127]
    ds_read_b64_tr_b16 a[88:89], v242 offset:30720
    ds_read_b64_tr_b16 a[90:91], v242 offset:30976
    s_add_u32 m0, s31, 110592
    s_cbranch_vccz L_x_27
    buffer_load_dwordx4 v247, s[8:11], s32 offen lds
L_x_27:
    v_cvt_pk_bf16_f32 v213, v234, v235
    v_mfma_f32_32x32x16_bf16 v[112:127], a[68:71], v[100:103], v[112:127]
    ds_read_b64_tr_b16 a[92:93], v242 offset:31744
    ds_read_b64_tr_b16 a[94:95], v242 offset:32000
    v_exp_f32 v237, v237
    v_fma_f32 v236, v236, v249, v249
    v_mul_f32 v234, v248, v146
    v_mfma_f32_32x32x16_bf16 v[112:127], a[72:75], v[104:107], v[112:127]
    ds_read_b64_tr_b16 a[64:65], v242 offset:32768
    ds_read_b64_tr_b16 a[66:67], v242 offset:33024
    s_add_u32 m0, s30, 129024
    s_add_u32 s32, s26, 184320
    buffer_load_dwordx4 v243, s[8:11], s32 offen lds
    s_waitcnt lgkmcnt(6)
    v_mfma_f32_32x32x16_bf16 v[112:127], a[76:79], v[108:111], v[112:127]
    ds_read_b64_tr_b16 a[68:69], v242 offset:33792
    ds_read_b64_tr_b16 a[70:71], v242 offset:34048
    v_rcp_f32 v236, v236
    v_exp_f32 v238, v238
    v_mfma_f32_32x32x16_bf16 v[112:127], a[80:83], a[0:3], v[112:127]
    ds_read_b64_tr_b16 a[72:73], v242 offset:34816
    ds_read_b64_tr_b16 a[74:75], v242 offset:35072
    buffer_load_dwordx4 v244, s[8:11], s32 offen offset:1024 lds
    v_mul_f32 v236, v236, v140
    v_fma_f32 v237, v237, v249, v249
    v_fma_f32 v238, v238, v249, v249
    v_mfma_f32_32x32x16_bf16 v[112:127], a[84:87], a[4:7], v[112:127]
    ds_read_b64_tr_b16 a[76:77], v242 offset:35840
    ds_read_b64_tr_b16 a[78:79], v242 offset:36096
    v_rcp_f32 v237, v237
    v_mul_f32 v235, v248, v147
    s_waitcnt vmcnt(25) lgkmcnt(6)
    v_mfma_f32_32x32x16_bf16 v[112:127], a[88:91], a[8:11], v[112:127]
    s_barrier
    v_accvgpr_read_b32 v240, a57
    v_accvgpr_read_b32 v241, a58
    v_accvgpr_read_b32 v242, a59
    ds_read_b64_tr_b16 a[80:81], v240 offset:36864
    ds_read_b64_tr_b16 a[82:83], v240 offset:40960
    buffer_load_dwordx4 v245, s[8:11], s32 offen offset:2048 lds
    v_rcp_f32 v238, v238
    v_mfma_f32_32x32x16_bf16 v[112:127], a[92:95], a[12:15], v[112:127]
    ds_read_b64_tr_b16 a[84:85], v241 offset:36864
    ds_read_b64_tr_b16 a[86:87], v241 offset:40960
    buffer_load_dwordx4 v246, s[8:11], s32 offen offset:3072 lds
    v_exp_f32 v239, v239
    v_mul_f32 v237, v237, v141
    v_mfma_f32_32x32x16_bf16 v[112:127], a[64:67], a[16:19], v[112:127]
    ds_read_b64_tr_b16 a[88:89], v240 offset:37888
    ds_read_b64_tr_b16 a[90:91], v240 offset:41984
    v_cvt_pk_bf16_f32 v214, v236, v237
    v_mul_f32 v238, v238, v142
    v_fma_f32 v239, v239, v249, v249
    s_waitcnt lgkmcnt(6)
    v_mfma_f32_32x32x16_bf16 v[112:127], a[68:71], a[20:23], v[112:127]
    ds_read_b64_tr_b16 a[92:93], v241 offset:37888
    ds_read_b64_tr_b16 a[94:95], v241 offset:41984
    s_add_u32 m0, s31, 129024
    s_cbranch_vccnz L_x_28
    buffer_load_dwordx4 v247, s[8:11], s32 offen lds
L_x_28:
    v_mul_f32 v236, v248, v148
    v_mfma_f32_32x32x16_bf16 v[112:127], a[72:75], a[24:27], v[112:127]
    ds_read_b64_tr_b16 a[64:65], v240 offset:38912
    ds_read_b64_tr_b16 a[66:67], v240 offset:43008
    v_rcp_f32 v239, v239
    v_exp_f32 v232, v232
    v_mfma_f32_32x32x16_bf16 v[112:127], a[76:79], a[28:31], v[112:127]
    ds_read_b64_tr_b16 a[68:69], v241 offset:38912
    ds_read_b64_tr_b16 a[70:71], v241 offset:43008
    buffer_load_dword v255, v251, s[16:19], s75 offen offset:8 sc1
    v_mul_f32 v239, v239, v143
    v_fma_f32 v232, v232, v249, v249
    s_waitcnt lgkmcnt(6)
    v_mfma_f32_32x32x16_bf16 v[0:15], a[80:83], v[160:163], 0
    ds_read_b64_tr_b16 a[72:73], v240 offset:39936
    ds_read_b64_tr_b16 a[74:75], v240 offset:44032
    s_add_u32 m0, s30, 0
    s_add_u32 s32, s26, 221184
    buffer_load_dwordx4 v243, s[8:11], s32 offen lds
    v_cvt_pk_bf16_f32 v215, v238, v239
    v_mfma_f32_32x32x16_bf16 v[16:31], a[84:87], v[160:163], 0
    ds_read_b64_tr_b16 a[76:77], v241 offset:39936
    ds_read_b64_tr_b16 a[78:79], v241 offset:44032
    buffer_store_dwordx4 v[212:215], v250, s[16:19], s34 offen offset:1024 sc1
    v_rcp_f32 v232, v232
    v_mul_f32 v237, v248, v149
    v_mfma_f32_32x32x16_bf16 v[32:47], a[88:91], v[160:163], 0
    ds_read_b64_tr_b16 a[80:81], v242 offset:53248
    ds_read_b64_tr_b16 a[82:83], v242 offset:53760
    v_mul_f32 v232, v232, v144
    v_mul_f32 v238, v248, v150
    v_mul_f32 v239, v248, v151
    s_waitcnt lgkmcnt(6)
    v_mfma_f32_32x32x16_bf16 v[48:63], a[92:95], v[160:163], 0
    ds_read_b64_tr_b16 a[84:85], v240 offset:45056
    ds_read_b64_tr_b16 a[86:87], v240 offset:49152
    buffer_load_dwordx4 v244, s[8:11], s32 offen offset:1024 lds
    v_exp_f32 v233, v233
    v_mfma_f32_32x32x16_bf16 v[64:79], a[64:67], v[160:163], 0
    ds_read_b64_tr_b16 a[88:89], v241 offset:45056
    ds_read_b64_tr_b16 a[90:91], v241 offset:49152
    v_exp_f32 v234, v234
    v_exp_f32 v235, v235
    v_mfma_f32_32x32x16_bf16 v[80:95], a[68:71], v[160:163], 0
    ds_read_b64_tr_b16 a[92:93], v240 offset:46080
    ds_read_b64_tr_b16 a[94:95], v240 offset:50176
    v_fma_f32 v233, v233, v249, v249
    v_fma_f32 v234, v234, v249, v249
    v_fma_f32 v235, v235, v249, v249
    s_waitcnt lgkmcnt(6)
    v_mfma_f32_32x32x16_bf16 v[96:111], a[72:75], v[160:163], 0
    ds_read_b64_tr_b16 a[64:65], v241 offset:46080
    ds_read_b64_tr_b16 a[66:67], v241 offset:50176
    buffer_load_dwordx4 v245, s[8:11], s32 offen offset:2048 lds
    v_rcp_f32 v233, v233
    v_mfma_f32_32x32x16_bf16 v[128:143], a[76:79], v[160:163], 0
    ds_read_b64_tr_b16 a[68:69], v240 offset:47104
    ds_read_b64_tr_b16 a[70:71], v240 offset:51200
    v_rcp_f32 v234, v234
    v_rcp_f32 v235, v235
    v_mfma_f32_32x32x16_bf16 a[0:15], a[80:83], v[160:163], 0
    ds_read_b64_tr_b16 a[72:73], v241 offset:47104
    ds_read_b64_tr_b16 a[74:75], v241 offset:51200
    v_mul_f32 v233, v233, v145
    v_mul_f32 v234, v234, v146
    v_mul_f32 v235, v235, v147
    s_waitcnt lgkmcnt(6)
    v_mfma_f32_32x32x16_bf16 v[0:15], a[84:87], v[164:167], v[0:15]
    ds_read_b64_tr_b16 a[76:77], v240 offset:48128
    ds_read_b64_tr_b16 a[78:79], v240 offset:52224
    buffer_load_dwordx4 v246, s[8:11], s32 offen offset:3072 lds
    v_exp_f32 v236, v236
    v_cvt_pk_bf16_f32 v216, v232, v233
    v_mfma_f32_32x32x16_bf16 v[16:31], a[88:91], v[164:167], v[16:31]
    ds_read_b64_tr_b16 a[80:81], v241 offset:48128
    ds_read_b64_tr_b16 a[82:83], v241 offset:52224
    s_add_u32 m0, s31, 0
    s_cbranch_vccz L_x_29
    buffer_load_dwordx4 v247, s[8:11], s32 offen lds
L_x_29:
    v_cvt_pk_bf16_f32 v217, v234, v235
    v_mfma_f32_32x32x16_bf16 v[32:47], a[92:95], v[164:167], v[32:47]
    ds_read_b64_tr_b16 a[84:85], v242 offset:54272
    ds_read_b64_tr_b16 a[86:87], v242 offset:54784
    v_fma_f32 v236, v236, v249, v249
    v_mul_f32 v232, v248, v152
    v_mul_f32 v233, v248, v153
    s_waitcnt vmcnt(28) lgkmcnt(6)
    v_mfma_f32_32x32x16_bf16 v[48:63], a[64:67], v[164:167], v[48:63]
    s_barrier
    ds_read_b64_tr_b16 a[88:89], v240 offset:55296
    ds_read_b64_tr_b16 a[90:91], v240 offset:59392
    v_rcp_f32 v236, v236
    v_mul_f32 v234, v248, v154
    v_mfma_f32_32x32x16_bf16 v[64:79], a[68:71], v[164:167], v[64:79]
    ds_read_b64_tr_b16 a[92:93], v241 offset:55296
    ds_read_b64_tr_b16 a[94:95], v241 offset:59392
    v_exp_f32 v237, v237
    v_exp_f32 v238, v238
    v_mfma_f32_32x32x16_bf16 v[80:95], a[72:75], v[164:167], v[80:95]
    ds_read_b64_tr_b16 a[64:65], v240 offset:56320
    ds_read_b64_tr_b16 a[66:67], v240 offset:60416
    v_mul_f32 v236, v236, v148
    v_fma_f32 v237, v237, v249, v249
    v_fma_f32 v238, v238, v249, v249
    s_waitcnt lgkmcnt(6)
    v_mfma_f32_32x32x16_bf16 v[96:111], a[76:79], v[164:167], v[96:111]
    ds_read_b64_tr_b16 a[68:69], v241 offset:56320
    ds_read_b64_tr_b16 a[70:71], v241 offset:60416
    v_rcp_f32 v237, v237
    v_rcp_f32 v238, v238
    v_mfma_f32_32x32x16_bf16 v[128:143], a[80:83], v[164:167], v[128:143]
    ds_read_b64_tr_b16 a[72:73], v240 offset:57344
    ds_read_b64_tr_b16 a[74:75], v240 offset:61440
    v_exp_f32 v239, v239
    v_mul_f32 v237, v237, v149
    v_mul_f32 v238, v238, v150
    v_mfma_f32_32x32x16_bf16 a[0:15], a[84:87], v[164:167], a[0:15]
    ds_read_b64_tr_b16 a[76:77], v241 offset:57344
    ds_read_b64_tr_b16 a[78:79], v241 offset:61440
    v_cvt_pk_bf16_f32 v218, v236, v237
    v_fma_f32 v239, v239, v249, v249
    v_mul_f32 v235, v248, v155
    s_waitcnt lgkmcnt(6)
    v_mfma_f32_32x32x16_bf16 v[0:15], a[88:91], v[168:171], v[0:15]
    ds_read_b64_tr_b16 a[80:81], v240 offset:58368
    ds_read_b64_tr_b16 a[82:83], v240 offset:62464
    s_add_u32 m0, s30, 18432
    s_add_u32 s32, s26, 258048
    buffer_load_dwordx4 v243, s[8:11], s32 offen lds
    v_mul_f32 v236, v248, v156
    v_mfma_f32_32x32x16_bf16 v[16:31], a[92:95], v[168:171], v[16:31]
    ds_read_b64_tr_b16 a[84:85], v241 offset:58368
    ds_read_b64_tr_b16 a[86:87], v241 offset:62464
    s_waitcnt vmcnt(6)
    v_cmp_eq_u32 s[44:45], v255, v252
    s_mov_b32 s42, 0x8000
    s_nop 0
    s_cmp_lg_u64 s[44:45], 0
    s_cbranch_scc1 L_pok_30
L_plp_31:
    buffer_load_dword v255, v251, s[16:19], s75 offen offset:8 sc1
    s_waitcnt vmcnt(0)
    v_cmp_eq_u32 s[44:45], v255, v252
    s_nop 1
    s_cmp_lg_u64 s[44:45], 0
    s_cbranch_scc1 L_pok_30
    s_sleep 1
    s_sub_u32 s42, s42, 1
    s_cbranch_scc0 L_plp_31
L_pok_30:
    v_mfma_f32_32x32x16_bf16 v[32:47], a[64:67], v[168:171], v[32:47]
    v_add_u32 v242, 55296, v242
    ds_read_b64_tr_b16 a[88:89], v242 offset:16384
    ds_read_b64_tr_b16 a[90:91], v242 offset:16896
    buffer_load_dwordx4 a[96:99], v250, s[16:19], s36 offen offset:0 sc1
    v_rcp_f32 v239, v239
    s_waitcnt lgkmcnt(6)
    v_mfma_f32_32x32x16_bf16 v[48:63], a[68:71], v[168:171], v[48:63]
    ds_read_b64_tr_b16 a[92:93], v240 offset:63488
    v_add_u32 v240, 55296, v240
    ds_read_b64_tr_b16 a[94:95], v240 offset:12288
    buffer_load_dwordx4 v244, s[8:11], s32 offen offset:1024 lds
    v_exp_f32 v232, v232
    v_mul_f32 v239, v239, v151
    v_mfma_f32_32x32x16_bf16 v[64:79], a[72:75], v[168:171], v[64:79]
    ds_read_b64_tr_b16 a[64:65], v241 offset:63488
    v_add_u32 v241, 55296, v241
    ds_read_b64_tr_b16 a[66:67], v241 offset:12288
    v_exp_f32 v233, v233
    v_cvt_pk_bf16_f32 v219, v238, v239
    v_fma_f32 v232, v232, v249, v249
    v_mfma_f32_32x32x16_bf16 v[80:95], a[76:79], v[168:171], v[80:95]
    ds_read_b64_tr_b16 a[68:69], v240 offset:9216
    ds_read_b64_tr_b16 a[70:71], v240 offset:13312
    buffer_store_dwordx4 v[216:219], v250, s[16:19], s34 offen offset:2048 sc1
    v_fma_f32 v233, v233, v249, v249
    v_mul_f32 v237, v248, v157
    s_waitcnt lgkmcnt(6)
    v_mfma_f32_32x32x16_bf16 v[96:111], a[80:83], v[168:171], v[96:111]
    ds_read_b64_tr_b16 a[72:73], v241 offset:9216
    ds_read_b64_tr_b16 a[74:75], v241 offset:13312
    buffer_load_dwordx4 v245, s[8:11], s32 offen offset:2048 lds
    v_rcp_f32 v232, v232
    v_mul_f32 v238, v248, v158
    v_mfma_f32_32x32x16_bf16 v[128:143], a[84:87], v[168:171], v[128:143]
    ds_read_b64_tr_b16 a[76:77], v240 offset:10240
    ds_read_b64_tr_b16 a[78:79], v240 offset:14336
    v_rcp_f32 v233, v233
    v_exp_f32 v234, v234
    v_mfma_f32_32x32x16_bf16 a[0:15], a[88:91], v[168:171], a[0:15]
    ds_read_b64_tr_b16 a[80:81], v241 offset:10240
    ds_read_b64_tr_b16 a[82:83], v241 offset:14336
    v_mul_f32 v232, v232, v152
    v_mul_f32 v233, v233, v153
    v_fma_f32 v234, v234, v249, v249
    s_waitcnt lgkmcnt(6)
    v_mfma_f32_32x32x16_bf16 v[0:15], a[92:95], v[172:175], v[0:15]
    ds_read_b64_tr_b16 a[84:85], v240 offset:11264
    ds_read_b64_tr_b16 a[86:87], v240 offset:15360
    buffer_load_dwordx4 v246, s[8:11], s32 offen offset:3072 lds
    v_rcp_f32 v234, v234
    v_cvt_pk_bf16_f32 v220, v232, v233
    v_mfma_f32_32x32x16_bf16 v[16:31], a[64:67], v[172:175], v[16:31]
    ds_read_b64_tr_b16 a[88:89], v241 offset:11264
    ds_read_b64_tr_b16 a[90:91], v241 offset:15360
    s_add_u32 m0, s31, 18432
    s_cbranch_vccnz L_x_32
    buffer_load_dwordx4 v247, s[8:11], s32 offen lds
L_x_32:
    buffer_load_dwordx4 a[100:103], v250, s[16:19], s36 offen offset:1024 sc1
    v_mfma_f32_32x32x16_bf16 v[32:47], a[68:71], v[172:175], v[32:47]
    ds_read_b64_tr_b16 a[92:93], v242 offset:17408
    ds_read_b64_tr_b16 a[94:95], v242 offset:17920
    v_mul_f32 v234, v234, v154
    v_mul_f32 v239, v248, v159
    v_mul_f32 v232, v248, v112
    s_waitcnt vmcnt(29) lgkmcnt(6)
    v_mfma_f32_32x32x16_bf16 v[48:63], a[72:75], v[172:175], v[48:63]
    s_barrier
    ds_read_b64_tr_b16 a[64:65], v240 offset:18432
    ds_read_b64_tr_b16 a[66:67], v240 offset:22528
    v_exp_f32 v235, v235
    v_mul_f32 v233, v248, v113
    v_mfma_f32_32x32x16_bf16 v[64:79], a[76:79], v[172:175], v[64:79]
    ds_read_b64_tr_b16 a[68:69], v241 offset:18432
    ds_read_b64_tr_b16 a[70:71], v241 offset:22528
    v_exp_f32 v236, v236
    v_exp_f32 v237, v237
    v_mfma_f32_32x32x16_bf16 v[80:95], a[80:83], v[172:175], v[80:95]
    ds_read_b64_tr_b16 a[72:73], v240 offset:19456
    ds_read_b64_tr_b16 a[74:75], v240 offset:23552
    v_fma_f32 v235, v235, v249, v249
    v_fma_f32 v236, v236, v249, v249
    v_fma_f32 v237, v237, v249, v249
    s_waitcnt lgkmcnt(6)
    v_mfma_f32_32x32x16_bf16 v[96:111], a[84:87], v[172:175], v[96:111]
    ds_read_b64_tr_b16 a[76:77], v241 offset:19456
    ds_read_b64_tr_b16 a[78:79], v241 offset:23552
    v_rcp_f32 v235, v235
    v_rcp_f32 v236, v236
    v_mfma_f32_32x32x16_bf16 v[128:143], a[88:91], v[172:175], v[128:143]
    ds_read_b64_tr_b16 a[80:81], v240 offset:20480
    ds_read_b64_tr_b16 a[82:83], v240 offset:24576
    v_rcp_f32 v237, v237
    v_exp_f32 v238, v238
    v_mfma_f32_32x32x16_bf16 a[0:15], a[92:95], v[172:175], a[0:15]
    ds_read_b64_tr_b16 a[84:85], v241 offset:20480
    ds_read_b64_tr_b16 a[86:87], v241 offset:24576
    v_mul_f32 v235, v235, v155
    v_mul_f32 v236, v236, v156
    v_mul_f32 v237, v237, v157
    s_waitcnt lgkmcnt(6)
    v_mfma_f32_32x32x16_bf16 v[0:15], a[64:67], v[176:179], v[0:15]
    ds_read_b64_tr_b16 a[88:89], v240 offset:21504
    ds_read_b64_tr_b16 a[90:91], v240 offset:25600
    s_add_u32 m0, s30, 36864
    s_add_u32 s32, s27, 0
    buffer_load_dwordx4 v243, s[8:11], s32 offen lds
    buffer_load_dwordx4 a[104:107], v250, s[16:19], s36 offen offset:2048 sc1
    v_mfma_f32_32x32x16_bf16 v[16:31], a[68:71], v[176:179], v[16:31]
    ds_read_b64_tr_b16 a[92:93], v241 offset:21504
    ds_read_b64_tr_b16 a[94:95], v241 offset:25600
    v_exp_f32 v239, v239
    v_cvt_pk_bf16_f32 v221, v234, v235
    v_cvt_pk_bf16_f32 v222, v236, v237
    v_mfma_f32_32x32x16_bf16 v[32:47], a[72:75], v[176:179], v[32:47]
    ds_read_b64_tr_b16 a[64:65], v242 offset:34816
    ds_read_b64_tr_b16 a[66:67], v242 offset:35328
    v_fma_f32 v238, v238, v249, v249
    v_fma_f32 v239, v239, v249, v249
    v_mul_f32 v234, v248, v114
    s_waitcnt lgkmcnt(6)
    v_mfma_f32_32x32x16_bf16 v[48:63], a[76:79], v[176:179], v[48:63]
    ds_read_b64_tr_b16 a[68:69], v240 offset:26624
    ds_read_b64_tr_b16 a[70:71], v240 offset:30720
    buffer_load_dwordx4 v244, s[8:11], s32 offen offset:1024 lds
    v_rcp_f32 v238, v238
    v_mul_f32 v235, v248, v115
    v_mfma_f32_32x32x16_bf16 v[64:79], a[80:83], v[176:179], v[64:79]
    ds_read_b64_tr_b16 a[72:73], v241 offset:26624
    ds_read_b64_tr_b16 a[74:75], v241 offset:30720
    v_rcp_f32 v239, v239
    v_mul_f32 v238, v238, v158
    v_mul_f32 v236, v248, v116
    v_mfma_f32_32x32x16_bf16 v[80:95], a[84:87], v[176:179], v[80:95]
    ds_read_b64_tr_b16 a[76:77], v240 offset:27648
    ds_read_b64_tr_b16 a[78:79], v240 offset:31744
    v_exp_f32 v232, v232
    v_mul_f32 v239, v239, v159
    s_waitcnt lgkmcnt(6)
    v_mfma_f32_32x32x16_bf16 v[96:111], a[88:91], v[176:179], v[96:111]
    ds_read_b64_tr_b16 a[80:81], v241 offset:27648
    ds_read_b64_tr_b16 a[82:83], v241 offset:31744
    buffer_load_dwordx4 v245, s[8:11], s32 offen offset:2048 lds
    v_cvt_pk_bf16_f32 v223, v238, v239
    v_fma_f32 v232, v232, v249, v249
    v_mul_f32 v237, v248, v117
    v_mfma_f32_32x32x16_bf16 v[128:143], a[92:95], v[176:179], v[128:143]
    ds_read_b64_tr_b16 a[84:85], v240 offset:28672
    ds_read_b64_tr_b16 a[86:87], v240 offset:32768
    buffer_store_dwordx4 v[220:223], v250, s[16:19], s34 offen offset:3072 sc1
    v_rcp_f32 v232, v232
    v_mul_f32 v238, v248, v118
    v_mfma_f32_32x32x16_bf16 a[0:15], a[64:67], v[176:179], a[0:15]
    ds_read_b64_tr_b16 a[88:89], v241 offset:28672
    ds_read_b64_tr_b16 a[90:91], v241 offset:32768
    buffer_load_dwordx4 a[108:111], v250, s[16:19], s36 offen offset:3072 sc1
    v_exp_f32 v233, v233
    s_waitcnt lgkmcnt(6)
    v_mfma_f32_32x32x16_bf16 v[0:15], a[68:71], v[180:183], v[0:15]
    ds_read_b64_tr_b16 a[92:93], v240 offset:29696
    ds_read_b64_tr_b16 a[94:95], v240 offset:33792
    buffer_load_dwordx4 v246, s[8:11], s32 offen offset:3072 lds
    v_mul_f32 v232, v232, v112
    v_fma_f32 v233, v233, v249, v249
    v_mul_f32 v239, v248, v119
    v_mfma_f32_32x32x16_bf16 v[16:31], a[72:75], v[180:183], v[16:31]
    ds_read_b64_tr_b16 a[64:65], v241 offset:29696
    ds_read_b64_tr_b16 a[66:67], v241 offset:33792
    s_add_u32 m0, s31, 36864
    s_cbranch_vccz L_x_33
    buffer_load_dwordx4 v247, s[8:11], s32 offen lds
L_x_33:
    v_mfma_f32_32x32x16_bf16 v[32:47], a[76:79], v[180:183], v[32:47]
    ds_read_b64_tr_b16 a[68:69], v242 offset:35840
    ds_read_b64_tr_b16 a[70:71], v242 offset:36352
    v_accvgpr_read_b32 v247, a42
    s_mul_i32 s92, s20, 36864
    s_waitcnt vmcnt(31) lgkmcnt(6)
    v_mfma_f32_32x32x16_bf16 v[48:63], a[80:83], v[180:183], v[48:63]
    s_barrier
    ds_read_b64_tr_b16 a[72:73], v240 offset:36864
    ds_read_b64_tr_b16 a[74:75], v240 offset:40960
    s_add_u32 s93, s92, 4096
    v_add_u32 v243, s93, v247
    v_mfma_f32_32x32x16_bf16 v[64:79], a[84:87], v[180:183], v[64:79]
    ds_read_b64_tr_b16 a[76:77], v241 offset:36864
    ds_read_b64_tr_b16 a[78:79], v241 offset:40960
    s_add_u32 s93, s92, 12288
    v_add_u32 v244, s93, v247
    v_rcp_f32 v233, v233
    v_mfma_f32_32x32x16_bf16 v[80:95], a[88:91], v[180:183], v[80:95]
    ds_read_b64_tr_b16 a[80:81], v240 offset:37888
    ds_read_b64_tr_b16 a[82:83], v240 offset:41984
    s_add_u32 s93, s92, 20480
    v_add_u32 v245, s93, v247
    v_mul_f32 v233, v233, v113
    s_waitcnt lgkmcnt(6)
    v_mfma_f32_32x32x16_bf16 v[96:111], a[92:95], v[180:183], v[96:111]
    ds_read_b64_tr_b16 a[84:85], v241 offset:37888
    ds_read_b64_tr_b16 a[86:87], v241 offset:41984
    s_add_u32 s93, s92, 28672
    v_add_u32 v246, s93, v247
    v_exp_f32 v234, v234
    v_mfma_f32_32x32x16_bf16 v[128:143], a[64:67], v[180:183], v[128:143]
    ds_read_b64_tr_b16 a[88:89], v240 offset:38912
    ds_read_b64_tr_b16 a[90:91], v240 offset:43008
    s_add_u32 s36, s36, 4096
    buffer_load_dwordx4 a[112:115], v250, s[16:19], s36 offen offset:0 sc1
    s_mul_i32 s93, s49, 9216
    s_add_u32 s93, s93, 151552
    v_mfma_f32_32x32x16_bf16 a[0:15], a[68:71], v[180:183], a[0:15]
    ds_read_b64_tr_b16 a[92:93], v241 offset:38912
    ds_read_b64_tr_b16 a[94:95], v241 offset:43008
    v_add_u32 v247, s93, v247
    v_exp_f32 v235, v235
    s_waitcnt lgkmcnt(6)
    v_mfma_f32_32x32x16_bf16 v[0:15], a[72:75], v[184:187], v[0:15]
    ds_read_b64_tr_b16 a[64:65], v240 offset:39936
    ds_read_b64_tr_b16 a[66:67], v240 offset:44032
    s_add_u32 m0, s30, 55296
    s_add_u32 s32, s28, 0
    buffer_load_dwordx4 v243, s[8:11], s32 offen lds
    v_cvt_pk_bf16_f32 v224, v232, v233
    v_mfma_f32_32x32x16_bf16 v[16:31], a[76:79], v[184:187], v[16:31]
    ds_read_b64_tr_b16 a[68:69], v241 offset:39936
    ds_read_b64_tr_b16 a[70:71], v241 offset:44032
    v_fma_f32 v234, v234, v249, v249
    v_fma_f32 v235, v235, v249, v249
    v_mul_f32 v232, v248, v120
    v_mul_f32 v233, v248, v121
    v_mfma_f32_32x32x16_bf16 v[32:47], a[80:83], v[184:187], v[32:47]
    ds_read_b64_tr_b16 a[72:73], v242 offset:53248
    ds_read_b64_tr_b16 a[74:75], v242 offset:53760
    v_rcp_f32 v234, v234
    s_waitcnt lgkmcnt(6)
    v_mfma_f32_32x32x16_bf16 v[48:63], a[84:87], v[184:187], v[48:63]
    ds_read_b64_tr_b16 a[76:77], v240 offset:45056
    ds_read_b64_tr_b16 a[78:79], v240 offset:49152
    buffer_load_dwordx4 v244, s[8:11], s32 offen offset:1024 lds
    v_rcp_f32 v235, v235
    v_mul_f32 v234, v234, v114
    v_mfma_f32_32x32x16_bf16 v[64:79], a[88:91], v[184:187], v[64:79]
    ds_read_b64_tr_b16 a[80:81], v241 offset:45056
    ds_read_b64_tr_b16 a[82:83], v241 offset:49152
    v_exp_f32 v236, v236
    v_exp_f32 v237, v237
    v_mfma_f32_32x32x16_bf16 v[80:95], a[92:95], v[184:187], v[80:95]
    ds_read_b64_tr_b16 a[84:85], v240 offset:46080
    ds_read_b64_tr_b16 a[86:87], v240 offset:50176
    v_mul_f32 v235, v235, v115
    v_fma_f32 v236, v236, v249, v249
    v_fma_f32 v237, v237, v249, v249
    s_waitcnt lgkmcnt(6)
    v_mfma_f32_32x32x16_bf16 v[96:111], a[64:67], v[184:187], v[96:111]
    ds_read_b64_tr_b16 a[88:89], v241 offset:46080
    ds_read_b64_tr_b16 a[90:91], v241 offset:50176
    buffer_load_dwordx4 v245, s[8:11], s32 offen offset:2048 lds
    buffer_load_dwordx4 a[116:119], v250, s[16:19], s36 offen offset:1024 sc1
    v_rcp_f32 v236, v236
    v_mfma_f32_32x32x16_bf16 v[128:143], a[68:71], v[184:187], v[128:143]
    ds_read_b64_tr_b16 a[92:93], v240 offset:47104
    ds_read_b64_tr_b16 a[94:95], v240 offset:51200
    v_rcp_f32 v237, v237
    v_exp_f32 v238, v238
    v_mfma_f32_32x32x16_bf16 a[0:15], a[72:75], v[184:187], a[0:15]
    ds_read_b64_tr_b16 a[64:65], v241 offset:47104
    ds_read_b64_tr_b16 a[66:67], v241 offset:51200
    v_cvt_pk_bf16_f32 v225, v234, v235
    v_mul_f32 v236, v236, v116
    v_mul_f32 v237, v237, v117
    s_waitcnt lgkmcnt(6)
    v_mfma_f32_32x32x16_bf16 v[0:15], a[76:79], v[188:191], v[0:15]
    ds_read_b64_tr_b16 a[68:69], v240 offset:48128
    ds_read_b64_tr_b16 a[70:71], v240 offset:52224
    buffer_load_dwordx4 v246, s[8:11], s32 offen offset:3072 lds
    v_cvt_pk_bf16_f32 v226, v236, v237
    v_fma_f32 v238, v238, v249, v249
    v_mul_f32 v234, v248, v122
    v_mfma_f32_32x32x16_bf16 v[16:31], a[80:83], v[188:191], v[16:31]
    ds_read_b64_tr_b16 a[72:73], v241 offset:48128
    ds_read_b64_tr_b16 a[74:75], v241 offset:52224
    s_add_u32 m0, s31, 55296
    s_cbranch_vccnz L_x_34
    buffer_load_dwordx4 v247, s[8:11], s32 offen lds
L_x_34:
    v_mul_f32 v235, v248, v123
    v_mfma_f32_32x32x16_bf16 v[32:47], a[84:87], v[188:191], v[32:47]
    ds_read_b64_tr_b16 a[76:77], v242 offset:54272
    ds_read_b64_tr_b16 a[78:79], v242 offset:54784
    v_accvgpr_read_b32 v164, a42
    s_mul_i32 s92, s20, 36864
    s_add_u32 s93, s92, 4096
    s_waitcnt vmcnt(32) lgkmcnt(6)
    v_mfma_f32_32x32x16_bf16 v[48:63], a[88:91], v[188:191], v[48:63]
    s_barrier
    ds_read_b64_tr_b16 a[80:81], v240 offset:55296
    ds_read_b64_tr_b16 a[82:83], v240 offset:59392
    s_add_u32 s93, s93, s99
    v_add_u32 v160, s93, v164
    s_add_u32 s93, s92, 12288
    v_mfma_f32_32x32x16_bf16 v[64:79], a[92:95], v[188:191], v[64:79]
    ds_read_b64_tr_b16 a[84:85], v241 offset:55296
    ds_read_b64_tr_b16 a[86:87], v241 offset:59392
    s_add_u32 s93, s93, s99
    v_add_u32 v161, s93, v164
    s_add_u32 s93, s92, 20480
    v_mul_f32 v236, v248, v124
    v_mfma_f32_32x32x16_bf16 v[80:95], a[64:67], v[188:191], v[80:95]
    ds_read_b64_tr_b16 a[88:89], v240 offset:56320
    ds_read_b64_tr_b16 a[90:91], v240 offset:60416
    buffer_load_dwordx4 a[120:123], v250, s[16:19], s36 offen offset:2048 sc1
    s_cmp_eq_u32 s20, 3
    s_cselect_b32 s94, 0, s99
    s_add_u32 s93, s93, s94
    s_waitcnt lgkmcnt(6)
    v_mfma_f32_32x32x16_bf16 v[96:111], a[68:71], v[188:191], v[96:111]
    ds_read_b64_tr_b16 a[92:93], v241 offset:56320
    ds_read_b64_tr_b16 a[94:95], v241 offset:60416
    v_add_u32 v162, s93, v164
    s_add_u32 s93, s92, 28672
    s_cmp_eq_u32 s20, 3
    s_cselect_b32 s94, 0, s99
    v_mfma_f32_32x32x16_bf16 v[128:143], a[72:75], v[188:191], v[128:143]
    ds_read_b64_tr_b16 a[64:65], v240 offset:57344
    ds_read_b64_tr_b16 a[66:67], v240 offset:61440
    s_add_u32 s93, s93, s94
    v_add_u32 v163, s93, v164
    s_mul_i32 s93, s49, 9216
    v_mul_f32 v237, v248, v125
    v_mfma_f32_32x32x16_bf16 a[0:15], a[76:79], v[188:191], a[0:15]
    ds_read_b64_tr_b16 a[68:69], v241 offset:57344
    ds_read_b64_tr_b16 a[70:71], v241 offset:61440
    s_add_u32 s93, s93, 151552
    v_add_u32 v164, s93, v164
    s_waitcnt lgkmcnt(6)
    v_mfma_f32_32x32x16_bf16 v[0:15], a[80:83], v[192:195], v[0:15]
    ds_read_b64_tr_b16 a[72:73], v240 offset:58368
    ds_read_b64_tr_b16 a[74:75], v240 offset:62464
    s_add_u32 m0, s30, 73728
    s_add_u32 s32, s35, 165888
    buffer_load_dwordx4 v160, s[8:11], s32 offen lds
    v_mfma_f32_32x32x16_bf16 v[16:31], a[84:87], v[192:195], v[16:31]
    ds_read_b64_tr_b16 a[76:77], v241 offset:58368
    ds_read_b64_tr_b16 a[78:79], v241 offset:62464
    v_rcp_f32 v238, v238
    v_exp_f32 v239, v239
    v_mfma_f32_32x32x16_bf16 v[32:47], a[88:91], v[192:195], v[32:47]
    v_add_u32 v242, 55296, v242
    ds_read_b64_tr_b16 a[80:81], v242 offset:16384
    ds_read_b64_tr_b16 a[82:83], v242 offset:16896
    v_exp_f32 v232, v232
    v_mul_f32 v238, v238, v118
    s_waitcnt lgkmcnt(6)
    v_mfma_f32_32x32x16_bf16 v[48:63], a[92:95], v[192:195], v[48:63]
    ds_read_b64_tr_b16 a[84:85], v240 offset:63488
    v_add_u32 v240, 55296, v240
    ds_read_b64_tr_b16 a[86:87], v240 offset:12288
    buffer_load_dwordx4 v161, s[8:11], s32 offen offset:1024 lds
    v_exp_f32 v233, v233
    v_fma_f32 v239, v239, v249, v249
    v_mfma_f32_32x32x16_bf16 v[64:79], a[64:67], v[192:195], v[64:79]
    ds_read_b64_tr_b16 a[88:89], v241 offset:63488
    v_add_u32 v241, 55296, v241
    ds_read_b64_tr_b16 a[90:91], v241 offset:12288
    buffer_load_dwordx4 a[124:127], v250, s[16:19], s36 offen offset:3072 sc1
    v_rcp_f32 v239, v239
    v_fma_f32 v232, v232, v249, v249
    v_mfma_f32_32x32x16_bf16 v[80:95], a[68:71], v[192:195], v[80:95]
    ds_read_b64_tr_b16 a[92:93], v240 offset:9216
    ds_read_b64_tr_b16 a[94:95], v240 offset:13312
    v_rcp_f32 v232, v232
    v_mul_f32 v239, v239, v119
    s_waitcnt lgkmcnt(6)
    v_mfma_f32_32x32x16_bf16 v[96:111], a[72:75], v[192:195], v[96:111]
    ds_read_b64_tr_b16 a[64:65], v241 offset:9216
    ds_read_b64_tr_b16 a[66:67], v241 offset:13312
    buffer_load_dwordx4 v162, s[8:11], s32 offen offset:2048 lds
    v_cvt_pk_bf16_f32 v227, v238, v239
    v_mul_f32 v232, v232, v120
    v_fma_f32 v233, v233, v249, v249
    v_mfma_f32_32x32x16_bf16 v[128:143], a[76:79], v[192:195], v[128:143]
    ds_read_b64_tr_b16 a[68:69], v240 offset:10240
    ds_read_b64_tr_b16 a[70:71], v240 offset:14336
    s_add_u32 s34, s34, 4096
    buffer_store_dwordx4 v[224:227], v250, s[16:19], s34 offen offset:0 sc1
    v_rcp_f32 v233, v233
    v_mfma_f32_32x32x16_bf16 a[0:15], a[80:83], v[192:195], a[0:15]
    ds_read_b64_tr_b16 a[72:73], v241 offset:10240
    ds_read_b64_tr_b16 a[74:75], v241 offset:14336
    v_mul_f32 v233, v233, v121
    v_mul_f32 v238, v248, v126
    v_mul_f32 v239, v248, v127
    s_waitcnt lgkmcnt(6)
    v_mfma_f32_32x32x16_bf16 v[0:15], a[84:87], v[196:199], v[0:15]
    ds_read_b64_tr_b16 a[76:77], v240 offset:11264
    ds_read_b64_tr_b16 a[78:79], v240 offset:15360
    buffer_load_dwordx4 v163, s[8:11], s32 offen offset:3072 lds
    v_exp_f32 v234, v234
    v_cvt_pk_bf16_f32 v228, v232, v233
    v_mfma_f32_32x32x16_bf16 v[16:31], a[88:91], v[196:199], v[16:31]
    ds_read_b64_tr_b16 a[80:81], v241 offset:11264
    ds_read_b64_tr_b16 a[82:83], v241 offset:15360
    s_add_u32 m0, s31, 73728
    s_cbranch_vccz L_x_35
    buffer_load_dwordx4 v164, s[8:11], s32 offen lds
L_x_35:
    v_fma_f32 v234, v234, v249, v249
    v_mfma_f32_32x32x16_bf16 v[32:47], a[92:95], v[196:199], v[32:47]
    ds_read_b64_tr_b16 a[84:85], v242 offset:17408
    ds_read_b64_tr_b16 a[86:87], v242 offset:17920
    v_rcp_f32 v234, v234
    s_waitcnt vmcnt(35) lgkmcnt(6)
    v_mfma_f32_32x32x16_bf16 v[48:63], a[64:67], v[196:199], v[48:63]
    s_barrier
    ds_read_b64_tr_b16 a[88:89], v240 offset:18432
    ds_read_b64_tr_b16 a[90:91], v240 offset:22528
    s_add_u32 s36, s36, 4096
    buffer_load_dwordx4 a[128:131], v250, s[16:19], s36 offen offset:0 sc1
    v_mul_f32 v234, v234, v122
    v_mfma_f32_32x32x16_bf16 v[64:79], a[68:71], v[196:199], v[64:79]
    ds_read_b64_tr_b16 a[92:93], v241 offset:18432
    ds_read_b64_tr_b16 a[94:95], v241 offset:22528
    v_exp_f32 v235, v235
    v_exp_f32 v236, v236
    v_mfma_f32_32x32x16_bf16 v[80:95], a[72:75], v[196:199], v[80:95]
    ds_read_b64_tr_b16 a[64:65], v240 offset:19456
    ds_read_b64_tr_b16 a[66:67], v240 offset:23552
    v_exp_f32 v237, v237
    v_fma_f32 v235, v235, v249, v249
    s_waitcnt lgkmcnt(6)
    v_mfma_f32_32x32x16_bf16 v[96:111], a[76:79], v[196:199], v[96:111]
    ds_read_b64_tr_b16 a[68:69], v241 offset:19456
    ds_read_b64_tr_b16 a[70:71], v241 offset:23552
    v_rcp_f32 v235, v235
    v_exp_f32 v238, v238
    v_mfma_f32_32x32x16_bf16 v[128:143], a[80:83], v[196:199], v[128:143]
    ds_read_b64_tr_b16 a[72:73], v240 offset:20480
    ds_read_b64_tr_b16 a[74:75], v240 offset:24576
    v_mul_f32 v235, v235, v123
    v_fma_f32 v236, v236, v249, v249
    v_fma_f32 v237, v237, v249, v249
    v_fma_f32 v238, v238, v249, v249
    v_mfma_f32_32x32x16_bf16 a[0:15], a[84:87], v[196:199], a[0:15]
    ds_read_b64_tr_b16 a[76:77], v241 offset:20480
    ds_read_b64_tr_b16 a[78:79], v241 offset:24576
    v_rcp_f32 v236, v236
    v_cvt_pk_bf16_f32 v229, v234, v235
    s_waitcnt lgkmcnt(6)
    v_mfma_f32_32x32x16_bf16 v[0:15], a[88:91], v[200:203], v[0:15]
    ds_read_b64_tr_b16 a[80:81], v240 offset:21504
    ds_read_b64_tr_b16 a[82:83], v240 offset:25600
    s_add_u32 m0, s30, 92160
    s_add_u32 s32, s28, 128
    buffer_load_dwordx4 v243, s[8:11], s32 offen lds
    v_mul_f32 v236, v236, v124
    v_mfma_f32_32x32x16_bf16 v[16:31], a[92:95], v[200:203], v[16:31]
    ds_read_b64_tr_b16 a[84:85], v241 offset:21504
    ds_read_b64_tr_b16 a[86:87], v241 offset:25600
    v_rcp_f32 v237, v237
    v_rcp_f32 v238, v238
    v_mfma_f32_32x32x16_bf16 v[32:47], a[64:67], v[200:203], v[32:47]
    ds_read_b64_tr_b16 a[88:89], v242 offset:34816
    ds_read_b64_tr_b16 a[90:91], v242 offset:35328
    buffer_load_dwordx4 a[132:135], v250, s[16:19], s36 offen offset:1024 sc1
    v_exp_f32 v239, v239
    s_waitcnt lgkmcnt(6)
    v_mfma_f32_32x32x16_bf16 v[48:63], a[68:71], v[200:203], v[48:63]
    ds_read_b64_tr_b16 a[92:93], v240 offset:26624
    ds_read_b64_tr_b16 a[94:95], v240 offset:30720
    buffer_load_dwordx4 v244, s[8:11], s32 offen offset:1024 lds
    v_mul_f32 v237, v237, v125
    v_mul_f32 v238, v238, v126
    v_fma_f32 v239, v239, v249, v249
    v_mfma_f32_32x32x16_bf16 v[64:79], a[72:75], v[200:203], v[64:79]
    ds_read_b64_tr_b16 a[64:65], v241 offset:26624
    ds_read_b64_tr_b16 a[66:67], v241 offset:30720
    v_rcp_f32 v239, v239
    v_cvt_pk_bf16_f32 v230, v236, v237
    v_mfma_f32_32x32x16_bf16 v[80:95], a[76:79], v[200:203], v[80:95]
    ds_read_b64_tr_b16 a[68:69], v240 offset:27648
    ds_read_b64_tr_b16 a[70:71], v240 offset:31744
    v_mul_f32 v239, v239, v127
    s_waitcnt lgkmcnt(6)
    v_mfma_f32_32x32x16_bf16 v[96:111], a[80:83], v[200:203], v[96:111]
    ds_read_b64_tr_b16 a[72:73], v241 offset:27648
    ds_read_b64_tr_b16 a[74:75], v241 offset:31744
    buffer_load_dwordx4 v245, s[8:11], s32 offen offset:2048 lds
    v_cvt_pk_bf16_f32 v231, v238, v239
    v_mfma_f32_32x32x16_bf16 v[128:143], a[84:87], v[200:203], v[128:143]
    ds_read_b64_tr_b16 a[76:77], v240 offset:28672
    ds_read_b64_tr_b16 a[78:79], v240 offset:32768
    buffer_store_dwordx4 v[228:231], v250, s[16:19], s34 offen offset:1024 sc1
    v_mfma_f32_32x32x16_bf16 a[0:15], a[88:91], v[200:203], a[0:15]
    ds_read_b64_tr_b16 a[80:81], v241 offset:28672
    ds_read_b64_tr_b16 a[82:83], v241 offset:32768
    s_waitcnt lgkmcnt(6)
    v_mfma_f32_32x32x16_bf16 v[0:15], a[92:95], v[204:207], v[0:15]
    ds_read_b64_tr_b16 a[84:85], v240 offset:29696
    ds_read_b64_tr_b16 a[86:87], v240 offset:33792
    buffer_load_dwordx4 v246, s[8:11], s32 offen offset:3072 lds
    v_mfma_f32_32x32x16_bf16 v[16:31], a[64:67], v[204:207], v[16:31]
    ds_read_b64_tr_b16 a[88:89], v241 offset:29696
    ds_read_b64_tr_b16 a[90:91], v241 offset:33792
    s_add_u32 m0, s31, 92160
    s_cbranch_vccnz L_x_36
    buffer_load_dwordx4 v247, s[8:11], s32 offen lds
L_x_36:
    buffer_load_dwordx4 a[136:139], v250, s[16:19], s36 offen offset:2048 sc1
    v_mfma_f32_32x32x16_bf16 v[32:47], a[68:71], v[204:207], v[32:47]
    ds_read_b64_tr_b16 a[92:93], v242 offset:35840
    ds_read_b64_tr_b16 a[94:95], v242 offset:36352
    s_waitcnt vmcnt(37) lgkmcnt(6)
    v_mfma_f32_32x32x16_bf16 v[48:63], a[72:75], v[204:207], v[48:63]
    s_barrier
    v_add_u32 v240, 4294856704, v240
    ds_read_b64_tr_b16 a[64:65], v240 offset:0
    ds_read_b64_tr_b16 a[66:67], v240 offset:4096
    v_mfma_f32_32x32x16_bf16 v[64:79], a[76:79], v[204:207], v[64:79]
    v_add_u32 v241, 4294856704, v241
    ds_read_b64_tr_b16 a[68:69], v241 offset:0
    ds_read_b64_tr_b16 a[70:71], v241 offset:4096
    v_mfma_f32_32x32x16_bf16 v[80:95], a[80:83], v[204:207], v[80:95]
    ds_read_b64_tr_b16 a[72:73], v240 offset:1024
    ds_read_b64_tr_b16 a[74:75], v240 offset:5120
    s_waitcnt lgkmcnt(6)
    v_mfma_f32_32x32x16_bf16 v[96:111], a[84:87], v[204:207], v[96:111]
    ds_read_b64_tr_b16 a[76:77], v241 offset:1024
    ds_read_b64_tr_b16 a[78:79], v241 offset:5120
    v_mfma_f32_32x32x16_bf16 v[128:143], a[88:91], v[204:207], v[128:143]
    ds_read_b64_tr_b16 a[80:81], v240 offset:2048
    ds_read_b64_tr_b16 a[82:83], v240 offset:6144
    v_mfma_f32_32x32x16_bf16 a[0:15], a[92:95], v[204:207], a[0:15]
    ds_read_b64_tr_b16 a[84:85], v241 offset:2048
    ds_read_b64_tr_b16 a[86:87], v241 offset:6144
    s_waitcnt lgkmcnt(6)
    v_mfma_f32_32x32x16_bf16 v[0:15], a[64:67], v[208:211], v[0:15]
    ds_read_b64_tr_b16 a[88:89], v240 offset:3072
    ds_read_b64_tr_b16 a[90:91], v240 offset:7168
    s_add_u32 m0, s30, 110592
    s_add_u32 s32, s35, 166016
    buffer_load_dwordx4 v160, s[8:11], s32 offen lds
    buffer_load_dwordx4 a[140:143], v250, s[16:19], s36 offen offset:3072 sc1
    v_mfma_f32_32x32x16_bf16 v[16:31], a[68:71], v[208:211], v[16:31]
    ds_read_b64_tr_b16 a[92:93], v241 offset:3072
    ds_read_b64_tr_b16 a[94:95], v241 offset:7168
    v_mfma_f32_32x32x16_bf16 v[32:47], a[72:75], v[208:211], v[32:47]
    v_add_u32 v242, 4294856704, v242
    ds_read_b64_tr_b16 a[64:65], v242 offset:16384
    ds_read_b64_tr_b16 a[66:67], v242 offset:16896
    s_waitcnt lgkmcnt(6)
    v_mfma_f32_32x32x16_bf16 v[48:63], a[76:79], v[208:211], v[48:63]
    ds_read_b64_tr_b16 a[68:69], v240 offset:8192
    ds_read_b64_tr_b16 a[70:71], v240 offset:12288
    buffer_load_dwordx4 v161, s[8:11], s32 offen offset:1024 lds
    v_mfma_f32_32x32x16_bf16 v[64:79], a[80:83], v[208:211], v[64:79]
    ds_read_b64_tr_b16 a[72:73], v241 offset:8192
    ds_read_b64_tr_b16 a[74:75], v241 offset:12288
    v_mfma_f32_32x32x16_bf16 v[80:95], a[84:87], v[208:211], v[80:95]
    ds_read_b64_tr_b16 a[76:77], v240 offset:9216
    ds_read_b64_tr_b16 a[78:79], v240 offset:13312
    s_waitcnt lgkmcnt(6)
    v_mfma_f32_32x32x16_bf16 v[96:111], a[88:91], v[208:211], v[96:111]
    ds_read_b64_tr_b16 a[80:81], v241 offset:9216
    ds_read_b64_tr_b16 a[82:83], v241 offset:13312
    buffer_load_dwordx4 v162, s[8:11], s32 offen offset:2048 lds
    v_mfma_f32_32x32x16_bf16 v[128:143], a[92:95], v[208:211], v[128:143]
    ds_read_b64_tr_b16 a[84:85], v240 offset:10240
    ds_read_b64_tr_b16 a[86:87], v240 offset:14336
    v_mfma_f32_32x32x16_bf16 a[0:15], a[64:67], v[208:211], a[0:15]
    ds_read_b64_tr_b16 a[88:89], v241 offset:10240
    ds_read_b64_tr_b16 a[90:91], v241 offset:14336
    s_waitcnt lgkmcnt(6)
    v_mfma_f32_32x32x16_bf16 v[0:15], a[68:71], v[212:215], v[0:15]
    ds_read_b64_tr_b16 a[92:93], v240 offset:11264
    ds_read_b64_tr_b16 a[94:95], v240 offset:15360
    s_waitcnt vmcnt(6)
    s_mov_b64 exec, 1
    buffer_store_dword v252, v251, s[16:19], s74 offen offset:12 sc1
    s_mov_b64 exec, -1
    buffer_load_dwordx4 v163, s[8:11], s32 offen offset:3072 lds
    v_mfma_f32_32x32x16_bf16 v[16:31], a[72:75], v[212:215], v[16:31]
    ds_read_b64_tr_b16 a[64:65], v241 offset:11264
    ds_read_b64_tr_b16 a[66:67], v241 offset:15360
    s_add_u32 m0, s31, 110592
    s_cbranch_vccz L_x_37
    buffer_load_dwordx4 v164, s[8:11], s32 offen lds
L_x_37:
    v_mfma_f32_32x32x16_bf16 v[32:47], a[76:79], v[212:215], v[32:47]
    ds_read_b64_tr_b16 a[68:69], v242 offset:17408
    ds_read_b64_tr_b16 a[70:71], v242 offset:17920
    s_waitcnt vmcnt(37) lgkmcnt(6)
    v_mfma_f32_32x32x16_bf16 v[48:63], a[80:83], v[212:215], v[48:63]
    s_barrier
    ds_read_b64_tr_b16 a[72:73], v240 offset:18432
    ds_read_b64_tr_b16 a[74:75], v240 offset:22528
    v_mfma_f32_32x32x16_bf16 v[64:79], a[84:87], v[212:215], v[64:79]
    ds_read_b64_tr_b16 a[76:77], v241 offset:18432
    ds_read_b64_tr_b16 a[78:79], v241 offset:22528
    v_mfma_f32_32x32x16_bf16 v[80:95], a[88:91], v[212:215], v[80:95]
    ds_read_b64_tr_b16 a[80:81], v240 offset:19456
    ds_read_b64_tr_b16 a[82:83], v240 offset:23552
    s_waitcnt lgkmcnt(6)
    v_mfma_f32_32x32x16_bf16 v[96:111], a[92:95], v[212:215], v[96:111]
    ds_read_b64_tr_b16 a[84:85], v241 offset:19456
    ds_read_b64_tr_b16 a[86:87], v241 offset:23552
    v_mfma_f32_32x32x16_bf16 v[128:143], a[64:67], v[212:215], v[128:143]
    ds_read_b64_tr_b16 a[88:89], v240 offset:20480
    ds_read_b64_tr_b16 a[90:91], v240 offset:24576
    v_mfma_f32_32x32x16_bf16 a[0:15], a[68:71], v[212:215], a[0:15]
    ds_read_b64_tr_b16 a[92:93], v241 offset:20480
    ds_read_b64_tr_b16 a[94:95], v241 offset:24576
    s_waitcnt lgkmcnt(6)
    v_mfma_f32_32x32x16_bf16 v[0:15], a[72:75], v[216:219], v[0:15]
    ds_read_b64_tr_b16 a[64:65], v240 offset:21504
    ds_read_b64_tr_b16 a[66:67], v240 offset:25600
    s_add_u32 m0, s30, 129024
    s_add_u32 s32, s28, 256
    buffer_load_dwordx4 v243, s[8:11], s32 offen lds
    v_mfma_f32_32x32x16_bf16 v[16:31], a[76:79], v[216:219], v[16:31]
    ds_read_b64_tr_b16 a[68:69], v241 offset:21504
    ds_read_b64_tr_b16 a[70:71], v241 offset:25600
    v_mfma_f32_32x32x16_bf16 v[32:47], a[80:83], v[216:219], v[32:47]
    ds_read_b64_tr_b16 a[72:73], v242 offset:34816
    ds_read_b64_tr_b16 a[74:75], v242 offset:35328
    s_waitcnt lgkmcnt(6)
    v_mfma_f32_32x32x16_bf16 v[48:63], a[84:87], v[216:219], v[48:63]
    ds_read_b64_tr_b16 a[76:77], v240 offset:26624
    ds_read_b64_tr_b16 a[78:79], v240 offset:30720
    buffer_load_dwordx4 v244, s[8:11], s32 offen offset:1024 lds
    v_mfma_f32_32x32x16_bf16 v[64:79], a[88:91], v[216:219], v[64:79]
    ds_read_b64_tr_b16 a[80:81], v241 offset:26624
    ds_read_b64_tr_b16 a[82:83], v241 offset:30720
    v_mfma_f32_32x32x16_bf16 v[80:95], a[92:95], v[216:219], v[80:95]
    ds_read_b64_tr_b16 a[84:85], v240 offset:27648
    ds_read_b64_tr_b16 a[86:87], v240 offset:31744
    buffer_load_dword v255, v251, s[16:19], s75 offen offset:16 sc1
    s_waitcnt lgkmcnt(6)
    v_mfma_f32_32x32x16_bf16 v[96:111], a[64:67], v[216:219], v[96:111]
    ds_read_b64_tr_b16 a[88:89], v241 offset:27648
    ds_read_b64_tr_b16 a[90:91], v241 offset:31744
    buffer_load_dwordx4 v245, s[8:11], s32 offen offset:2048 lds
    v_mfma_f32_32x32x16_bf16 v[128:143], a[68:71], v[216:219], v[128:143]
    ds_read_b64_tr_b16 a[92:93], v240 offset:28672
    ds_read_b64_tr_b16 a[94:95], v240 offset:32768
    v_mfma_f32_32x32x16_bf16 a[0:15], a[72:75], v[216:219], a[0:15]
    ds_read_b64_tr_b16 a[64:65], v241 offset:28672
    ds_read_b64_tr_b16 a[66:67], v241 offset:32768
    s_waitcnt lgkmcnt(6)
    v_mfma_f32_32x32x16_bf16 v[0:15], a[76:79], v[220:223], v[0:15]
    ds_read_b64_tr_b16 a[68:69], v240 offset:29696
    ds_read_b64_tr_b16 a[70:71], v240 offset:33792
    buffer_load_dwordx4 v246, s[8:11], s32 offen offset:3072 lds
    v_mfma_f32_32x32x16_bf16 v[16:31], a[80:83], v[220:223], v[16:31]
    ds_read_b64_tr_b16 a[72:73], v241 offset:29696
    ds_read_b64_tr_b16 a[74:75], v241 offset:33792
    s_add_u32 m0, s31, 129024
    s_cbranch_vccnz L_x_38
    buffer_load_dwordx4 v247, s[8:11], s32 offen lds
L_x_38:
    v_mfma_f32_32x32x16_bf16 v[32:47], a[84:87], v[220:223], v[32:47]
    ds_read_b64_tr_b16 a[76:77], v242 offset:35840
    ds_read_b64_tr_b16 a[78:79], v242 offset:36352
    s_waitcnt vmcnt(34) lgkmcnt(6)
    v_mfma_f32_32x32x16_bf16 v[48:63], a[88:91], v[220:223], v[48:63]
    s_barrier
    ds_read_b64_tr_b16 a[80:81], v240 offset:36864
    ds_read_b64_tr_b16 a[82:83], v240 offset:40960
    v_mfma_f32_32x32x16_bf16 v[64:79], a[92:95], v[220:223], v[64:79]
    ds_read_b64_tr_b16 a[84:85], v241 offset:36864
    ds_read_b64_tr_b16 a[86:87], v241 offset:40960
    v_mfma_f32_32x32x16_bf16 v[80:95], a[64:67], v[220:223], v[80:95]
    ds_read_b64_tr_b16 a[88:89], v240 offset:37888
    ds_read_b64_tr_b16 a[90:91], v240 offset:41984
    s_waitcnt lgkmcnt(6)
    v_mfma_f32_32x32x16_bf16 v[96:111], a[68:71], v[220:223], v[96:111]
    ds_read_b64_tr_b16 a[92:93], v241 offset:37888
    ds_read_b64_tr_b16 a[94:95], v241 offset:41984
    v_mfma_f32_32x32x16_bf16 v[128:143], a[72:75], v[220:223], v[128:143]
    ds_read_b64_tr_b16 a[64:65], v240 offset:38912
    ds_read_b64_tr_b16 a[66:67], v240 offset:43008
    v_mfma_f32_32x32x16_bf16 a[0:15], a[76:79], v[220:223], a[0:15]
    ds_read_b64_tr_b16 a[68:69], v241 offset:38912
    ds_read_b64_tr_b16 a[70:71], v241 offset:43008
    s_waitcnt lgkmcnt(6)
    v_mfma_f32_32x32x16_bf16 v[0:15], a[80:83], v[224:227], v[0:15]
    ds_read_b64_tr_b16 a[72:73], v240 offset:39936
    ds_read_b64_tr_b16 a[74:75], v240 offset:44032
    s_add_u32 m0, s30, 0
    s_add_u32 s32, s35, 166144
    buffer_load_dwordx4 v160, s[8:11], s32 offen lds
    v_mfma_f32_32x32x16_bf16 v[16:31], a[84:87], v[224:227], v[16:31]
    ds_read_b64_tr_b16 a[76:77], v241 offset:39936
    ds_read_b64_tr_b16 a[78:79], v241 offset:44032
    v_mfma_f32_32x32x16_bf16 v[32:47], a[88:91], v[224:227], v[32:47]
    ds_read_b64_tr_b16 a[80:81], v242 offset:53248
    ds_read_b64_tr_b16 a[82:83], v242 offset:53760
    s_waitcnt lgkmcnt(6)
    v_mfma_f32_32x32x16_bf16 v[48:63], a[92:95], v[224:227], v[48:63]
    ds_read_b64_tr_b16 a[84:85], v240 offset:45056
    ds_read_b64_tr_b16 a[86:87], v240 offset:49152
    buffer_load_dwordx4 v161, s[8:11], s32 offen offset:1024 lds
    v_mfma_f32_32x32x16_bf16 v[64:79], a[64:67], v[224:227], v[64:79]
    ds_read_b64_tr_b16 a[88:89], v241 offset:45056
    ds_read_b64_tr_b16 a[90:91], v241 offset:49152
    v_mfma_f32_32x32x16_bf16 v[80:95], a[68:71], v[224:227], v[80:95]
    ds_read_b64_tr_b16 a[92:93], v240 offset:46080
    ds_read_b64_tr_b16 a[94:95], v240 offset:50176
    s_waitcnt vmcnt(4)
    v_cmp_eq_u32 s[44:45], v255, v252
    s_mov_b32 s42, 0x8000
    s_nop 0
    s_cmp_lg_u64 s[44:45], 0
    s_cbranch_scc1 L_pok_39
L_plp_40:
    buffer_load_dword v255, v251, s[16:19], s75 offen offset:16 sc1
    s_waitcnt vmcnt(0)
    v_cmp_eq_u32 s[44:45], v255, v252
    s_nop 1
    s_cmp_lg_u64 s[44:45], 0
    s_cbranch_scc1 L_pok_39
    s_sleep 1
    s_sub_u32 s42, s42, 1
    s_cbranch_scc0 L_plp_40
L_pok_39:
    s_cmp_eq_u32 s23, 0
    s_cbranch_scc0 L_adv_41
    s_mov_b64 exec, 1
    buffer_store_dword v252, v251, s[16:19], s38 offen sc1
    s_mov_b64 exec, -1
L_adv_41:
    s_waitcnt lgkmcnt(6)
    v_mfma_f32_32x32x16_bf16 v[96:111], a[72:75], v[224:227], v[96:111]
    ds_read_b64_tr_b16 a[64:65], v241 offset:46080
    ds_read_b64_tr_b16 a[66:67], v241 offset:50176
    buffer_load_dwordx4 v162, s[8:11], s32 offen offset:2048 lds
    s_add_u32 s36, s36, 4096
    buffer_load_dwordx4 a[144:147], v250, s[16:19], s36 offen offset:0 sc1
    v_mfma_f32_32x32x16_bf16 v[128:143], a[76:79], v[224:227], v[128:143]
    ds_read_b64_tr_b16 a[68:69], v240 offset:47104
    ds_read_b64_tr_b16 a[70:71], v240 offset:51200
    buffer_load_dwordx4 a[148:151], v250, s[16:19], s36 offen offset:1024 sc1
    v_mfma_f32_32x32x16_bf16 a[0:15], a[80:83], v[224:227], a[0:15]
    ds_read_b64_tr_b16 a[72:73], v241 offset:47104
    ds_read_b64_tr_b16 a[74:75], v241 offset:51200
    s_waitcnt lgkmcnt(6)
    v_mfma_f32_32x32x16_bf16 v[0:15], a[84:87], v[228:231], v[0:15]
    ds_read_b64_tr_b16 a[76:77], v240 offset:48128
    ds_read_b64_tr_b16 a[78:79], v240 offset:52224
    buffer_load_dwordx4 v163, s[8:11], s32 offen offset:3072 lds
    buffer_load_dwordx4 a[16:19], v250, s[16:19], s36 offen offset:2048 sc1
    v_mfma_f32_32x32x16_bf16 v[16:31], a[88:91], v[228:231], v[16:31]
    ds_read_b64_tr_b16 a[80:81], v241 offset:48128
    ds_read_b64_tr_b16 a[82:83], v241 offset:52224
    s_add_u32 m0, s31, 0
    s_cbranch_vccz L_x_42
    buffer_load_dwordx4 v164, s[8:11], s32 offen lds
L_x_42:
    v_mfma_f32_32x32x16_bf16 v[32:47], a[92:95], v[228:231], v[32:47]
    ds_read_b64_tr_b16 a[84:85], v242 offset:54272
    ds_read_b64_tr_b16 a[86:87], v242 offset:54784
    buffer_load_dwordx4 a[20:23], v250, s[16:19], s36 offen offset:3072 sc1
    s_waitcnt vmcnt(36) lgkmcnt(6)
    v_mfma_f32_32x32x16_bf16 v[48:63], a[64:67], v[228:231], v[48:63]
    s_barrier
    ds_read_b64_tr_b16 a[88:89], v240 offset:55296
    ds_read_b64_tr_b16 a[90:91], v240 offset:56320
    s_add_u32 s36, s36, 4096
    buffer_load_dwordx4 a[24:27], v250, s[16:19], s36 offen offset:0 sc1
    v_mfma_f32_32x32x16_bf16 v[64:79], a[68:71], v[228:231], v[64:79]
    ds_read_b64_tr_b16 a[92:93], v241 offset:55296
    ds_read_b64_tr_b16 a[94:95], v241 offset:56320
    v_mfma_f32_32x32x16_bf16 v[80:95], a[72:75], v[228:231], v[80:95]
    ds_read_b64_tr_b16 a[64:65], v240 offset:57344
    ds_read_b64_tr_b16 a[66:67], v240 offset:58368
    buffer_load_dwordx4 a[28:31], v250, s[16:19], s36 offen offset:1024 sc1
    s_waitcnt lgkmcnt(6)
    v_mfma_f32_32x32x16_bf16 v[96:111], a[76:79], v[228:231], v[96:111]
    ds_read_b64_tr_b16 a[68:69], v241 offset:57344
    ds_read_b64_tr_b16 a[70:71], v241 offset:58368
    v_mfma_f32_32x32x16_bf16 v[128:143], a[80:83], v[228:231], v[128:143]
    ds_read_b64_tr_b16 a[72:73], v240 offset:59392
    ds_read_b64_tr_b16 a[74:75], v240 offset:60416
    v_mfma_f32_32x32x16_bf16 a[0:15], a[84:87], v[228:231], a[0:15]
    ds_read_b64_tr_b16 a[76:77], v241 offset:59392
    ds_read_b64_tr_b16 a[78:79], v241 offset:60416
    s_waitcnt vmcnt(30) lgkmcnt(6)
    v_mfma_f32_32x32x16_bf16 v[0:15], a[88:91], a[96:99], v[0:15]
    ds_read_b64_tr_b16 a[80:81], v240 offset:61440
    ds_read_b64_tr_b16 a[82:83], v240 offset:62464
    s_add_u32 m0, s30, 18432
    s_add_u32 s32, s28, 384
    buffer_load_dwordx4 v243, s[8:11], s32 offen lds
    v_mfma_f32_32x32x16_bf16 v[16:31], a[92:95], a[96:99], v[16:31]
    ds_read_b64_tr_b16 a[84:85], v241 offset:61440
    ds_read_b64_tr_b16 a[86:87], v241 offset:62464
    v_mfma_f32_32x32x16_bf16 v[0:15], a[64:67], a[100:103], v[0:15]
    ds_read_b64_tr_b16 a[88:89], v240 offset:63488
    ds_read_b64_tr_b16 a[90:91], v240 offset:64512
    s_waitcnt lgkmcnt(6)
    v_mfma_f32_32x32x16_bf16 v[16:31], a[68:71], a[100:103], v[16:31]
    ds_read_b64_tr_b16 a[92:93], v241 offset:63488
    ds_read_b64_tr_b16 a[94:95], v241 offset:64512
    buffer_load_dwordx4 v244, s[8:11], s32 offen offset:1024 lds
    v_mfma_f32_32x32x16_bf16 v[0:15], a[72:75], a[104:107], v[0:15]
    v_add_u32 v240, 55296, v240
    ds_read_b64_tr_b16 a[64:65], v240 offset:10240
    ds_read_b64_tr_b16 a[66:67], v240 offset:11264
    v_mfma_f32_32x32x16_bf16 v[16:31], a[76:79], a[104:107], v[16:31]
    v_add_u32 v241, 55296, v241
    ds_read_b64_tr_b16 a[68:69], v241 offset:10240
    ds_read_b64_tr_b16 a[70:71], v241 offset:11264
    s_waitcnt lgkmcnt(6)
    v_mfma_f32_32x32x16_bf16 v[0:15], a[80:83], a[108:111], v[0:15]
    ds_read_b64_tr_b16 a[72:73], v240 offset:12288
    ds_read_b64_tr_b16 a[74:75], v240 offset:13312
    buffer_load_dwordx4 v245, s[8:11], s32 offen offset:2048 lds
    v_mfma_f32_32x32x16_bf16 v[16:31], a[84:87], a[108:111], v[16:31]
    ds_read_b64_tr_b16 a[76:77], v241 offset:12288
    ds_read_b64_tr_b16 a[78:79], v241 offset:13312
    v_mfma_f32_32x32x16_bf16 v[0:15], a[88:91], a[112:115], v[0:15]
    ds_read_b64_tr_b16 a[80:81], v240 offset:14336
    ds_read_b64_tr_b16 a[82:83], v240 offset:15360
    s_waitcnt lgkmcnt(6)
    v_mfma_f32_32x32x16_bf16 v[16:31], a[92:95], a[112:115], v[16:31]
    ds_read_b64_tr_b16 a[84:85], v241 offset:14336
    ds_read_b64_tr_b16 a[86:87], v241 offset:15360
    buffer_load_dwordx4 v246, s[8:11], s32 offen offset:3072 lds
    v_mfma_f32_32x32x16_bf16 v[0:15], a[64:67], a[116:119], v[0:15]
    ds_read_b64_tr_b16 a[88:89], v240 offset:16384
    ds_read_b64_tr_b16 a[90:91], v240 offset:17408
    s_add_u32 m0, s31, 18432
    s_cbranch_vccnz L_x_43
    buffer_load_dwordx4 v247, s[8:11], s32 offen lds
L_x_43:
    v_mfma_f32_32x32x16_bf16 v[16:31], a[68:71], a[116:119], v[16:31]
    ds_read_b64_tr_b16 a[92:93], v241 offset:16384
    ds_read_b64_tr_b16 a[94:95], v241 offset:17408
    s_waitcnt vmcnt(35) lgkmcnt(6)
    v_mfma_f32_32x32x16_bf16 v[0:15], a[72:75], a[120:123], v[0:15]
    s_barrier
    ds_read_b64_tr_b16 a[64:65], v240 offset:18432
    ds_read_b64_tr_b16 a[66:67], v240 offset:19456
    buffer_load_dword v237, v250, s[16:19], s68 offen sc1
    v_accvgpr_read_b32 v238, a251
    v_mul_lo_u32 v238, v238, s50
    v_add_u32 v238, 0x7f4a7c15, v238
    v_mfma_f32_32x32x16_bf16 v[16:31], a[76:79], a[120:123], v[16:31]
    ds_read_b64_tr_b16 a[68:69], v241 offset:18432
    ds_read_b64_tr_b16 a[70:71], v241 offset:19456
    v_mfma_f32_32x32x16_bf16 v[0:15], a[80:83], a[124:127], v[0:15]
    ds_read_b64_tr_b16 a[72:73], v240 offset:20480
    ds_read_b64_tr_b16 a[74:75], v240 offset:21504
    s_waitcnt lgkmcnt(6)
    v_mfma_f32_32x32x16_bf16 v[16:31], a[84:87], a[124:127], v[16:31]
    ds_read_b64_tr_b16 a[76:77], v241 offset:20480
    ds_read_b64_tr_b16 a[78:79], v241 offset:21504
    v_mfma_f32_32x32x16_bf16 v[0:15], a[88:91], a[128:131], v[0:15]
    ds_read_b64_tr_b16 a[80:81], v240 offset:22528
    ds_read_b64_tr_b16 a[82:83], v240 offset:23552
    v_mfma_f32_32x32x16_bf16 v[16:31], a[92:95], a[128:131], v[16:31]
    ds_read_b64_tr_b16 a[84:85], v241 offset:22528
    ds_read_b64_tr_b16 a[86:87], v241 offset:23552
    s_waitcnt vmcnt(26) lgkmcnt(6)
    v_mfma_f32_32x32x16_bf16 v[0:15], a[64:67], a[132:135], v[0:15]
    ds_read_b64_tr_b16 a[88:89], v240 offset:24576
    ds_read_b64_tr_b16 a[90:91], v240 offset:25600
    s_add_u32 m0, s30, 36864
    s_add_u32 s32, s35, 166272
    buffer_load_dwordx4 v160, s[8:11], s32 offen lds
    v_mfma_f32_32x32x16_bf16 v[16:31], a[68:71], a[132:135], v[16:31]
    ds_read_b64_tr_b16 a[92:93], v241 offset:24576
    ds_read_b64_tr_b16 a[94:95], v241 offset:25600
    v_mfma_f32_32x32x16_bf16 v[0:15], a[72:75], a[136:139], v[0:15]
    ds_read_b64_tr_b16 a[64:65], v240 offset:26624
    ds_read_b64_tr_b16 a[66:67], v240 offset:27648
    s_waitcnt lgkmcnt(6)
    v_mfma_f32_32x32x16_bf16 v[16:31], a[76:79], a[136:139], v[16:31]
    ds_read_b64_tr_b16 a[68:69], v241 offset:26624
    ds_read_b64_tr_b16 a[70:71], v241 offset:27648
    buffer_load_dwordx4 v161, s[8:11], s32 offen offset:1024 lds
    v_mfma_f32_32x32x16_bf16 v[0:15], a[80:83], a[140:143], v[0:15]
    ds_read_b64_tr_b16 a[72:73], v240 offset:28672
    ds_read_b64_tr_b16 a[74:75], v240 offset:29696
    v_mfma_f32_32x32x16_bf16 v[16:31], a[84:87], a[140:143], v[16:31]
    ds_read_b64_tr_b16 a[76:77], v241 offset:28672
    ds_read_b64_tr_b16 a[78:79], v241 offset:29696
    s_waitcnt vmcnt(7) lgkmcnt(6)
    v_mfma_f32_32x32x16_bf16 v[0:15], a[88:91], a[144:147], v[0:15]
    ds_read_b64_tr_b16 a[80:81], v240 offset:30720
    ds_read_b64_tr_b16 a[82:83], v240 offset:31744
    buffer_load_dwordx4 v162, s[8:11], s32 offen offset:2048 lds
    v_mfma_f32_32x32x16_bf16 v[16:31], a[92:95], a[144:147], v[16:31]
    ds_read_b64_tr_b16 a[84:85], v241 offset:30720
    ds_read_b64_tr_b16 a[86:87], v241 offset:31744
    v_mfma_f32_32x32x16_bf16 v[0:15], a[64:67], a[148:151], v[0:15]
    ds_read_b64_tr_b16 a[88:89], v240 offset:32768
    ds_read_b64_tr_b16 a[90:91], v240 offset:33792
    s_waitcnt lgkmcnt(6)
    v_mfma_f32_32x32x16_bf16 v[16:31], a[68:71], a[148:151], v[16:31]
    ds_read_b64_tr_b16 a[92:93], v241 offset:32768
    ds_read_b64_tr_b16 a[94:95], v241 offset:33792
    buffer_load_dwordx4 v163, s[8:11], s32 offen offset:3072 lds
    v_mfma_f32_32x32x16_bf16 v[0:15], a[72:75], a[16:19], v[0:15]
    ds_read_b64_tr_b16 a[64:65], v240 offset:34816
    ds_read_b64_tr_b16 a[66:67], v240 offset:35840
    s_add_u32 m0, s31, 36864
    s_cbranch_vccz L_x_44
    buffer_load_dwordx4 v164, s[8:11], s32 offen lds
L_x_44:
    v_mfma_f32_32x32x16_bf16 v[16:31], a[76:79], a[16:19], v[16:31]
    ds_read_b64_tr_b16 a[68:69], v241 offset:34816
    ds_read_b64_tr_b16 a[70:71], v241 offset:35840
    v_accvgpr_read_b32 v247, a43
    s_mul_i32 s92, s20, 73728
    s_add_u32 s93, s92, 4096
    s_waitcnt vmcnt(33) lgkmcnt(6)
    v_mfma_f32_32x32x16_bf16 v[0:15], a[80:83], a[20:23], v[0:15]
    s_barrier
    ds_read_b64_tr_b16 a[72:73], v240 offset:36864
    ds_read_b64_tr_b16 a[74:75], v240 offset:37888
    s_add_u32 s93, s93, s99
    v_add_u32 v243, s93, v247
    v_mfma_f32_32x32x16_bf16 v[16:31], a[84:87], a[20:23], v[16:31]
    ds_read_b64_tr_b16 a[76:77], v241 offset:36864
    ds_read_b64_tr_b16 a[78:79], v241 offset:37888
    s_add_u32 s93, s92, 21504
    s_add_u32 s93, s93, s99
    v_add_u32 v244, s93, v247
    v_mfma_f32_32x32x16_bf16 v[0:15], a[88:91], a[24:27], v[0:15]
    ds_read_b64_tr_b16 a[80:81], v240 offset:38912
    ds_read_b64_tr_b16 a[82:83], v240 offset:39936
    s_add_u32 s93, s92, 38912
    s_add_u32 s93, s93, s99
    s_waitcnt lgkmcnt(6)
    v_mfma_f32_32x32x16_bf16 v[16:31], a[92:95], a[24:27], v[16:31]
    ds_read_b64_tr_b16 a[84:85], v241 offset:38912
    ds_read_b64_tr_b16 a[86:87], v241 offset:39936
    v_add_u32 v245, s93, v247
    s_add_u32 s93, s92, 56320
    s_add_u32 s93, s93, s99
    v_mfma_f32_32x32x16_bf16 v[0:15], a[64:67], a[28:31], v[0:15]
    ds_read_b64_tr_b16 a[88:89], v240 offset:40960
    ds_read_b64_tr_b16 a[90:91], v240 offset:41984
    v_add_u32 v246, s93, v247
    s_mul_i32 s93, s49, 18432
    v_mfma_f32_32x32x16_bf16 v[16:31], a[68:71], a[28:31], v[16:31]
    ds_read_b64_tr_b16 a[92:93], v241 offset:40960
    ds_read_b64_tr_b16 a[94:95], v241 offset:41984
    s_add_u32 s93, s93, 299008
    v_add_u32 v247, s93, v247
    s_waitcnt lgkmcnt(6)
    v_mfma_f32_32x32x16_bf16 v[32:47], a[72:75], a[96:99], v[32:47]
    ds_read_b64_tr_b16 a[64:65], v240 offset:43008
    ds_read_b64_tr_b16 a[66:67], v240 offset:44032
    s_add_u32 m0, s30, 55296
    s_add_u32 s32, s29, 0
    buffer_load_dwordx4 v243, s[8:11], s32 offen lds
    v_mfma_f32_32x32x16_bf16 v[48:63], a[76:79], a[96:99], v[48:63]
    ds_read_b64_tr_b16 a[68:69], v241 offset:43008
    ds_read_b64_tr_b16 a[70:71], v241 offset:44032
    v_mfma_f32_32x32x16_bf16 v[32:47], a[80:83], a[100:103], v[32:47]
    ds_read_b64_tr_b16 a[72:73], v240 offset:45056
    ds_read_b64_tr_b16 a[74:75], v240 offset:46080
    s_waitcnt lgkmcnt(6)
    v_mfma_f32_32x32x16_bf16 v[48:63], a[84:87], a[100:103], v[48:63]
    ds_read_b64_tr_b16 a[76:77], v241 offset:45056
    ds_read_b64_tr_b16 a[78:79], v241 offset:46080
    buffer_load_dwordx4 v244, s[8:11], s32 offen offset:1024 lds
    v_mfma_f32_32x32x16_bf16 v[32:47], a[88:91], a[104:107], v[32:47]
    ds_read_b64_tr_b16 a[80:81], v240 offset:47104
    ds_read_b64_tr_b16 a[82:83], v240 offset:48128
    v_cvt_pk_bf16_f32 v144, v0, v1
    v_mfma_f32_32x32x16_bf16 v[48:63], a[92:95], a[104:107], v[48:63]
    ds_read_b64_tr_b16 a[84:85], v241 offset:47104
    ds_read_b64_tr_b16 a[86:87], v241 offset:48128
    v_cvt_pk_bf16_f32 v145, v2, v3
    s_waitcnt lgkmcnt(6)
    v_mfma_f32_32x32x16_bf16 v[32:47], a[64:67], a[108:111], v[32:47]
    ds_read_b64_tr_b16 a[88:89], v240 offset:49152
    ds_read_b64_tr_b16 a[90:91], v240 offset:50176
    buffer_load_dwordx4 v245, s[8:11], s32 offen offset:2048 lds
    v_mfma_f32_32x32x16_bf16 v[48:63], a[68:71], a[108:111], v[48:63]
    ds_read_b64_tr_b16 a[92:93], v241 offset:49152
    ds_read_b64_tr_b16 a[94:95], v241 offset:50176
    v_cvt_pk_bf16_f32 v146, v4, v5
    v_mfma_f32_32x32x16_bf16 v[32:47], a[72:75], a[112:115], v[32:47]
    ds_read_b64_tr_b16 a[64:65], v240 offset:51200
    ds_read_b64_tr_b16 a[66:67], v240 offset:52224
    s_waitcnt lgkmcnt(6)
    v_mfma_f32_32x32x16_bf16 v[48:63], a[76:79], a[112:115], v[48:63]
    ds_read_b64_tr_b16 a[68:69], v241 offset:51200
    ds_read_b64_tr_b16 a[70:71], v241 offset:52224
    buffer_load_dwordx4 v246, s[8:11], s32 offen offset:3072 lds
    v_mfma_f32_32x32x16_bf16 v[32:47], a[80:83], a[116:119], v[32:47]
    ds_read_b64_tr_b16 a[72:73], v240 offset:53248
    ds_read_b64_tr_b16 a[74:75], v240 offset:54272
    s_add_u32 m0, s31, 55296
    s_cbranch_vccnz L_x_45
    buffer_load_dwordx4 v247, s[8:11], s32 offen lds
L_x_45:
    v_mfma_f32_32x32x16_bf16 v[48:63], a[84:87], a[116:119], v[48:63]
    ds_read_b64_tr_b16 a[76:77], v241 offset:53248
    ds_read_b64_tr_b16 a[78:79], v241 offset:54272
    s_waitcnt vmcnt(30) lgkmcnt(6)
    v_mfma_f32_32x32x16_bf16 v[32:47], a[88:91], a[120:123], v[32:47]
    s_barrier
    ds_read_b64_tr_b16 a[80:81], v240 offset:55296
    ds_read_b64_tr_b16 a[82:83], v240 offset:56320
    v_mfma_f32_32x32x16_bf16 v[48:63], a[92:95], a[120:123], v[48:63]
    ds_read_b64_tr_b16 a[84:85], v241 offset:55296
    ds_read_b64_tr_b16 a[86:87], v241 offset:56320
    v_mfma_f32_32x32x16_bf16 v[32:47], a[64:67], a[124:127], v[32:47]
    ds_read_b64_tr_b16 a[88:89], v240 offset:57344
    ds_read_b64_tr_b16 a[90:91], v240 offset:58368
    s_waitcnt lgkmcnt(6)
    v_mfma_f32_32x32x16_bf16 v[48:63], a[68:71], a[124:127], v[48:63]
    ds_read_b64_tr_b16 a[92:93], v241 offset:57344
    ds_read_b64_tr_b16 a[94:95], v241 offset:58368
    v_cvt_pk_bf16_f32 v147, v6, v7
    v_mfma_f32_32x32x16_bf16 v[32:47], a[72:75], a[128:131], v[32:47]
    ds_read_b64_tr_b16 a[64:65], v240 offset:59392
    ds_read_b64_tr_b16 a[66:67], v240 offset:60416
    buffer_store_dwordx4 v[144:147], v250, s[16:19], s37 offen offset:0 sc1
    v_mfma_f32_32x32x16_bf16 v[48:63], a[76:79], a[128:131], v[48:63]
    ds_read_b64_tr_b16 a[68:69], v241 offset:59392
    ds_read_b64_tr_b16 a[70:71], v241 offset:60416
    s_waitcnt lgkmcnt(6)
    v_mfma_f32_32x32x16_bf16 v[32:47], a[80:83], a[132:135], v[32:47]
    ds_read_b64_tr_b16 a[72:73], v240 offset:61440
    ds_read_b64_tr_b16 a[74:75], v240 offset:62464
    v_cvt_pk_bf16_f32 v148, v8, v9
    v_mfma_f32_32x32x16_bf16 v[48:63], a[84:87], a[132:135], v[48:63]
    ds_read_b64_tr_b16 a[76:77], v241 offset:61440
    ds_read_b64_tr_b16 a[78:79], v241 offset:62464
    v_cvt_pk_bf16_f32 v149, v10, v11
    v_cvt_pk_bf16_f32 v150, v12, v13
    v_mfma_f32_32x32x16_bf16 v[32:47], a[88:91], a[136:139], v[32:47]
    ds_read_b64_tr_b16 a[80:81], v240 offset:63488
    ds_read_b64_tr_b16 a[82:83], v240 offset:64512
    s_waitcnt lgkmcnt(6)
    v_mfma_f32_32x32x16_bf16 v[48:63], a[92:95], a[136:139], v[48:63]
    ds_read_b64_tr_b16 a[84:85], v241 offset:63488
    ds_read_b64_tr_b16 a[86:87], v241 offset:64512
    v_cvt_pk_bf16_f32 v151, v14, v15
    v_mfma_f32_32x32x16_bf16 v[32:47], a[64:67], a[140:143], v[32:47]
    v_add_u32 v240, 55296, v240
    ds_read_b64_tr_b16 a[88:89], v240 offset:10240
    ds_read_b64_tr_b16 a[90:91], v240 offset:11264
    buffer_store_dwordx4 v[148:151], v250, s[16:19], s37 offen offset:1024 sc1
    v_mfma_f32_32x32x16_bf16 v[48:63], a[68:71], a[140:143], v[48:63]
    v_add_u32 v241, 55296, v241
    ds_read_b64_tr_b16 a[92:93], v241 offset:10240
    ds_read_b64_tr_b16 a[94:95], v241 offset:11264
    s_waitcnt lgkmcnt(6)
    v_mfma_f32_32x32x16_bf16 v[32:47], a[72:75], a[144:147], v[32:47]
    ds_read_b64_tr_b16 a[64:65], v240 offset:12288
    ds_read_b64_tr_b16 a[66:67], v240 offset:13312
    v_cvt_pk_bf16_f32 v152, v16, v17
    v_cvt_pk_bf16_f32 v153, v18, v19
    v_mfma_f32_32x32x16_bf16 v[48:63], a[76:79], a[144:147], v[48:63]
    ds_read_b64_tr_b16 a[68:69], v241 offset:12288
    ds_read_b64_tr_b16 a[70:71], v241 offset:13312
    v_cvt_pk_bf16_f32 v154, v20, v21
    v_mfma_f32_32x32x16_bf16 v[32:47], a[80:83], a[148:151], v[32:47]
    ds_read_b64_tr_b16 a[72:73], v240 offset:14336
    ds_read_b64_tr_b16 a[74:75], v240 offset:15360
    s_waitcnt lgkmcnt(6)
    v_mfma_f32_32x32x16_bf16 v[48:63], a[84:87], a[148:151], v[48:63]
    ds_read_b64_tr_b16 a[76:77], v241 offset:14336
    ds_read_b64_tr_b16 a[78:79], v241 offset:15360
    v_cvt_pk_bf16_f32 v155, v22, v23
    v_mfma_f32_32x32x16_bf16 v[32:47], a[88:91], a[16:19], v[32:47]
    ds_read_b64_tr_b16 a[80:81], v240 offset:16384
    ds_read_b64_tr_b16 a[82:83], v240 offset:17408
    s_add_u32 s37, s37, 98304
    buffer_store_dwordx4 v[152:155], v250, s[16:19], s37 offen offset:0 sc1
    v_mfma_f32_32x32x16_bf16 v[48:63], a[92:95], a[16:19], v[48:63]
    ds_read_b64_tr_b16 a[84:85], v241 offset:16384
    ds_read_b64_tr_b16 a[86:87], v241 offset:17408
    s_waitcnt vmcnt(12)
    v_cmp_ne_u32 s[44:45], v238, v237
    s_mov_b32 s42, 0x8000
    s_nop 0
    s_cmp_eq_u64 s[44:45], 0
    s_cbranch_scc1 L_xok_46
L_xlp_47:
    buffer_load_dword v237, v250, s[16:19], s68 offen sc1
    s_waitcnt vmcnt(0)
    v_cmp_ne_u32 s[44:45], v238, v237
    s_nop 1
    s_cmp_eq_u64 s[44:45], 0
    s_cbranch_scc1 L_xok_46
    s_sleep 1
    s_sub_u32 s42, s42, 1
    s_cbranch_scc0 L_xlp_47
L_xok_46:
    s_lshl_b32 s44, s101, 13
    s_add_u32 s44, s44, 44040308
    s_lshl_b32 s47, s20, 10
    s_add_u32 s46, s44, s47
    s_lshl_b32 s45, s20, 2
    s_add_u32 s72, s44, s45
    s_mul_i32 s73, s20, 4640
    s_waitcnt vmcnt(28) lgkmcnt(6)
    v_mfma_f32_32x32x16_bf16 v[32:47], a[64:67], a[20:23], v[32:47]
    s_barrier
    ds_read_b64_tr_b16 a[88:89], v240 offset:18432
    ds_read_b64_tr_b16 a[90:91], v240 offset:19456
    v_mfma_f32_32x32x16_bf16 v[48:63], a[68:71], a[20:23], v[48:63]
    ds_read_b64_tr_b16 a[92:93], v241 offset:18432
    ds_read_b64_tr_b16 a[94:95], v241 offset:19456
    v_cvt_pk_bf16_f32 v156, v24, v25
    v_mfma_f32_32x32x16_bf16 v[32:47], a[72:75], a[24:27], v[32:47]
    ds_read_b64_tr_b16 a[64:65], v240 offset:20480
    ds_read_b64_tr_b16 a[66:67], v240 offset:21504
    s_waitcnt lgkmcnt(6)
    v_mfma_f32_32x32x16_bf16 v[48:63], a[76:79], a[24:27], v[48:63]
    ds_read_b64_tr_b16 a[68:69], v241 offset:20480
    ds_read_b64_tr_b16 a[70:71], v241 offset:21504
    v_cvt_pk_bf16_f32 v157, v26, v27
    v_mfma_f32_32x32x16_bf16 v[32:47], a[80:83], a[28:31], v[32:47]
    ds_read_b64_tr_b16 a[72:73], v240 offset:22528
    ds_read_b64_tr_b16 a[74:75], v240 offset:23552
    v_cvt_pk_bf16_f32 v158, v28, v29
    v_cvt_pk_bf16_f32 v159, v30, v31
    v_mfma_f32_32x32x16_bf16 v[48:63], a[84:87], a[28:31], v[48:63]
    ds_read_b64_tr_b16 a[76:77], v241 offset:22528
    ds_read_b64_tr_b16 a[78:79], v241 offset:23552
    s_waitcnt lgkmcnt(6)
    v_mfma_f32_32x32x16_bf16 v[64:79], a[88:91], a[96:99], v[64:79]
    ds_read_b64_tr_b16 a[80:81], v240 offset:24576
    ds_read_b64_tr_b16 a[82:83], v240 offset:25600
    buffer_store_dwordx4 v[156:159], v250, s[16:19], s37 offen offset:1024 sc1
    v_mfma_f32_32x32x16_bf16 v[80:95], a[92:95], a[96:99], v[80:95]
    ds_read_b64_tr_b16 a[84:85], v241 offset:24576
    ds_read_b64_tr_b16 a[86:87], v241 offset:25600
    v_mfma_f32_32x32x16_bf16 v[64:79], a[64:67], a[100:103], v[64:79]
    ds_read_b64_tr_b16 a[88:89], v240 offset:26624
    ds_read_b64_tr_b16 a[90:91], v240 offset:27648
    s_waitcnt lgkmcnt(6)
    v_mfma_f32_32x32x16_bf16 v[80:95], a[68:71], a[100:103], v[80:95]
    ds_read_b64_tr_b16 a[92:93], v241 offset:26624
    ds_read_b64_tr_b16 a[94:95], v241 offset:27648
    v_cvt_pk_bf16_f32 v144, v32, v33
    v_mfma_f32_32x32x16_bf16 v[64:79], a[72:75], a[104:107], v[64:79]
    ds_read_b64_tr_b16 a[64:65], v240 offset:28672
    ds_read_b64_tr_b16 a[66:67], v240 offset:29696
    v_cvt_pk_bf16_f32 v145, v34, v35
    v_mfma_f32_32x32x16_bf16 v[80:95], a[76:79], a[104:107], v[80:95]
    ds_read_b64_tr_b16 a[68:69], v241 offset:28672
    ds_read_b64_tr_b16 a[70:71], v241 offset:29696
    s_waitcnt lgkmcnt(6)
    v_mfma_f32_32x32x16_bf16 v[64:79], a[80:83], a[108:111], v[64:79]
    ds_read_b64_tr_b16 a[72:73], v240 offset:30720
    ds_read_b64_tr_b16 a[74:75], v240 offset:31744
    v_cvt_pk_bf16_f32 v146, v36, v37
    v_mfma_f32_32x32x16_bf16 v[80:95], a[84:87], a[108:111], v[80:95]
    ds_read_b64_tr_b16 a[76:77], v241 offset:30720
    ds_read_b64_tr_b16 a[78:79], v241 offset:31744
    v_cvt_pk_bf16_f32 v147, v38, v39
    v_mfma_f32_32x32x16_bf16 v[64:79], a[88:91], a[112:115], v[64:79]
    ds_read_b64_tr_b16 a[80:81], v240 offset:32768
    ds_read_b64_tr_b16 a[82:83], v240 offset:33792
    s_waitcnt lgkmcnt(6)
    v_mfma_f32_32x32x16_bf16 v[80:95], a[92:95], a[112:115], v[80:95]
    ds_read_b64_tr_b16 a[84:85], v241 offset:32768
    ds_read_b64_tr_b16 a[86:87], v241 offset:33792
    s_add_u32 s37, s37, 98304
    buffer_store_dwordx4 v[144:147], v250, s[16:19], s37 offen offset:0 sc1
    v_mfma_f32_32x32x16_bf16 v[64:79], a[64:67], a[116:119], v[64:79]
    ds_read_b64_tr_b16 a[88:89], v240 offset:34816
    ds_read_b64_tr_b16 a[90:91], v240 offset:35840
    v_mfma_f32_32x32x16_bf16 v[80:95], a[68:71], a[116:119], v[80:95]
    ds_read_b64_tr_b16 a[92:93], v241 offset:34816
    ds_read_b64_tr_b16 a[94:95], v241 offset:35840
    s_waitcnt vmcnt(22) lgkmcnt(6)
    v_mfma_f32_32x32x16_bf16 v[64:79], a[72:75], a[120:123], v[64:79]
    s_barrier
    v_add_u32 v240, 4294856704, v240
    ds_read_b64_tr_b16 a[64:65], v240 offset:0
    ds_read_b64_tr_b16 a[66:67], v240 offset:1024
    v_mfma_f32_32x32x16_bf16 v[80:95], a[76:79], a[120:123], v[80:95]
    v_add_u32 v241, 4294856704, v241
    ds_read_b64_tr_b16 a[68:69], v241 offset:0
    ds_read_b64_tr_b16 a[70:71], v241 offset:1024
    v_cvt_pk_bf16_f32 v148, v40, v41
    v_mfma_f32_32x32x16_bf16 v[64:79], a[80:83], a[124:127], v[64:79]
    ds_read_b64_tr_b16 a[72:73], v240 offset:2048
    ds_read_b64_tr_b16 a[74:75], v240 offset:3072
    s_waitcnt lgkmcnt(6)
    v_mfma_f32_32x32x16_bf16 v[80:95], a[84:87], a[124:127], v[80:95]
    ds_read_b64_tr_b16 a[76:77], v241 offset:2048
    ds_read_b64_tr_b16 a[78:79], v241 offset:3072
    v_cvt_pk_bf16_f32 v149, v42, v43
    s_lshl_b32 s40, s70, 12
    s_lshl_b32 s41, s20, 10
    s_add_u32 s40, s40, s41
    s_add_u32 s86, s40, 54657024
    s_lshl_b32 s40, s22, 7
    s_add_u32 s85, s40, s86
    s_cmp_lt_u32 s22, 4
    s_cselect_b32 s3, 2, 2
    v_bfe_u32 v239, v253, 4, 1
    v_mul_u32_u24 v239, 98048, v239
    v_add_u32 v243, v239, v250
    v_and_b32 v239, 7, v253
    v_lshlrev_b32 v239, 7, v239
    v_mfma_f32_32x32x16_bf16 v[64:79], a[88:91], a[128:131], v[64:79]
    ds_read_b64_tr_b16 a[80:81], v240 offset:4096
    ds_read_b64_tr_b16 a[82:83], v240 offset:5120
    v_cvt_pk_bf16_f32 v150, v44, v45
    v_mfma_f32_32x32x16_bf16 v[80:95], a[92:95], a[128:131], v[80:95]
    ds_read_b64_tr_b16 a[84:85], v241 offset:4096
    ds_read_b64_tr_b16 a[86:87], v241 offset:5120
    s_waitcnt lgkmcnt(6)
    v_mfma_f32_32x32x16_bf16 v[64:79], a[64:67], a[132:135], v[64:79]
    ds_read_b64_tr_b16 a[88:89], v240 offset:6144
    ds_read_b64_tr_b16 a[90:91], v240 offset:7168
    v_cvt_pk_bf16_f32 v151, v46, v47
    v_mfma_f32_32x32x16_bf16 v[80:95], a[68:71], a[132:135], v[80:95]
    ds_read_b64_tr_b16 a[92:93], v241 offset:6144
    ds_read_b64_tr_b16 a[94:95], v241 offset:7168
    buffer_store_dwordx4 v[148:151], v250, s[16:19], s37 offen offset:1024 sc1
    v_cvt_pk_bf16_f32 v152, v48, v49
    v_mfma_f32_32x32x16_bf16 v[64:79], a[72:75], a[136:139], v[64:79]
    ds_read_b64_tr_b16 a[64:65], v240 offset:8192
    ds_read_b64_tr_b16 a[66:67], v240 offset:9216
    s_waitcnt lgkmcnt(6)
    v_mfma_f32_32x32x16_bf16 v[80:95], a[76:79], a[136:139], v[80:95]
    ds_read_b64_tr_b16 a[68:69], v241 offset:8192
    ds_read_b64_tr_b16 a[70:71], v241 offset:9216
    v_cvt_pk_bf16_f32 v153, v50, v51
    v_mfma_f32_32x32x16_bf16 v[64:79], a[80:83], a[140:143], v[64:79]
    ds_read_b64_tr_b16 a[72:73], v240 offset:10240
    ds_read_b64_tr_b16 a[74:75], v240 offset:11264
    v_cvt_pk_bf16_f32 v154, v52, v53
    v_mfma_f32_32x32x16_bf16 v[80:95], a[84:87], a[140:143], v[80:95]
    ds_read_b64_tr_b16 a[76:77], v241 offset:10240
    ds_read_b64_tr_b16 a[78:79], v241 offset:11264
    s_waitcnt lgkmcnt(6)
    v_mfma_f32_32x32x16_bf16 v[64:79], a[88:91], a[144:147], v[64:79]
    ds_read_b64_tr_b16 a[80:81], v240 offset:12288
    ds_read_b64_tr_b16 a[82:83], v240 offset:13312
    v_cvt_pk_bf16_f32 v155, v54, v55
    v_mfma_f32_32x32x16_bf16 v[80:95], a[92:95], a[144:147], v[80:95]
    ds_read_b64_tr_b16 a[84:85], v241 offset:12288
    ds_read_b64_tr_b16 a[86:87], v241 offset:13312
    v_mfma_f32_32x32x16_bf16 v[64:79], a[64:67], a[148:151], v[64:79]
    ds_read_b64_tr_b16 a[88:89], v240 offset:14336
    ds_read_b64_tr_b16 a[90:91], v240 offset:15360
    s_waitcnt lgkmcnt(6)
    v_mfma_f32_32x32x16_bf16 v[80:95], a[68:71], a[148:151], v[80:95]
    ds_read_b64_tr_b16 a[92:93], v241 offset:14336
    ds_read_b64_tr_b16 a[94:95], v241 offset:15360
    s_add_u32 s37, s37, 98304
    buffer_store_dwordx4 v[152:155], v250, s[16:19], s37 offen offset:0 sc1
    v_mfma_f32_32x32x16_bf16 v[64:79], a[72:75], a[16:19], v[64:79]
    ds_read_b64_tr_b16 a[64:65], v240 offset:16384
    ds_read_b64_tr_b16 a[66:67], v240 offset:17408
    v_cvt_pk_bf16_f32 v156, v56, v57
    v_mfma_f32_32x32x16_bf16 v[80:95], a[76:79], a[16:19], v[80:95]
    ds_read_b64_tr_b16 a[68:69], v241 offset:16384
    ds_read_b64_tr_b16 a[70:71], v241 offset:17408
    s_waitcnt vmcnt(17) lgkmcnt(6)
    v_mfma_f32_32x32x16_bf16 v[64:79], a[80:83], a[20:23], v[64:79]
    s_barrier
    ds_read_b64_tr_b16 a[72:73], v240 offset:18432
    ds_read_b64_tr_b16 a[74:75], v240 offset:19456
    v_mfma_f32_32x32x16_bf16 v[80:95], a[84:87], a[20:23], v[80:95]
    ds_read_b64_tr_b16 a[76:77], v241 offset:18432
    ds_read_b64_tr_b16 a[78:79], v241 offset:19456
    v_cvt_pk_bf16_f32 v157, v58, v59
    v_mfma_f32_32x32x16_bf16 v[64:79], a[88:91], a[24:27], v[64:79]
    ds_read_b64_tr_b16 a[80:81], v240 offset:20480
    ds_read_b64_tr_b16 a[82:83], v240 offset:21504
    s_waitcnt lgkmcnt(6)
    v_mfma_f32_32x32x16_bf16 v[80:95], a[92:95], a[24:27], v[80:95]
    ds_read_b64_tr_b16 a[84:85], v241 offset:20480
    ds_read_b64_tr_b16 a[86:87], v241 offset:21504
    v_cvt_pk_bf16_f32 v158, v60, v61
    v_mfma_f32_32x32x16_bf16 v[64:79], a[64:67], a[28:31], v[64:79]
    ds_read_b64_tr_b16 a[88:89], v240 offset:22528
    ds_read_b64_tr_b16 a[90:91], v240 offset:23552
    v_cvt_pk_bf16_f32 v159, v62, v63
    v_mfma_f32_32x32x16_bf16 v[80:95], a[68:71], a[28:31], v[80:95]
    ds_read_b64_tr_b16 a[92:93], v241 offset:22528
    ds_read_b64_tr_b16 a[94:95], v241 offset:23552
    s_waitcnt lgkmcnt(6)
    v_mfma_f32_32x32x16_bf16 v[96:111], a[72:75], a[96:99], v[96:111]
    ds_read_b64_tr_b16 a[64:65], v240 offset:24576
    ds_read_b64_tr_b16 a[66:67], v240 offset:25600
    buffer_store_dwordx4 v[156:159], v250, s[16:19], s37 offen offset:1024 sc1
    v_mfma_f32_32x32x16_bf16 v[128:143], a[76:79], a[96:99], v[128:143]
    ds_read_b64_tr_b16 a[68:69], v241 offset:24576
    ds_read_b64_tr_b16 a[70:71], v241 offset:25600
    v_mfma_f32_32x32x16_bf16 v[96:111], a[80:83], a[100:103], v[96:111]
    ds_read_b64_tr_b16 a[72:73], v240 offset:26624
    ds_read_b64_tr_b16 a[74:75], v240 offset:27648
    s_waitcnt lgkmcnt(6)
    v_mfma_f32_32x32x16_bf16 v[128:143], a[84:87], a[100:103], v[128:143]
    ds_read_b64_tr_b16 a[76:77], v241 offset:26624
    ds_read_b64_tr_b16 a[78:79], v241 offset:27648
    v_cvt_pk_bf16_f32 v144, v64, v65
    v_cvt_pk_bf16_f32 v145, v66, v67
    v_mfma_f32_32x32x16_bf16 v[96:111], a[88:91], a[104:107], v[96:111]
    ds_read_b64_tr_b16 a[80:81], v240 offset:28672
    ds_read_b64_tr_b16 a[82:83], v240 offset:29696
    v_cvt_pk_bf16_f32 v146, v68, v69
    v_cvt_pk_bf16_f32 v147, v70, v71
    v_mfma_f32_32x32x16_bf16 v[128:143], a[92:95], a[104:107], v[128:143]
    ds_read_b64_tr_b16 a[84:85], v241 offset:28672
    ds_read_b64_tr_b16 a[86:87], v241 offset:29696
    s_waitcnt lgkmcnt(6)
    v_mfma_f32_32x32x16_bf16 v[96:111], a[64:67], a[108:111], v[96:111]
    ds_read_b64_tr_b16 a[88:89], v240 offset:30720
    ds_read_b64_tr_b16 a[90:91], v240 offset:31744
    s_add_u32 s37, s37, 98304
    buffer_store_dwordx4 v[144:147], v250, s[16:19], s37 offen offset:0 sc1
    v_mfma_f32_32x32x16_bf16 v[128:143], a[68:71], a[108:111], v[128:143]
    ds_read_b64_tr_b16 a[92:93], v241 offset:30720
    ds_read_b64_tr_b16 a[94:95], v241 offset:31744
    v_cvt_pk_bf16_f32 v148, v72, v73
    v_cvt_pk_bf16_f32 v149, v74, v75
    v_mfma_f32_32x32x16_bf16 v[96:111], a[72:75], a[112:115], v[96:111]
    ds_read_b64_tr_b16 a[64:65], v240 offset:32768
    ds_read_b64_tr_b16 a[66:67], v240 offset:33792
    v_cvt_pk_bf16_f32 v150, v76, v77
    s_waitcnt lgkmcnt(6)
    v_mfma_f32_32x32x16_bf16 v[128:143], a[76:79], a[112:115], v[128:143]
    ds_read_b64_tr_b16 a[68:69], v241 offset:32768
    ds_read_b64_tr_b16 a[70:71], v241 offset:33792
    v_cvt_pk_bf16_f32 v151, v78, v79
    v_mfma_f32_32x32x16_bf16 v[96:111], a[80:83], a[116:119], v[96:111]
    ds_read_b64_tr_b16 a[72:73], v240 offset:34816
    ds_read_b64_tr_b16 a[74:75], v240 offset:35840
    buffer_store_dwordx4 v[148:151], v250, s[16:19], s37 offen offset:1024 sc1
    v_cvt_pk_bf16_f32 v152, v80, v81
    v_mfma_f32_32x32x16_bf16 v[128:143], a[84:87], a[116:119], v[128:143]
    ds_read_b64_tr_b16 a[76:77], v241 offset:34816
    ds_read_b64_tr_b16 a[78:79], v241 offset:35840
    v_cvt_pk_bf16_f32 v153, v82, v83
    s_waitcnt vmcnt(14) lgkmcnt(6)
    v_mfma_f32_32x32x16_bf16 v[96:111], a[88:91], a[120:123], v[96:111]
    s_barrier
    ds_read_b64_tr_b16 a[80:81], v240 offset:36864
    ds_read_b64_tr_b16 a[82:83], v240 offset:37888
    v_cvt_pk_bf16_f32 v154, v84, v85
    v_mfma_f32_32x32x16_bf16 v[128:143], a[92:95], a[120:123], v[128:143]
    ds_read_b64_tr_b16 a[84:85], v241 offset:36864
    ds_read_b64_tr_b16 a[86:87], v241 offset:37888
    v_cvt_pk_bf16_f32 v155, v86, v87
    v_mfma_f32_32x32x16_bf16 v[96:111], a[64:67], a[124:127], v[96:111]
    ds_read_b64_tr_b16 a[88:89], v240 offset:38912
    ds_read_b64_tr_b16 a[90:91], v240 offset:39936
    s_add_u32 s37, s37, 98304
    buffer_store_dwordx4 v[152:155], v250, s[16:19], s37 offen offset:0 sc1
    s_waitcnt lgkmcnt(6)
    v_mfma_f32_32x32x16_bf16 v[128:143], a[68:71], a[124:127], v[128:143]
    ds_read_b64_tr_b16 a[92:93], v241 offset:38912
    ds_read_b64_tr_b16 a[94:95], v241 offset:39936
    v_cvt_pk_bf16_f32 v156, v88, v89
    v_mfma_f32_32x32x16_bf16 v[96:111], a[72:75], a[128:131], v[96:111]
    ds_read_b64_tr_b16 a[64:65], v240 offset:40960
    ds_read_b64_tr_b16 a[66:67], v240 offset:41984
    v_cvt_pk_bf16_f32 v157, v90, v91
    v_cvt_pk_bf16_f32 v158, v92, v93
    v_mfma_f32_32x32x16_bf16 v[128:143], a[76:79], a[128:131], v[128:143]
    ds_read_b64_tr_b16 a[68:69], v241 offset:40960
    ds_read_b64_tr_b16 a[70:71], v241 offset:41984
    s_waitcnt lgkmcnt(6)
    v_mfma_f32_32x32x16_bf16 v[96:111], a[80:83], a[132:135], v[96:111]
    ds_read_b64_tr_b16 a[72:73], v240 offset:43008
    ds_read_b64_tr_b16 a[74:75], v240 offset:44032
    v_cvt_pk_bf16_f32 v159, v94, v95
    buffer_store_dwordx4 v[156:159], v250, s[16:19], s37 offen offset:1024 sc1
    v_mfma_f32_32x32x16_bf16 v[128:143], a[84:87], a[132:135], v[128:143]
    ds_read_b64_tr_b16 a[76:77], v241 offset:43008
    ds_read_b64_tr_b16 a[78:79], v241 offset:44032
    v_mfma_f32_32x32x16_bf16 v[96:111], a[88:91], a[136:139], v[96:111]
    ds_read_b64_tr_b16 a[80:81], v240 offset:45056
    ds_read_b64_tr_b16 a[82:83], v240 offset:46080
    s_waitcnt lgkmcnt(6)
    v_mfma_f32_32x32x16_bf16 v[128:143], a[92:95], a[136:139], v[128:143]
    ds_read_b64_tr_b16 a[84:85], v241 offset:45056
    ds_read_b64_tr_b16 a[86:87], v241 offset:46080
    v_mfma_f32_32x32x16_bf16 v[96:111], a[64:67], a[140:143], v[96:111]
    ds_read_b64_tr_b16 a[88:89], v240 offset:47104
    ds_read_b64_tr_b16 a[90:91], v240 offset:48128
    v_mfma_f32_32x32x16_bf16 v[128:143], a[68:71], a[140:143], v[128:143]
    ds_read_b64_tr_b16 a[92:93], v241 offset:47104
    ds_read_b64_tr_b16 a[94:95], v241 offset:48128
    s_waitcnt lgkmcnt(6)
    v_mfma_f32_32x32x16_bf16 v[96:111], a[72:75], a[144:147], v[96:111]
    ds_read_b64_tr_b16 a[64:65], v240 offset:49152
    ds_read_b64_tr_b16 a[66:67], v240 offset:50176
    v_mfma_f32_32x32x16_bf16 v[128:143], a[76:79], a[144:147], v[128:143]
    ds_read_b64_tr_b16 a[68:69], v241 offset:49152
    ds_read_b64_tr_b16 a[70:71], v241 offset:50176
    v_mfma_f32_32x32x16_bf16 v[96:111], a[80:83], a[148:151], v[96:111]
    ds_read_b64_tr_b16 a[72:73], v240 offset:51200
    ds_read_b64_tr_b16 a[74:75], v240 offset:52224
    s_waitcnt lgkmcnt(6)
    v_mfma_f32_32x32x16_bf16 v[128:143], a[84:87], a[148:151], v[128:143]
    ds_read_b64_tr_b16 a[76:77], v241 offset:51200
    ds_read_b64_tr_b16 a[78:79], v241 offset:52224
    v_mfma_f32_32x32x16_bf16 v[96:111], a[88:91], a[16:19], v[96:111]
    ds_read_b64_tr_b16 a[80:81], v240 offset:53248
    ds_read_b64_tr_b16 a[82:83], v240 offset:54272
    v_mfma_f32_32x32x16_bf16 v[128:143], a[92:95], a[16:19], v[128:143]
    ds_read_b64_tr_b16 a[84:85], v241 offset:53248
    ds_read_b64_tr_b16 a[86:87], v241 offset:54272
    s_waitcnt vmcnt(12) lgkmcnt(6)
    v_mfma_f32_32x32x16_bf16 v[96:111], a[64:67], a[20:23], v[96:111]
    s_barrier
    ds_read_b64_tr_b16 a[88:89], v242 offset:55296
    ds_read_b64_tr_b16 a[90:91], v242 offset:55808
    v_mfma_f32_32x32x16_bf16 v[128:143], a[68:71], a[20:23], v[128:143]
    ds_read_b64_tr_b16 a[92:93], v242 offset:56320
    ds_read_b64_tr_b16 a[94:95], v242 offset:56832
    v_mfma_f32_32x32x16_bf16 v[96:111], a[72:75], a[24:27], v[96:111]
    ds_read_b64_tr_b16 a[64:65], v242 offset:57344
    ds_read_b64_tr_b16 a[66:67], v242 offset:57856
    s_waitcnt lgkmcnt(6)
    v_mfma_f32_32x32x16_bf16 v[128:143], a[76:79], a[24:27], v[128:143]
    ds_read_b64_tr_b16 a[68:69], v242 offset:58368
    ds_read_b64_tr_b16 a[70:71], v242 offset:58880
    v_mfma_f32_32x32x16_bf16 v[96:111], a[80:83], a[28:31], v[96:111]
    ds_read_b64_tr_b16 a[72:73], v242 offset:59392
    ds_read_b64_tr_b16 a[74:75], v242 offset:59904
    v_mfma_f32_32x32x16_bf16 v[128:143], a[84:87], a[28:31], v[128:143]
    ds_read_b64_tr_b16 a[76:77], v242 offset:60416
    ds_read_b64_tr_b16 a[78:79], v242 offset:60928
    s_waitcnt lgkmcnt(6)
    v_mfma_f32_32x32x16_bf16 a[0:15], a[88:91], a[96:99], a[0:15]
    ds_read_b64_tr_b16 a[80:81], v242 offset:61440
    ds_read_b64_tr_b16 a[82:83], v242 offset:61952
    v_mfma_f32_32x32x16_bf16 a[0:15], a[92:95], a[100:103], a[0:15]
    ds_read_b64_tr_b16 a[84:85], v242 offset:62464
    ds_read_b64_tr_b16 a[86:87], v242 offset:62976
    v_mfma_f32_32x32x16_bf16 a[0:15], a[64:67], a[104:107], a[0:15]
    ds_read_b64_tr_b16 a[88:89], v242 offset:63488
    ds_read_b64_tr_b16 a[90:91], v242 offset:64000
    s_waitcnt lgkmcnt(6)
    v_mfma_f32_32x32x16_bf16 a[0:15], a[68:71], a[108:111], a[0:15]
    ds_read_b64_tr_b16 a[92:93], v242 offset:64512
    ds_read_b64_tr_b16 a[94:95], v242 offset:65024
    v_cvt_pk_bf16_f32 v144, v96, v97
    v_cvt_pk_bf16_f32 v145, v98, v99
    v_mfma_f32_32x32x16_bf16 a[0:15], a[72:75], a[112:115], a[0:15]
    v_add_u32 v242, 55296, v242
    ds_read_b64_tr_b16 a[64:65], v242 offset:10240
    ds_read_b64_tr_b16 a[66:67], v242 offset:10752
    v_cvt_pk_bf16_f32 v146, v100, v101
    v_cvt_pk_bf16_f32 v147, v102, v103
    v_mfma_f32_32x32x16_bf16 a[0:15], a[76:79], a[116:119], a[0:15]
    ds_read_b64_tr_b16 a[68:69], v242 offset:11264
    ds_read_b64_tr_b16 a[70:71], v242 offset:11776
    s_waitcnt lgkmcnt(6)
    v_mfma_f32_32x32x16_bf16 a[0:15], a[80:83], a[120:123], a[0:15]
    ds_read_b64_tr_b16 a[72:73], v242 offset:12288
    ds_read_b64_tr_b16 a[74:75], v242 offset:12800
    s_add_u32 s37, s37, 98304
    buffer_store_dwordx4 v[144:147], v250, s[16:19], s37 offen offset:0 sc1
    v_mfma_f32_32x32x16_bf16 a[0:15], a[84:87], a[124:127], a[0:15]
    ds_read_b64_tr_b16 a[76:77], v242 offset:13312
    ds_read_b64_tr_b16 a[78:79], v242 offset:13824
    v_cvt_pk_bf16_f32 v148, v104, v105
    v_cvt_pk_bf16_f32 v149, v106, v107
    v_mfma_f32_32x32x16_bf16 a[0:15], a[88:91], a[128:131], a[0:15]
    ds_read_b64_tr_b16 a[80:81], v242 offset:14336
    ds_read_b64_tr_b16 a[82:83], v242 offset:14848
    v_cvt_pk_bf16_f32 v150, v108, v109
    s_waitcnt lgkmcnt(6)
    v_mfma_f32_32x32x16_bf16 a[0:15], a[92:95], a[132:135], a[0:15]
    ds_read_b64_tr_b16 a[84:85], v242 offset:15360
    ds_read_b64_tr_b16 a[86:87], v242 offset:15872
    v_cvt_pk_bf16_f32 v151, v110, v111
    buffer_store_dwordx4 v[148:151], v250, s[16:19], s37 offen offset:1024 sc1
    v_mfma_f32_32x32x16_bf16 a[0:15], a[64:67], a[136:139], a[0:15]
    ds_read_b64_tr_b16 a[88:89], v242 offset:16384
    ds_read_b64_tr_b16 a[90:91], v242 offset:16896
    v_cvt_pk_bf16_f32 v152, v128, v129
    v_cvt_pk_bf16_f32 v153, v130, v131
    s_waitcnt vmcnt(2)
    v_mov_b32 v254, 2
    s_mov_b64 exec, 1
    buffer_store_dword v254, v251, s[16:19], s85 offen sc1
    s_mov_b64 exec, -1
    v_mfma_f32_32x32x16_bf16 a[0:15], a[68:71], a[140:143], a[0:15]
    ds_read_b64_tr_b16 a[92:93], v242 offset:17408
    ds_read_b64_tr_b16 a[94:95], v242 offset:17920
    v_cvt_pk_bf16_f32 v154, v132, v133
    s_waitcnt lgkmcnt(6)
    v_mfma_f32_32x32x16_bf16 a[0:15], a[72:75], a[144:147], a[0:15]
    v_cvt_pk_bf16_f32 v155, v134, v135
    v_mfma_f32_32x32x16_bf16 a[0:15], a[76:79], a[148:151], a[0:15]
    s_add_u32 s37, s37, 98304
    buffer_store_dwordx4 v[152:155], v250, s[16:19], s37 offen offset:0 sc1
    v_mfma_f32_32x32x16_bf16 a[0:15], a[80:83], a[16:19], a[0:15]
    v_cvt_pk_bf16_f32 v156, v136, v137
    s_waitcnt lgkmcnt(0)
    v_mfma_f32_32x32x16_bf16 a[0:15], a[84:87], a[20:23], a[0:15]
    v_cvt_pk_bf16_f32 v157, v138, v139
    v_cvt_pk_bf16_f32 v158, v140, v141
    v_mfma_f32_32x32x16_bf16 a[0:15], a[88:91], a[24:27], a[0:15]
    v_cvt_pk_bf16_f32 v159, v142, v143
    buffer_store_dwordx4 v[156:159], v250, s[16:19], s37 offen offset:1024 sc1
    v_mfma_f32_32x32x16_bf16 a[0:15], a[92:95], a[28:31], a[0:15]
    s_nop 11
    v_accvgpr_read_b32 v0, a0
    v_accvgpr_read_b32 v1, a1
    v_accvgpr_read_b32 v2, a2
    v_accvgpr_read_b32 v3, a3
    v_accvgpr_read_b32 v4, a4
    v_accvgpr_read_b32 v5, a5
    v_accvgpr_read_b32 v6, a6
    v_accvgpr_read_b32 v7, a7
    v_accvgpr_read_b32 v8, a8
    v_accvgpr_read_b32 v9, a9
    v_accvgpr_read_b32 v10, a10
    v_accvgpr_read_b32 v11, a11
    v_accvgpr_read_b32 v12, a12
    v_accvgpr_read_b32 v13, a13
    v_accvgpr_read_b32 v14, a14
    v_accvgpr_read_b32 v15, a15
    v_cvt_pk_bf16_f32 v144, v0, v1
    v_cvt_pk_bf16_f32 v145, v2, v3
    v_cvt_pk_bf16_f32 v146, v4, v5
    v_cvt_pk_bf16_f32 v147, v6, v7
    buffer_store_dwordx4 v[144:147], v243, s[16:19], s71 offen offset:0 sc1
    v_cvt_pk_bf16_f32 v148, v8, v9
    v_cvt_pk_bf16_f32 v149, v10, v11
    v_cvt_pk_bf16_f32 v150, v12, v13
    v_cvt_pk_bf16_f32 v151, v14, v15
    buffer_store_dwordx4 v[148:151], v243, s[16:19], s71 offen offset:256 sc1
    s_load_dwordx2 s[76:77], s[0:1], 96
    s_lshl_b32 s40, s70, 3
    s_add_u32 s40, s40, s22
    s_lshl_b32 s42, s20, 11
    s_lshl_b32 s43, s20, 10
    s_add_u32 s43, s43, 8192
    s_mul_i32 s41, s40, 98304
    s_add_u32 s80, s41, s42
    s_add_u32 s87, s41, s43
    s_lshl_b32 s41, s40, 14
    s_add_u32 s41, s41, 50331648
    s_add_u32 s81, s41, s42
    s_add_u32 s88, s41, s43
    s_barrier
    s_cmp_ge_u32 s22, 6
    s_cbranch_scc1 L_noconv
    s_mov_b32 s89, 0
    v_and_b32 v102, 1, v253
    v_bfe_u32 v103, v253, 1, 1
    v_lshl_add_u32 v102, v102, 1, v103
    v_and_b32 v103, 4, v253
    s_and_b32 s40, s20, 2
    s_lshl_b32 s40, s40, 1
    v_add_u32 v102, v102, v103
    v_xor_b32 v102, s40, v102
    s_lshl_b32 s40, s49, 14
    v_lshl_add_u32 v102, v102, 4, s40
    v_lshl_add_u32 v60, v253, 8, v102
    v_xor_b32 v61, 16, v60
    v_xor_b32 v62, 32, v60
    v_xor_b32 v63, 48, v60
    ds_write_b128 v60, a[152:155] offset:0
    s_add_u32 m0, s47, 126720
    s_add_u32 s48, s46, 0
    buffer_load_dwordx4 v250, s[16:19], s48 offen lds
    v_and_b32 v100, 15, v253
    v_lshrrev_b32 v101, 4, v253
    v_bfe_u32 v64, v253, 1, 1
    v_bfe_u32 v65, v253, 3, 2
    v_lshlrev_b32 v65, 1, v65
    v_xor_b32 v64, v64, v65
    v_lshlrev_b32 v64, 4, v64
    ds_write_b128 v60, a[156:159] offset:128
    v_and_b32 v65, 1, v253
    v_lshl_add_u32 v64, v65, 3, v64
    v_bfe_u32 v65, v253, 2, 2
    v_lshl_add_u32 v64, v65, 7, v64
    v_lshl_add_u32 v64, v101, 10, v64
    s_lshl_b32 s49, s20, 15
    v_add_u32 v64, s49, v64
    ds_write_b128 v61, a[160:163] offset:0
    s_add_u32 m0, s47, 131360
    s_add_u32 s48, s46, 4
    buffer_load_dwordx4 v250, s[16:19], s48 offen lds
    v_xor_b32 v65, 16, v64
    v_xor_b32 v66, 32, v64
    v_xor_b32 v67, 48, v64
    v_xor_b32 v68, 64, v64
    v_xor_b32 v69, 80, v64
    v_xor_b32 v70, 96, v64
    v_xor_b32 v71, 112, v64
    ds_write_b128 v61, a[164:167] offset:128
    s_add_u32 m0, s47, 136000
    s_add_u32 s48, s46, 8
    buffer_load_dwordx4 v250, s[16:19], s48 offen lds
    v_lshlrev_b32 v103, 5, v100
    v_sub_u32 v103, s49, v103
    v_lshlrev_b32 v104, 3, v101
    v_sub_u32 v104, v103, v104
    v_add_u32 v104, 4088, v104
    v_lshlrev_b32 v105, 4, v101
    v_sub_u32 v105, v103, v105
    ds_write_b128 v62, a[168:171] offset:0
    v_add_u32 v105, 3568, v105
    v_lshlrev_b32 v107, 9, v101
    v_sub_u32 v107, v103, v107
    v_add_u32 v107, 2016, v107
    v_add_u32 v108, 47, v253
    v_subrev_u32 v106, 16, v253
    v_cmp_gt_u32 s[44:45], 16, v253
    ds_write_b128 v62, a[172:175] offset:128
    s_add_u32 m0, s47, 140640
    s_add_u32 s48, s46, 12
    buffer_load_dwordx4 v250, s[16:19], s48 offen lds
    s_nop 1
    v_cndmask_b32 v108, v106, v108, s[44:45]
    v_lshlrev_b32 v108, 2, v108
    s_mul_i32 s40, s21, 147456
    s_mul_i32 s41, s20, 36864
    s_add_u32 s40, s41, s40
    s_mul_i32 s42, s23, 640
    ds_write_b128 v63, a[176:179] offset:0
    s_add_u32 m0, s73, 130816
    s_add_u32 s48, s72, 4096
    s_mov_b64 exec, 0x1ffffff
    buffer_load_dwordx4 v250, s[16:19], s48 offen lds
    s_mov_b64 exec, -1
    s_add_u32 s41, s40, s42
    s_lshl_b32 s42, s22, 6
    s_add_u32 s82, s41, s42
    s_add_u32 s83, s82, 32
    s_lshl_b32 s41, s23, 6
    s_add_u32 s40, s40, s41
    s_mul_i32 s41, s22, 18432
    ds_write_b128 v63, a[180:183] offset:128
    s_add_u32 s40, s40, s41
    s_add_u32 s84, s40, 4294857216
    v_and_b32 v236, 31, v253
    v_lshrrev_b32 v200, 5, v253
    v_mul_u32_u24 v236, 1152, v236
    v_lshl_add_u32 v236, v200, 4, v236
    s_mul_i32 s40, s20, 3072
    ds_write_b128 v60, a[184:187] offset:32768
    s_add_u32 m0, s47, 145280
    s_add_u32 s48, s46, 8192
    buffer_load_dwordx4 v250, s[16:19], s48 offen lds
    s_add_u32 s40, s40, 16384
    v_add_u32 v238, s40, v250
    v_and_b32 v237, 3, v253
    v_lshlrev_b32 v237, 3, v237
    v_lshl_add_u32 v237, v200, 9, v237
    v_bfe_u32 v200, v253, 4, 1
    v_lshl_add_u32 v237, v200, 5, v237
    ds_write_b128 v60, a[188:191] offset:32896
    s_add_u32 m0, s47, 149920
    s_add_u32 s48, s46, 8196
    buffer_load_dwordx4 v250, s[16:19], s48 offen lds
    v_bfe_u32 v200, v253, 2, 2
    v_lshl_add_u32 v237, v200, 6, v237
    v_add_u32 v237, s40, v237
    v_and_b32 v240, 15, v253
    v_mul_u32_u24 v240, 1152, v240
    v_bfe_u32 v200, v253, 4, 1
    v_lshl_add_u32 v240, v200, 5, v240
    ds_write_b128 v61, a[192:195] offset:32768
    v_lshrrev_b32 v200, 5, v253
    v_lshl_add_u32 v240, v200, 4, v240
    v_accvgpr_read_b32 v212, a44
    v_accvgpr_read_b32 v213, a45
    v_accvgpr_read_b32 v214, a46
    v_accvgpr_read_b32 v215, a47
    v_accvgpr_read_b32 v216, a48
    ds_write_b128 v61, a[196:199] offset:32896
    s_add_u32 m0, s47, 154560
    s_add_u32 s48, s46, 8200
    buffer_load_dwordx4 v250, s[16:19], s48 offen lds
    v_accvgpr_read_b32 v217, a49
    v_accvgpr_read_b32 v218, a50
    v_accvgpr_read_b32 v219, a51
    v_and_b32 v102, 1, v100
    v_xor_b32 v102, 1, v102
    v_mul_u32_u24 v90, 4224, v102
    v_lshrrev_b32 v102, 1, v100
    ds_write_b128 v62, a[200:203] offset:32768
    s_waitcnt vmcnt(8)
    v_mov_b32 v254, 3
    s_mov_b64 exec, 1
    buffer_store_dword v254, v251, s[16:19], s85 offen sc1
    s_mov_b64 exec, -1
    v_sub_u32 v102, v101, v102
    v_lshl_add_u32 v90, v102, 4, v90
    v_add_u32 v90, 112, v90
    v_and_b32 v102, 3, v100
    v_lshrrev_b32 v103, 2, v100
    v_mul_u32_u24 v91, 4640, v102
    v_lshl_add_u32 v91, v103, 7, v91
    ds_write_b128 v62, a[204:207] offset:32896
    s_add_u32 m0, s47, 159200
    s_add_u32 s48, s46, 8204
    buffer_load_dwordx4 v250, s[16:19], s48 offen lds
    v_lshl_add_u32 v91, v101, 4, v91
    v_lshlrev_b32 v94, 2, v102
    v_lshl_add_u32 v94, v103, 7, v94
    v_lshl_add_u32 v94, v101, 5, v94
    v_add_u32 v94, 396, v94
    s_lshl_b32 s40, s20, 12
    s_add_u32 s40, s40, 48756
    s_waitcnt lgkmcnt(8)
    ds_write_b128 v63, a[208:211] offset:32768
    s_add_u32 m0, s73, 149376
    s_add_u32 s48, s72, 12288
    s_mov_b64 exec, 0x1ffffff
    buffer_load_dwordx4 v250, s[16:19], s48 offen lds
    s_mov_b64 exec, -1
    v_add_u32 v109, s40, v94
    s_add_u32 s40, s40, 396
    v_add_u32 v110, s40, v250
    v_lshlrev_b32 v98, 18, v101
    v_lshl_add_u32 v98, v102, 4, v98
    v_mov_b32 v99, v103
    v_lshrrev_b32 v111, 5, v253
    ds_write_b128 v63, a[212:215] offset:32896
    v_mul_u32_u24 v111, 4096, v111
    v_lshl_add_u32 v111, v253, 2, v111
    v_add_u32 v111, s49, v111
    v_accvgpr_read_b32 v95, a248
    v_accvgpr_read_b32 v96, a249
    v_accvgpr_read_b32 v97, a250
    s_cmp_eq_u32 s20, 1
    s_cselect_b32 s95, 18560, 0
    s_cselect_b64 s[44:45], -1, 0
    v_add_u32 v60, 0x10000, v60
    v_add_u32 v61, 0x10000, v61
    v_add_u32 v62, 0x10000, v62
    v_add_u32 v63, 0x10000, v63
    ds_write_b128 v60, a[216:219] offset:0
    s_add_u32 m0, s47, 108160
    s_add_u32 s48, s46, 16384
    buffer_load_dwordx4 v250, s[16:19], s48 offen lds
    s_add_u32 s95, s95, 126720
    v_cndmask_b32 v92, v95, v96, s[44:45]
    s_cmp_eq_u32 s20, 2
    s_cselect_b32 s95, 108160, s95
    s_cselect_b64 s[44:45], -1, 0
    v_add_u32 v90, s49, v90
    v_cndmask_b32 v92, v92, v97, s[44:45]
    ds_write_b128 v60, a[220:223] offset:128
    s_add_u32 m0, s47, 112800
    s_add_u32 s48, s46, 16388
    buffer_load_dwordx4 v250, s[16:19], s48 offen lds
    v_add_u32 v91, s95, v91
    v_add_u32 v94, s95, v94
    v_lshlrev_b32 v92, 16, v92
    s_add_u32 s43, s101, s20
    s_cmp_ge_u32 s43, 288
    s_cselect_b32 s41, 1, 0
    s_mul_i32 s40, s41, 320
    ds_write_b128 v61, a[224:227] offset:0
    s_sub_u32 s40, s43, s40
    s_ashr_i32 s40, s40, 4
    s_cmp_lt_i32 s40, 0
    s_cselect_b32 s42, 18, 0
    s_add_i32 s40, s40, s42
    s_lshl_b32 s41, s41, 17
    s_lshr_b32 s42, s40, 1
    ds_write_b128 v61, a[228:231] offset:128
    s_add_u32 m0, s47, 117440
    s_add_u32 s48, s46, 16392
    buffer_load_dwordx4 v250, s[16:19], s48 offen lds
    s_lshl_b32 s42, s42, 14
    s_and_b32 s92, s40, 1
    s_lshl_b32 s92, s92, 10
    s_add_u32 s42, s42, s92
    s_lshl_b32 s92, s40, 14
    s_sub_u32 s92, s92, 155648
    s_mov_b32 s95, 1024
    s_waitcnt lgkmcnt(8)
    ds_write_b128 v62, a[232:235] offset:0
    s_cmp_lt_u32 s40, 16
    s_cselect_b32 s95, 2048, s95
    s_cselect_b32 s92, s42, s92
    v_mad_u32_u24 v93, v99, s95, v98
    s_add_u32 s92, s92, s41
    s_and_b32 s42, s43, 15
    s_lshl_b32 s42, s42, 6
    ds_write_b128 v62, a[236:239] offset:128
    s_add_u32 m0, s47, 122080
    s_add_u32 s48, s46, 16396
    buffer_load_dwordx4 v250, s[16:19], s48 offen lds
    s_add_u32 s92, s92, s42
    s_add_u32 s92, s92, 50331648
    v_mov_b32 v103, 0
    ds_write_b128 v63, a[240:243] offset:0
    s_add_u32 m0, s73, 112256
    s_add_u32 s48, s72, 20480
    s_mov_b64 exec, 0x1ffffff
    buffer_load_dwordx4 v250, s[16:19], s48 offen lds
    s_mov_b64 exec, -1
    ds_write_b128 v63, a[244:247] offset:128
    s_waitcnt lgkmcnt(0)
    s_barrier
    buffer_load_dword v255, v239, s[16:19], s86 offen sc1
    s_cmp_eq_u32 s20, 3
    s_cbranch_scc1 L_cv3
    ds_read_b64_tr_b16 a[0:1], v64 offset:0
    ds_read_b64_tr_b16 a[2:3], v65 offset:512
    ds_read_b64_tr_b16 a[4:5], v66 offset:0
    ds_read_b64_tr_b16 a[6:7], v67 offset:512
    ds_read_b64_tr_b16 a[8:9], v68 offset:0
    ds_read_b64_tr_b16 a[10:11], v69 offset:512
    ds_read_b64_tr_b16 a[12:13], v70 offset:0
    ds_read_b64_tr_b16 a[14:15], v71 offset:512
    ds_read_b64_tr_b16 a[16:17], v64 offset:4096
    ds_read_b64_tr_b16 a[18:19], v65 offset:4608
    ds_read_b64_tr_b16 a[20:21], v66 offset:4096
    ds_read_b64_tr_b16 a[22:23], v67 offset:4608
    ds_read_b64_tr_b16 a[24:25], v68 offset:4096
    ds_read_b64_tr_b16 a[26:27], v69 offset:4608
    ds_read_b64_tr_b16 a[28:29], v70 offset:4096
    s_waitcnt lgkmcnt(11)
    v_mfma_f32_16x16x32_bf16 v[0:3], a[4:7], a[0:3], 0
    ds_read_b64_tr_b16 a[30:31], v71 offset:4608
    ds_read_b64_tr_b16 a[32:33], v64 offset:8192
    ds_read_b64_tr_b16 a[34:35], v65 offset:8704
    ds_read_b64_tr_b16 a[36:37], v66 offset:8192
    s_waitcnt lgkmcnt(13)
    v_mfma_f32_16x16x32_bf16 v[4:7], a[8:11], a[0:3], 0
    ds_read_b64_tr_b16 a[38:39], v67 offset:8704
    ds_read_b64_tr_b16 a[40:41], v68 offset:8192
    s_waitcnt lgkmcnt(13)
    v_mfma_f32_16x16x32_bf16 v[8:11], a[12:15], a[0:3], 0
    ds_read_b64_tr_b16 a[42:43], v69 offset:8704
    ds_read_b64_tr_b16 a[44:45], v70 offset:8192
    s_waitcnt lgkmcnt(11)
    v_mfma_f32_16x16x32_bf16 v[0:3], a[20:23], a[16:19], v[0:3]
    ds_read_b64_tr_b16 a[46:47], v71 offset:8704
    ds_read_b64_tr_b16 a[48:49], v64 offset:12288
    ds_read_b64_tr_b16 a[50:51], v65 offset:12800
    ds_read_b64_tr_b16 a[52:53], v66 offset:12288
    s_waitcnt lgkmcnt(13)
    v_mfma_f32_16x16x32_bf16 v[4:7], a[24:27], a[16:19], v[4:7]
    ds_read_b64_tr_b16 a[54:55], v67 offset:12800
    ds_read_b64_tr_b16 a[56:57], v68 offset:12288
    s_waitcnt lgkmcnt(13)
    v_mfma_f32_16x16x32_bf16 v[8:11], a[28:31], a[16:19], v[8:11]
    ds_read_b64_tr_b16 a[58:59], v69 offset:12800
    ds_read_b64_tr_b16 a[60:61], v70 offset:12288
    s_waitcnt lgkmcnt(11)
    v_mfma_f32_16x16x32_bf16 v[0:3], a[36:39], a[32:35], v[0:3]
    ds_read_b64_tr_b16 a[62:63], v71 offset:12800
    ds_read_b64_tr_b16 a[64:65], v64 offset:16384
    ds_read_b64_tr_b16 a[66:67], v65 offset:16896
    ds_read_b64_tr_b16 a[68:69], v66 offset:16384
    s_waitcnt lgkmcnt(13)
    v_mfma_f32_16x16x32_bf16 v[4:7], a[40:43], a[32:35], v[4:7]
    ds_read_b64_tr_b16 a[70:71], v67 offset:16896
    ds_read_b64_tr_b16 a[72:73], v68 offset:16384
    s_waitcnt lgkmcnt(13)
    v_mfma_f32_16x16x32_bf16 v[8:11], a[44:47], a[32:35], v[8:11]
    ds_read_b64_tr_b16 a[74:75], v69 offset:16896
    ds_read_b64_tr_b16 a[76:77], v70 offset:16384
    s_waitcnt lgkmcnt(11)
    v_mfma_f32_16x16x32_bf16 v[0:3], a[52:55], a[48:51], v[0:3]
    ds_read_b64_tr_b16 a[78:79], v71 offset:16896
    ds_read_b64_tr_b16 a[80:81], v64 offset:20480
    ds_read_b64_tr_b16 a[82:83], v65 offset:20992
    ds_read_b64_tr_b16 a[84:85], v66 offset:20480
    s_waitcnt lgkmcnt(13)
    v_mfma_f32_16x16x32_bf16 v[4:7], a[56:59], a[48:51], v[4:7]
    ds_read_b64_tr_b16 a[86:87], v67 offset:20992
    ds_read_b64_tr_b16 a[88:89], v68 offset:20480
    s_waitcnt lgkmcnt(13)
    v_mfma_f32_16x16x32_bf16 v[8:11], a[60:63], a[48:51], v[8:11]
    ds_read_b64_tr_b16 a[90:91], v69 offset:20992
    ds_read_b64_tr_b16 a[92:93], v70 offset:20480
    s_waitcnt lgkmcnt(11)
    v_mfma_f32_16x16x32_bf16 v[0:3], a[68:71], a[64:67], v[0:3]
    ds_read_b64_tr_b16 a[94:95], v71 offset:20992
    ds_read_b64_tr_b16 a[96:97], v64 offset:24576
    ds_read_b64_tr_b16 a[98:99], v65 offset:25088
    ds_read_b64_tr_b16 a[100:101], v66 offset:24576
    s_waitcnt lgkmcnt(13)
    v_mfma_f32_16x16x32_bf16 v[4:7], a[72:75], a[64:67], v[4:7]
    ds_read_b64_tr_b16 a[102:103], v67 offset:25088
    ds_read_b64_tr_b16 a[104:105], v68 offset:24576
    s_waitcnt lgkmcnt(13)
    v_mfma_f32_16x16x32_bf16 v[8:11], a[76:79], a[64:67], v[8:11]
    ds_read_b64_tr_b16 a[106:107], v69 offset:25088
    ds_read_b64_tr_b16 a[108:109], v70 offset:24576
    s_waitcnt lgkmcnt(11)
    v_mfma_f32_16x16x32_bf16 v[0:3], a[84:87], a[80:83], v[0:3]
    ds_read_b64_tr_b16 a[110:111], v71 offset:25088
    ds_read_b64_tr_b16 a[112:113], v64 offset:28672
    ds_read_b64_tr_b16 a[114:115], v65 offset:29184
    ds_read_b64_tr_b16 a[116:117], v66 offset:28672
    s_waitcnt lgkmcnt(13)
    v_mfma_f32_16x16x32_bf16 v[4:7], a[88:91], a[80:83], v[4:7]
    ds_read_b64_tr_b16 a[118:119], v67 offset:29184
    ds_read_b64_tr_b16 a[120:121], v68 offset:28672
    s_waitcnt lgkmcnt(13)
    v_mfma_f32_16x16x32_bf16 v[8:11], a[92:95], a[80:83], v[8:11]
    ds_read_b64_tr_b16 a[122:123], v69 offset:29184
    ds_read_b64_tr_b16 a[124:125], v70 offset:28672
    s_waitcnt lgkmcnt(11)
    v_mfma_f32_16x16x32_bf16 v[0:3], a[100:103], a[96:99], v[0:3]
    ds_read_b64_tr_b16 a[126:127], v71 offset:29184
    s_waitcnt lgkmcnt(10)
    v_mfma_f32_16x16x32_bf16 v[4:7], a[104:107], a[96:99], v[4:7]
    s_waitcnt lgkmcnt(8)
    v_mfma_f32_16x16x32_bf16 v[8:11], a[108:111], a[96:99], v[8:11]
    s_waitcnt lgkmcnt(4)
    v_mfma_f32_16x16x32_bf16 v[0:3], a[116:119], a[112:115], v[0:3]
    s_waitcnt lgkmcnt(2)
    v_mfma_f32_16x16x32_bf16 v[4:7], a[120:123], a[112:115], v[4:7]
    s_waitcnt lgkmcnt(0)
    v_mfma_f32_16x16x32_bf16 v[8:11], a[124:127], a[112:115], v[8:11]
    ds_write_b32 v111, v103 offset:4096
    s_nop 6
    ds_bpermute_b32 v12, v108, v3
    v_cvt_pk_bf16_f32 v16, v11, v11
    v_cvt_pk_bf16_f32 v17, v11, v11
    v_cvt_pk_bf16_f32 v18, v10, v10
    v_cvt_pk_bf16_f32 v19, v10, v10
    ds_write_b128 v107, v[16:19] offset:0
    v_cvt_pk_bf16_f32 v20, v10, v10
    v_cvt_pk_bf16_f32 v21, v10, v9
    v_cvt_pk_bf16_f32 v22, v9, v9
    v_cvt_pk_bf16_f32 v23, v9, v9
    ds_write_b128 v107, v[20:23] offset:16
    v_cvt_pk_bf16_f32 v24, v11, v11
    v_cvt_pk_bf16_f32 v25, v11, v10
    v_cvt_pk_bf16_f32 v26, v10, v10
    v_cvt_pk_bf16_f32 v27, v10, v10
    ds_write_b128 v107, v[24:27] offset:4224
    v_cvt_pk_bf16_f32 v28, v10, v10
    v_cvt_pk_bf16_f32 v29, v9, v9
    v_cvt_pk_bf16_f32 v30, v9, v9
    v_cvt_pk_bf16_f32 v31, v9, v9
    ds_write_b128 v107, v[28:31] offset:4240
    v_cvt_pk_bf16_f32 v40, v8, v8
    v_cvt_pk_bf16_f32 v41, v7, v7
    v_cvt_pk_bf16_f32 v42, v7, v6
    v_cvt_pk_bf16_f32 v43, v6, v6
    s_lshl_b64 exec, -1, 32
    ds_write_b128 v107, v[40:43] offset:2048
    s_mov_b64 exec, -1
    v_cvt_pk_bf16_f32 v44, v6, v6
    v_cvt_pk_bf16_f32 v45, v5, v5
    v_cvt_pk_bf16_f32 v46, v5, v4
    v_cvt_pk_bf16_f32 v47, v4, v4
    s_lshl_b64 exec, -1, 32
    ds_write_b128 v107, v[44:47] offset:2064
    s_mov_b64 exec, -1
    v_cvt_pk_bf16_f32 v48, v8, v7
    v_cvt_pk_bf16_f32 v49, v7, v7
    v_cvt_pk_bf16_f32 v50, v6, v6
    v_cvt_pk_bf16_f32 v51, v6, v6
    s_lshl_b64 exec, -1, 32
    ds_write_b128 v107, v[48:51] offset:6272
    s_mov_b64 exec, -1
    v_cvt_pk_bf16_f32 v52, v6, v5
    v_cvt_pk_bf16_f32 v53, v5, v5
    v_cvt_pk_bf16_f32 v54, v4, v4
    v_cvt_pk_bf16_f32 v55, v4, v4
    s_lshl_b64 exec, -1, 32
    ds_write_b128 v107, v[52:55] offset:6288
    s_mov_b64 exec, -1
    v_cvt_pk_bf16_f32 v32, v8, v7
    v_cvt_pk_bf16_f32 v33, v6, v6
    v_cvt_pk_bf16_f32 v34, v6, v5
    v_cvt_pk_bf16_f32 v35, v4, v4
    s_mov_b64 exec, 0xffffffff
    ds_write_b128 v105, v[32:35] offset:0
    s_mov_b64 exec, -1
    v_cvt_pk_bf16_f32 v36, v7, v6
    v_cvt_pk_bf16_f32 v37, v6, v6
    v_cvt_pk_bf16_f32 v38, v5, v4
    v_cvt_pk_bf16_f32 v39, v4, v4
    s_mov_b64 exec, 0xffffffff
    ds_write_b128 v105, v[36:39] offset:4224
    s_mov_b64 exec, -1
    s_waitcnt lgkmcnt(10)
    v_cmp_eq_u32 s[44:45], 0, v253
    v_cvt_pk_bf16_f32 v56, v3, v2
    v_cvt_pk_bf16_f32 v57, v1, v0
    v_cndmask_b32 v12, v12, 0, s[44:45]
    v_cvt_pk_bf16_f32 v58, v2, v1
    v_cvt_pk_bf16_f32 v59, v0, v12
    ds_write_b64 v104, v[56:57] offset:0
    ds_write_b64 v104, v[58:59] offset:4224
    s_lshl_b64 exec, 1, 63
    ds_write_b16 v104, v56 offset:4222
    s_mov_b64 exec, -1
    s_cmp_eq_u32 s89, 4
    s_cbranch_scc1 L_s4_48
    s_waitcnt vmcnt(0)
    v_cmp_gt_u32 s[90:91], s3, v255
    s_nop 1
    s_cmp_eq_u64 s[90:91], 0
    s_cselect_b32 s89, 3, 0
    s_cbranch_scc1 L_rp_49
    buffer_load_dword v255, v239, s[16:19], s86 offen sc1
    s_branch L_rp_49
L_s4_48:
    s_waitcnt vmcnt(6)
L_rp_49:
    s_waitcnt lgkmcnt(0)
    s_barrier
    ds_read_b128 a[0:3], v90 offset:4032
    ds_read_b128 a[4:7], v91 offset:448
    ds_read_b128 a[8:11], v90 offset:3520
    ds_read_b128 a[12:15], v91 offset:960
    ds_read_b128 a[16:19], v90 offset:3008
    ds_read_b128 a[20:23], v91 offset:1472
    ds_read_b128 a[24:27], v90 offset:2496
    ds_read_b128 a[28:31], v91 offset:1984
    ds_read_b128 a[32:35], v90 offset:1984
    ds_read_b128 a[36:39], v91 offset:2496
    ds_read_b128 a[40:43], v90 offset:1472
    ds_read_b128 a[44:47], v91 offset:3008
    ds_read_b128 a[48:51], v90 offset:960
    ds_read_b128 a[52:55], v91 offset:3520
    s_cmp_eq_u32 s89, 3
    s_cbranch_scc0 L_sm_50
    s_add_u32 s43, s80, 0
    buffer_load_dwordx4 v[116:119], v250, s[16:19], s43 offen offset:0 sc1
    buffer_load_dwordx4 v[148:151], v250, s[16:19], s43 offen offset:1024 sc1
L_sm_50:
    s_waitcnt lgkmcnt(12)
    v_mfma_f32_16x16x32_bf16 v[0:3], a[0:3], a[4:7], 0
    s_waitcnt lgkmcnt(10)
    v_mfma_f32_16x16x32_bf16 v[4:7], a[0:3], a[12:15], 0
    v_mfma_f32_16x16x32_bf16 v[4:7], a[8:11], a[4:7], v[4:7]
    v_mfma_f32_16x16x32_bf16 v[8:11], a[8:11], a[12:15], 0
    s_waitcnt lgkmcnt(8)
    v_mfma_f32_16x16x32_bf16 v[8:11], a[0:3], a[20:23], v[8:11]
    ds_read_b128 a[56:59], v90 offset:3968
    v_mfma_f32_16x16x32_bf16 v[8:11], a[16:19], a[4:7], v[8:11]
    v_mfma_f32_16x16x32_bf16 v[12:15], a[8:11], a[20:23], 0
    ds_read_b128 a[60:63], v91 offset:384
    v_mfma_f32_16x16x32_bf16 v[12:15], a[16:19], a[12:15], v[12:15]
    ds_read_b128 a[64:67], v90 offset:3456
    v_mfma_f32_16x16x32_bf16 v[16:19], a[16:19], a[20:23], 0
    s_waitcnt lgkmcnt(9)
    v_mfma_f32_16x16x32_bf16 v[12:15], a[0:3], a[28:31], v[12:15]
    ds_read_b128 a[68:71], v91 offset:896
    v_mfma_f32_16x16x32_bf16 v[12:15], a[24:27], a[4:7], v[12:15]
    ds_read_b128 a[72:75], v90 offset:2944
    v_mfma_f32_16x16x32_bf16 v[16:19], a[8:11], a[28:31], v[16:19]
    v_mfma_f32_16x16x32_bf16 v[16:19], a[24:27], a[12:15], v[16:19]
    ds_read_b128 a[76:79], v91 offset:1408
    v_mfma_f32_16x16x32_bf16 v[20:23], a[16:19], a[28:31], 0
    ds_read_b128 a[80:83], v90 offset:2432
    v_mfma_f32_16x16x32_bf16 v[20:23], a[24:27], a[20:23], v[20:23]
    v_mfma_f32_16x16x32_bf16 v[24:27], a[24:27], a[28:31], 0
    ds_read_b128 a[84:87], v91 offset:1920
    s_waitcnt lgkmcnt(12)
    v_mfma_f32_16x16x32_bf16 v[16:19], a[0:3], a[36:39], v[16:19]
    ds_read_b128 a[88:91], v90 offset:1920
    v_mfma_f32_16x16x32_bf16 v[16:19], a[32:35], a[4:7], v[16:19]
    v_mfma_f32_16x16x32_bf16 v[20:23], a[8:11], a[36:39], v[20:23]
    ds_read_b128 a[92:95], v91 offset:2432
    v_mfma_f32_16x16x32_bf16 v[20:23], a[32:35], a[12:15], v[20:23]
    ds_read_b128 a[96:99], v90 offset:1408
    v_mfma_f32_16x16x32_bf16 v[24:27], a[16:19], a[36:39], v[24:27]
    v_mfma_f32_16x16x32_bf16 v[24:27], a[32:35], a[20:23], v[24:27]
    s_waitcnt lgkmcnt(13)
    v_mfma_f32_16x16x32_bf16 v[20:23], a[0:3], a[44:47], v[20:23]
    ds_read_b128 a[100:103], v91 offset:2944
    v_mfma_f32_16x16x32_bf16 v[20:23], a[40:43], a[4:7], v[20:23]
    s_waitcnt lgkmcnt(8)
    ds_read_b32 v60, v94 offset:0
    ds_read_b32 v61, v94 offset:16
    v_mfma_f32_16x16x32_bf16 v[24:27], a[8:11], a[44:47], v[24:27]
    ds_read_b128 a[104:107], v90 offset:896
    v_mfma_f32_16x16x32_bf16 v[24:27], a[40:43], a[12:15], v[24:27]
    ds_read_b128 a[108:111], v91 offset:3456
    v_mfma_f32_16x16x32_bf16 v[24:27], a[0:3], a[52:55], v[24:27]
    v_mfma_f32_16x16x32_bf16 v[24:27], a[48:51], a[4:7], v[24:27]
    s_waitcnt lgkmcnt(0)
    s_cmp_eq_u32 s89, 3
    s_cbranch_scc0 L_sm_51
    s_add_u32 s43, s80, 12288
    buffer_load_dwordx4 v[120:123], v250, s[16:19], s43 offen offset:0 sc1
    buffer_load_dwordx4 v[152:155], v250, s[16:19], s43 offen offset:1024 sc1
    s_add_u32 s43, s80, 24576
    buffer_load_dwordx4 v[124:127], v250, s[16:19], s43 offen offset:0 sc1
    buffer_load_dwordx4 v[156:159], v250, s[16:19], s43 offen offset:1024 sc1
L_sm_51:
    v_mfma_f32_16x16x32_bf16 v[0:3], a[56:59], a[60:63], v[0:3]
    ds_read_b128 a[0:3], v90 offset:3904
    v_mfma_f32_16x16x32_bf16 v[4:7], a[56:59], a[68:71], v[4:7]
    ds_read_b128 a[4:7], v91 offset:320
    v_mfma_f32_16x16x32_bf16 v[4:7], a[64:67], a[60:63], v[4:7]
    v_lshlrev_b32 v28, 16, v60
    v_mfma_f32_16x16x32_bf16 v[8:11], a[64:67], a[68:71], v[8:11]
    ds_read_b128 a[8:11], v90 offset:3392
    v_mfma_f32_16x16x32_bf16 v[8:11], a[56:59], a[76:79], v[8:11]
    ds_read_b128 a[12:15], v91 offset:832
    v_mfma_f32_16x16x32_bf16 v[8:11], a[72:75], a[60:63], v[8:11]
    v_and_b32 v29, 0xffff0000, v60
    v_mfma_f32_16x16x32_bf16 v[12:15], a[64:67], a[76:79], v[12:15]
    ds_read_b128 a[16:19], v90 offset:2880
    v_mfma_f32_16x16x32_bf16 v[12:15], a[72:75], a[68:71], v[12:15]
    ds_read_b128 a[20:23], v91 offset:1344
    v_mfma_f32_16x16x32_bf16 v[16:19], a[72:75], a[76:79], v[16:19]
    v_mul_f32 v28, v92, v28
    v_mfma_f32_16x16x32_bf16 v[12:15], a[56:59], a[84:87], v[12:15]
    ds_read_b128 a[24:27], v90 offset:2368
    v_mfma_f32_16x16x32_bf16 v[12:15], a[80:83], a[60:63], v[12:15]
    ds_read_b128 a[28:31], v91 offset:1856
    v_mfma_f32_16x16x32_bf16 v[16:19], a[64:67], a[84:87], v[16:19]
    v_mul_f32 v29, v92, v29
    v_mfma_f32_16x16x32_bf16 v[16:19], a[80:83], a[68:71], v[16:19]
    ds_read_b128 a[32:35], v90 offset:1856
    v_mfma_f32_16x16x32_bf16 v[20:23], a[72:75], a[84:87], v[20:23]
    ds_read_b128 a[36:39], v91 offset:2368
    v_mfma_f32_16x16x32_bf16 v[20:23], a[80:83], a[76:79], v[20:23]
    v_lshlrev_b32 v30, 16, v61
    v_mfma_f32_16x16x32_bf16 v[24:27], a[80:83], a[84:87], v[24:27]
    ds_read_b128 a[40:43], v90 offset:1344
    v_mfma_f32_16x16x32_bf16 v[16:19], a[56:59], a[92:95], v[16:19]
    ds_read_b128 a[44:47], v91 offset:2880
    v_mfma_f32_16x16x32_bf16 v[16:19], a[88:91], a[60:63], v[16:19]
    v_and_b32 v31, 0xffff0000, v61
    v_mfma_f32_16x16x32_bf16 v[20:23], a[64:67], a[92:95], v[20:23]
    ds_read_b128 a[48:51], v90 offset:832
    v_mfma_f32_16x16x32_bf16 v[20:23], a[88:91], a[68:71], v[20:23]
    ds_read_b128 a[52:55], v91 offset:3392
    v_mfma_f32_16x16x32_bf16 v[24:27], a[72:75], a[92:95], v[24:27]
    v_mul_f32 v30, v92, v30
    v_mfma_f32_16x16x32_bf16 v[24:27], a[88:91], a[76:79], v[24:27]
    v_mul_f32 v31, v92, v31
    v_mfma_f32_16x16x32_bf16 v[20:23], a[56:59], a[100:103], v[20:23]
    v_mfma_f32_16x16x32_bf16 v[20:23], a[96:99], a[60:63], v[20:23]
    s_waitcnt lgkmcnt(8)
    ds_read_b32 v62, v94 offset:512
    ds_read_b32 v63, v94 offset:528
    v_mfma_f32_16x16x32_bf16 v[24:27], a[64:67], a[100:103], v[24:27]
    v_mfma_f32_16x16x32_bf16 v[24:27], a[96:99], a[68:71], v[24:27]
    v_mfma_f32_16x16x32_bf16 v[24:27], a[56:59], a[108:111], v[24:27]
    v_mfma_f32_16x16x32_bf16 v[24:27], a[104:107], a[60:63], v[24:27]
    s_waitcnt lgkmcnt(0)
    s_cmp_eq_u32 s89, 3
    s_cbranch_scc0 L_sm_52
    s_add_u32 s43, s80, 36864
    buffer_load_dwordx4 v[128:131], v250, s[16:19], s43 offen offset:0 sc1
    buffer_load_dwordx4 v[160:163], v250, s[16:19], s43 offen offset:1024 sc1
L_sm_52:
    s_cmp_eq_u32 s89, 0
    s_cbranch_scc0 L_trs_53
    s_waitcnt vmcnt(0)
    v_cmp_gt_u32 s[90:91], s3, v255
    s_nop 1
    s_cmp_eq_u64 s[90:91], 0
    s_cbranch_scc0 L_tra_54
    s_add_u32 s43, s80, 0
    buffer_load_dwordx4 v[116:119], v250, s[16:19], s43 offen offset:0 sc1
    buffer_load_dwordx4 v[148:151], v250, s[16:19], s43 offen offset:1024 sc1
    s_add_u32 s43, s80, 12288
    buffer_load_dwordx4 v[120:123], v250, s[16:19], s43 offen offset:0 sc1
    buffer_load_dwordx4 v[152:155], v250, s[16:19], s43 offen offset:1024 sc1
    s_add_u32 s43, s80, 24576
    buffer_load_dwordx4 v[124:127], v250, s[16:19], s43 offen offset:0 sc1
    buffer_load_dwordx4 v[156:159], v250, s[16:19], s43 offen offset:1024 sc1
    s_add_u32 s43, s80, 36864
    buffer_load_dwordx4 v[128:131], v250, s[16:19], s43 offen offset:0 sc1
    buffer_load_dwordx4 v[160:163], v250, s[16:19], s43 offen offset:1024 sc1
    s_add_u32 s89, s89, 1
    s_branch L_trs_53
L_tra_54:
    buffer_load_dword v255, v239, s[16:19], s86 offen sc1
L_trs_53:
    v_mfma_f32_16x16x32_bf16 v[0:3], a[0:3], a[4:7], v[0:3]
    ds_read_b128 a[56:59], v90 offset:3840
    v_mfma_f32_16x16x32_bf16 v[4:7], a[0:3], a[12:15], v[4:7]
    ds_read_b128 a[60:63], v91 offset:256
    v_mfma_f32_16x16x32_bf16 v[4:7], a[8:11], a[4:7], v[4:7]
    v_lshlrev_b32 v32, 16, v62
    v_mfma_f32_16x16x32_bf16 v[8:11], a[8:11], a[12:15], v[8:11]
    ds_read_b128 a[64:67], v90 offset:3328
    v_mfma_f32_16x16x32_bf16 v[8:11], a[0:3], a[20:23], v[8:11]
    ds_read_b128 a[68:71], v91 offset:768
    v_mfma_f32_16x16x32_bf16 v[8:11], a[16:19], a[4:7], v[8:11]
    v_and_b32 v33, 0xffff0000, v62
    v_mfma_f32_16x16x32_bf16 v[12:15], a[8:11], a[20:23], v[12:15]
    ds_read_b128 a[72:75], v90 offset:2816
    v_mfma_f32_16x16x32_bf16 v[12:15], a[16:19], a[12:15], v[12:15]
    ds_read_b128 a[76:79], v91 offset:1280
    v_mfma_f32_16x16x32_bf16 v[16:19], a[16:19], a[20:23], v[16:19]
    v_mul_f32 v32, v92, v32
    v_mfma_f32_16x16x32_bf16 v[12:15], a[0:3], a[28:31], v[12:15]
    ds_read_b128 a[80:83], v90 offset:2304
    v_mfma_f32_16x16x32_bf16 v[12:15], a[24:27], a[4:7], v[12:15]
    ds_read_b128 a[84:87], v91 offset:1792
    v_mfma_f32_16x16x32_bf16 v[16:19], a[8:11], a[28:31], v[16:19]
    v_mul_f32 v33, v92, v33
    v_mfma_f32_16x16x32_bf16 v[16:19], a[24:27], a[12:15], v[16:19]
    ds_read_b128 a[88:91], v90 offset:1792
    v_mfma_f32_16x16x32_bf16 v[20:23], a[16:19], a[28:31], v[20:23]
    ds_read_b128 a[92:95], v91 offset:2304
    v_mfma_f32_16x16x32_bf16 v[20:23], a[24:27], a[20:23], v[20:23]
    v_lshlrev_b32 v34, 16, v63
    v_mfma_f32_16x16x32_bf16 v[24:27], a[24:27], a[28:31], v[24:27]
    ds_read_b128 a[96:99], v90 offset:1280
    v_mfma_f32_16x16x32_bf16 v[16:19], a[0:3], a[36:39], v[16:19]
    ds_read_b128 a[100:103], v91 offset:2816
    v_mfma_f32_16x16x32_bf16 v[16:19], a[32:35], a[4:7], v[16:19]
    v_and_b32 v35, 0xffff0000, v63
    v_mfma_f32_16x16x32_bf16 v[20:23], a[8:11], a[36:39], v[20:23]
    ds_read_b128 a[104:107], v90 offset:768
    v_mfma_f32_16x16x32_bf16 v[20:23], a[32:35], a[12:15], v[20:23]
    ds_read_b128 a[108:111], v91 offset:3328
    v_mfma_f32_16x16x32_bf16 v[24:27], a[16:19], a[36:39], v[24:27]
    v_mul_f32 v34, v92, v34
    v_mfma_f32_16x16x32_bf16 v[24:27], a[32:35], a[20:23], v[24:27]
    v_mul_f32 v35, v92, v35
    v_mfma_f32_16x16x32_bf16 v[20:23], a[0:3], a[44:47], v[20:23]
    v_mfma_f32_16x16x32_bf16 v[20:23], a[40:43], a[4:7], v[20:23]
    s_waitcnt lgkmcnt(8)
    ds_read_b32 v64, v94 offset:1024
    ds_read_b32 v65, v94 offset:1040
    v_mfma_f32_16x16x32_bf16 v[24:27], a[8:11], a[44:47], v[24:27]
    v_mfma_f32_16x16x32_bf16 v[24:27], a[40:43], a[12:15], v[24:27]
    v_mfma_f32_16x16x32_bf16 v[24:27], a[0:3], a[52:55], v[24:27]
    v_mfma_f32_16x16x32_bf16 v[24:27], a[48:51], a[4:7], v[24:27]
    s_waitcnt lgkmcnt(0)
    s_cmp_eq_u32 s89, 3
    s_cbranch_scc0 L_sm_55
    s_add_u32 s43, s80, 49152
    buffer_load_dwordx4 v[132:135], v250, s[16:19], s43 offen offset:0 sc1
    buffer_load_dwordx4 v[164:167], v250, s[16:19], s43 offen offset:1024 sc1
    s_add_u32 s43, s80, 61440
    buffer_load_dwordx4 v[136:139], v250, s[16:19], s43 offen offset:0 sc1
    buffer_load_dwordx4 v[168:171], v250, s[16:19], s43 offen offset:1024 sc1
L_sm_55:
    v_mfma_f32_16x16x32_bf16 v[0:3], a[56:59], a[60:63], v[0:3]
    ds_read_b128 a[0:3], v90 offset:3776
    v_mfma_f32_16x16x32_bf16 v[4:7], a[56:59], a[68:71], v[4:7]
    ds_read_b128 a[4:7], v91 offset:192
    v_mfma_f32_16x16x32_bf16 v[4:7], a[64:67], a[60:63], v[4:7]
    v_lshlrev_b32 v36, 16, v64
    v_mfma_f32_16x16x32_bf16 v[8:11], a[64:67], a[68:71], v[8:11]
    ds_read_b128 a[8:11], v90 offset:3264
    v_mfma_f32_16x16x32_bf16 v[8:11], a[56:59], a[76:79], v[8:11]
    ds_read_b128 a[12:15], v91 offset:704
    v_mfma_f32_16x16x32_bf16 v[8:11], a[72:75], a[60:63], v[8:11]
    v_and_b32 v37, 0xffff0000, v64
    v_mfma_f32_16x16x32_bf16 v[12:15], a[64:67], a[76:79], v[12:15]
    ds_read_b128 a[16:19], v90 offset:2752
    v_mfma_f32_16x16x32_bf16 v[12:15], a[72:75], a[68:71], v[12:15]
    ds_read_b128 a[20:23], v91 offset:1216
    v_mfma_f32_16x16x32_bf16 v[16:19], a[72:75], a[76:79], v[16:19]
    v_mul_f32 v36, v92, v36
    v_mfma_f32_16x16x32_bf16 v[12:15], a[56:59], a[84:87], v[12:15]
    ds_read_b128 a[24:27], v90 offset:2240
    v_mfma_f32_16x16x32_bf16 v[12:15], a[80:83], a[60:63], v[12:15]
    ds_read_b128 a[28:31], v91 offset:1728
    v_mfma_f32_16x16x32_bf16 v[16:19], a[64:67], a[84:87], v[16:19]
    v_mul_f32 v37, v92, v37
    v_mfma_f32_16x16x32_bf16 v[16:19], a[80:83], a[68:71], v[16:19]
    ds_read_b128 a[32:35], v90 offset:1728
    v_mfma_f32_16x16x32_bf16 v[20:23], a[72:75], a[84:87], v[20:23]
    ds_read_b128 a[36:39], v91 offset:2240
    v_mfma_f32_16x16x32_bf16 v[20:23], a[80:83], a[76:79], v[20:23]
    v_lshlrev_b32 v38, 16, v65
    v_mfma_f32_16x16x32_bf16 v[24:27], a[80:83], a[84:87], v[24:27]
    ds_read_b128 a[40:43], v90 offset:1216
    v_mfma_f32_16x16x32_bf16 v[16:19], a[56:59], a[92:95], v[16:19]
    ds_read_b128 a[44:47], v91 offset:2752
    v_mfma_f32_16x16x32_bf16 v[16:19], a[88:91], a[60:63], v[16:19]
    v_and_b32 v39, 0xffff0000, v65
    v_mfma_f32_16x16x32_bf16 v[20:23], a[64:67], a[92:95], v[20:23]
    ds_read_b128 a[48:51], v90 offset:704
    v_mfma_f32_16x16x32_bf16 v[20:23], a[88:91], a[68:71], v[20:23]
    ds_read_b128 a[52:55], v91 offset:3264
    v_mfma_f32_16x16x32_bf16 v[24:27], a[72:75], a[92:95], v[24:27]
    v_mul_f32 v38, v92, v38
    v_mfma_f32_16x16x32_bf16 v[24:27], a[88:91], a[76:79], v[24:27]
    v_mul_f32 v39, v92, v39
    v_mfma_f32_16x16x32_bf16 v[20:23], a[56:59], a[100:103], v[20:23]
    v_mfma_f32_16x16x32_bf16 v[20:23], a[96:99], a[60:63], v[20:23]
    s_waitcnt lgkmcnt(8)
    ds_read_b32 v66, v94 offset:1536
    ds_read_b32 v67, v94 offset:1552
    v_mfma_f32_16x16x32_bf16 v[24:27], a[64:67], a[100:103], v[24:27]
    v_mfma_f32_16x16x32_bf16 v[24:27], a[96:99], a[68:71], v[24:27]
    v_mfma_f32_16x16x32_bf16 v[24:27], a[56:59], a[108:111], v[24:27]
    v_mfma_f32_16x16x32_bf16 v[24:27], a[104:107], a[60:63], v[24:27]
    s_waitcnt lgkmcnt(0)
    s_cmp_eq_u32 s89, 3
    s_cbranch_scc0 L_sm_56
    s_add_u32 s43, s80, 73728
    buffer_load_dwordx4 v[140:143], v250, s[16:19], s43 offen offset:0 sc1
    buffer_load_dwordx4 v[172:175], v250, s[16:19], s43 offen offset:1024 sc1
    s_add_u32 s43, s80, 86016
    buffer_load_dwordx4 v[144:147], v250, s[16:19], s43 offen offset:0 sc1
    buffer_load_dwordx4 v[176:179], v250, s[16:19], s43 offen offset:1024 sc1
L_sm_56:
    s_cmp_eq_u32 s89, 1
    s_cbranch_scc0 L_trs_57
    s_add_u32 s43, s80, 49152
    buffer_load_dwordx4 v[132:135], v250, s[16:19], s43 offen offset:0 sc1
    buffer_load_dwordx4 v[164:167], v250, s[16:19], s43 offen offset:1024 sc1
    s_add_u32 s43, s80, 61440
    buffer_load_dwordx4 v[136:139], v250, s[16:19], s43 offen offset:0 sc1
    buffer_load_dwordx4 v[168:171], v250, s[16:19], s43 offen offset:1024 sc1
    s_add_u32 s43, s80, 73728
    buffer_load_dwordx4 v[140:143], v250, s[16:19], s43 offen offset:0 sc1
    buffer_load_dwordx4 v[172:175], v250, s[16:19], s43 offen offset:1024 sc1
    s_add_u32 s43, s80, 86016
    buffer_load_dwordx4 v[144:147], v250, s[16:19], s43 offen offset:0 sc1
    buffer_load_dwordx4 v[176:179], v250, s[16:19], s43 offen offset:1024 sc1
    s_add_u32 s89, s89, 1
L_trs_57:
    s_cmp_eq_u32 s89, 0
    s_cbranch_scc0 L_trs_59
    s_waitcnt vmcnt(0)
    v_cmp_gt_u32 s[90:91], s3, v255
    s_nop 1
    s_cmp_eq_u64 s[90:91], 0
    s_cbranch_scc0 L_tra_60
    s_add_u32 s43, s80, 0
    buffer_load_dwordx4 v[116:119], v250, s[16:19], s43 offen offset:0 sc1
    buffer_load_dwordx4 v[148:151], v250, s[16:19], s43 offen offset:1024 sc1
    s_add_u32 s43, s80, 12288
    buffer_load_dwordx4 v[120:123], v250, s[16:19], s43 offen offset:0 sc1
    buffer_load_dwordx4 v[152:155], v250, s[16:19], s43 offen offset:1024 sc1
    s_add_u32 s43, s80, 24576
    buffer_load_dwordx4 v[124:127], v250, s[16:19], s43 offen offset:0 sc1
    buffer_load_dwordx4 v[156:159], v250, s[16:19], s43 offen offset:1024 sc1
    s_add_u32 s43, s80, 36864
    buffer_load_dwordx4 v[128:131], v250, s[16:19], s43 offen offset:0 sc1
    buffer_load_dwordx4 v[160:163], v250, s[16:19], s43 offen offset:1024 sc1
    s_add_u32 s89, s89, 1
    s_branch L_trs_59
L_tra_60:
    buffer_load_dword v255, v239, s[16:19], s86 offen sc1
L_trs_59:
    v_mfma_f32_16x16x32_bf16 v[0:3], a[0:3], a[4:7], v[0:3]
    ds_read_b128 a[56:59], v90 offset:3712
    v_mfma_f32_16x16x32_bf16 v[4:7], a[0:3], a[12:15], v[4:7]
    ds_read_b128 a[60:63], v91 offset:128
    v_mfma_f32_16x16x32_bf16 v[4:7], a[8:11], a[4:7], v[4:7]
    v_lshlrev_b32 v40, 16, v66
    v_mfma_f32_16x16x32_bf16 v[8:11], a[8:11], a[12:15], v[8:11]
    ds_read_b128 a[64:67], v90 offset:3200
    v_mfma_f32_16x16x32_bf16 v[8:11], a[0:3], a[20:23], v[8:11]
    ds_read_b128 a[68:71], v91 offset:640
    v_mfma_f32_16x16x32_bf16 v[8:11], a[16:19], a[4:7], v[8:11]
    v_and_b32 v41, 0xffff0000, v66
    v_mfma_f32_16x16x32_bf16 v[12:15], a[8:11], a[20:23], v[12:15]
    ds_read_b128 a[72:75], v90 offset:2688
    v_mfma_f32_16x16x32_bf16 v[12:15], a[16:19], a[12:15], v[12:15]
    ds_read_b128 a[76:79], v91 offset:1152
    v_mfma_f32_16x16x32_bf16 v[16:19], a[16:19], a[20:23], v[16:19]
    v_mul_f32 v40, v92, v40
    v_mfma_f32_16x16x32_bf16 v[12:15], a[0:3], a[28:31], v[12:15]
    ds_read_b128 a[80:83], v90 offset:2176
    v_mfma_f32_16x16x32_bf16 v[12:15], a[24:27], a[4:7], v[12:15]
    ds_read_b128 a[84:87], v91 offset:1664
    v_mfma_f32_16x16x32_bf16 v[16:19], a[8:11], a[28:31], v[16:19]
    v_mul_f32 v41, v92, v41
    v_mfma_f32_16x16x32_bf16 v[16:19], a[24:27], a[12:15], v[16:19]
    ds_read_b128 a[88:91], v90 offset:1664
    v_mfma_f32_16x16x32_bf16 v[20:23], a[16:19], a[28:31], v[20:23]
    ds_read_b128 a[92:95], v91 offset:2176
    v_mfma_f32_16x16x32_bf16 v[20:23], a[24:27], a[20:23], v[20:23]
    v_lshlrev_b32 v42, 16, v67
    v_mfma_f32_16x16x32_bf16 v[24:27], a[24:27], a[28:31], v[24:27]
    ds_read_b128 a[96:99], v90 offset:1152
    v_mfma_f32_16x16x32_bf16 v[16:19], a[0:3], a[36:39], v[16:19]
    ds_read_b128 a[100:103], v91 offset:2688
    v_mfma_f32_16x16x32_bf16 v[16:19], a[32:35], a[4:7], v[16:19]
    v_and_b32 v43, 0xffff0000, v67
    v_mfma_f32_16x16x32_bf16 v[20:23], a[8:11], a[36:39], v[20:23]
    ds_read_b128 a[104:107], v90 offset:640
    v_mfma_f32_16x16x32_bf16 v[20:23], a[32:35], a[12:15], v[20:23]
    ds_read_b128 a[108:111], v91 offset:3200
    v_mfma_f32_16x16x32_bf16 v[24:27], a[16:19], a[36:39], v[24:27]
    v_mul_f32 v42, v92, v42
    v_mfma_f32_16x16x32_bf16 v[24:27], a[32:35], a[20:23], v[24:27]
    v_mul_f32 v43, v92, v43
    v_mfma_f32_16x16x32_bf16 v[20:23], a[0:3], a[44:47], v[20:23]
    v_mfma_f32_16x16x32_bf16 v[20:23], a[40:43], a[4:7], v[20:23]
    s_waitcnt lgkmcnt(8)
    ds_read_b32 v68, v94 offset:2048
    ds_read_b32 v69, v94 offset:2064
    v_mfma_f32_16x16x32_bf16 v[24:27], a[8:11], a[44:47], v[24:27]
    v_mfma_f32_16x16x32_bf16 v[24:27], a[40:43], a[12:15], v[24:27]
    v_mfma_f32_16x16x32_bf16 v[24:27], a[0:3], a[52:55], v[24:27]
    v_mfma_f32_16x16x32_bf16 v[24:27], a[48:51], a[4:7], v[24:27]
    s_waitcnt lgkmcnt(0)
    v_mfma_f32_16x16x32_bf16 v[0:3], a[56:59], a[60:63], v[0:3]
    ds_read_b128 a[0:3], v90 offset:3648
    v_mfma_f32_16x16x32_bf16 v[4:7], a[56:59], a[68:71], v[4:7]
    ds_read_b128 a[4:7], v91 offset:64
    v_mfma_f32_16x16x32_bf16 v[4:7], a[64:67], a[60:63], v[4:7]
    v_lshlrev_b32 v44, 16, v68
    v_mfma_f32_16x16x32_bf16 v[8:11], a[64:67], a[68:71], v[8:11]
    ds_read_b128 a[8:11], v90 offset:3136
    v_mfma_f32_16x16x32_bf16 v[8:11], a[56:59], a[76:79], v[8:11]
    ds_read_b128 a[12:15], v91 offset:576
    v_mfma_f32_16x16x32_bf16 v[8:11], a[72:75], a[60:63], v[8:11]
    v_and_b32 v45, 0xffff0000, v68
    v_mfma_f32_16x16x32_bf16 v[12:15], a[64:67], a[76:79], v[12:15]
    ds_read_b128 a[16:19], v90 offset:2624
    v_mfma_f32_16x16x32_bf16 v[12:15], a[72:75], a[68:71], v[12:15]
    ds_read_b128 a[20:23], v91 offset:1088
    v_mfma_f32_16x16x32_bf16 v[16:19], a[72:75], a[76:79], v[16:19]
    v_mul_f32 v44, v92, v44
    v_mfma_f32_16x16x32_bf16 v[12:15], a[56:59], a[84:87], v[12:15]
    ds_read_b128 a[24:27], v90 offset:2112
    v_mfma_f32_16x16x32_bf16 v[12:15], a[80:83], a[60:63], v[12:15]
    ds_read_b128 a[28:31], v91 offset:1600
    v_mfma_f32_16x16x32_bf16 v[16:19], a[64:67], a[84:87], v[16:19]
    v_mul_f32 v45, v92, v45
    v_mfma_f32_16x16x32_bf16 v[16:19], a[80:83], a[68:71], v[16:19]
    ds_read_b128 a[32:35], v90 offset:1600
    v_mfma_f32_16x16x32_bf16 v[20:23], a[72:75], a[84:87], v[20:23]
    ds_read_b128 a[36:39], v91 offset:2112
    v_mfma_f32_16x16x32_bf16 v[20:23], a[80:83], a[76:79], v[20:23]
    v_lshlrev_b32 v46, 16, v69
    v_mfma_f32_16x16x32_bf16 v[24:27], a[80:83], a[84:87], v[24:27]
    ds_read_b128 a[40:43], v90 offset:1088
    v_mfma_f32_16x16x32_bf16 v[16:19], a[56:59], a[92:95], v[16:19]
    ds_read_b128 a[44:47], v91 offset:2624
    v_mfma_f32_16x16x32_bf16 v[16:19], a[88:91], a[60:63], v[16:19]
    v_and_b32 v47, 0xffff0000, v69
    v_mfma_f32_16x16x32_bf16 v[20:23], a[64:67], a[92:95], v[20:23]
    ds_read_b128 a[48:51], v90 offset:576
    v_mfma_f32_16x16x32_bf16 v[20:23], a[88:91], a[68:71], v[20:23]
    ds_read_b128 a[52:55], v91 offset:3136
    v_mfma_f32_16x16x32_bf16 v[24:27], a[72:75], a[92:95], v[24:27]
    v_mul_f32 v46, v92, v46
    v_mfma_f32_16x16x32_bf16 v[24:27], a[88:91], a[76:79], v[24:27]
    v_mul_f32 v47, v92, v47
    v_mfma_f32_16x16x32_bf16 v[20:23], a[56:59], a[100:103], v[20:23]
    v_mfma_f32_16x16x32_bf16 v[20:23], a[96:99], a[60:63], v[20:23]
    s_waitcnt lgkmcnt(8)
    ds_read_b32 v70, v94 offset:2560
    ds_read_b32 v71, v94 offset:2576
    v_mfma_f32_16x16x32_bf16 v[24:27], a[64:67], a[100:103], v[24:27]
    v_mfma_f32_16x16x32_bf16 v[24:27], a[96:99], a[68:71], v[24:27]
    v_mfma_f32_16x16x32_bf16 v[24:27], a[56:59], a[108:111], v[24:27]
    v_mfma_f32_16x16x32_bf16 v[24:27], a[104:107], a[60:63], v[24:27]
    s_waitcnt lgkmcnt(0)
    s_cmp_eq_u32 s89, 1
    s_cbranch_scc0 L_trs_61
    s_add_u32 s43, s80, 49152
    buffer_load_dwordx4 v[132:135], v250, s[16:19], s43 offen offset:0 sc1
    buffer_load_dwordx4 v[164:167], v250, s[16:19], s43 offen offset:1024 sc1
    s_add_u32 s43, s80, 61440
    buffer_load_dwordx4 v[136:139], v250, s[16:19], s43 offen offset:0 sc1
    buffer_load_dwordx4 v[168:171], v250, s[16:19], s43 offen offset:1024 sc1
    s_add_u32 s43, s80, 73728
    buffer_load_dwordx4 v[140:143], v250, s[16:19], s43 offen offset:0 sc1
    buffer_load_dwordx4 v[172:175], v250, s[16:19], s43 offen offset:1024 sc1
    s_add_u32 s43, s80, 86016
    buffer_load_dwordx4 v[144:147], v250, s[16:19], s43 offen offset:0 sc1
    buffer_load_dwordx4 v[176:179], v250, s[16:19], s43 offen offset:1024 sc1
    s_add_u32 s89, s89, 1
L_trs_61:
    v_mfma_f32_16x16x32_bf16 v[0:3], a[0:3], a[4:7], v[0:3]
    ds_read_b128 a[56:59], v90 offset:3584
    v_mfma_f32_16x16x32_bf16 v[4:7], a[0:3], a[12:15], v[4:7]
    ds_read_b128 a[60:63], v91 offset:0
    v_mfma_f32_16x16x32_bf16 v[4:7], a[8:11], a[4:7], v[4:7]
    v_lshlrev_b32 v48, 16, v70
    v_mfma_f32_16x16x32_bf16 v[8:11], a[8:11], a[12:15], v[8:11]
    ds_read_b128 a[64:67], v90 offset:3072
    v_mfma_f32_16x16x32_bf16 v[8:11], a[0:3], a[20:23], v[8:11]
    ds_read_b128 a[68:71], v91 offset:512
    v_mfma_f32_16x16x32_bf16 v[8:11], a[16:19], a[4:7], v[8:11]
    v_and_b32 v49, 0xffff0000, v70
    v_mfma_f32_16x16x32_bf16 v[12:15], a[8:11], a[20:23], v[12:15]
    ds_read_b128 a[72:75], v90 offset:2560
    v_mfma_f32_16x16x32_bf16 v[12:15], a[16:19], a[12:15], v[12:15]
    ds_read_b128 a[76:79], v91 offset:1024
    v_mfma_f32_16x16x32_bf16 v[16:19], a[16:19], a[20:23], v[16:19]
    v_mul_f32 v48, v92, v48
    v_mfma_f32_16x16x32_bf16 v[12:15], a[0:3], a[28:31], v[12:15]
    ds_read_b128 a[80:83], v90 offset:2048
    v_mfma_f32_16x16x32_bf16 v[12:15], a[24:27], a[4:7], v[12:15]
    ds_read_b128 a[84:87], v91 offset:1536
    v_mfma_f32_16x16x32_bf16 v[16:19], a[8:11], a[28:31], v[16:19]
    v_mul_f32 v49, v92, v49
    v_mfma_f32_16x16x32_bf16 v[16:19], a[24:27], a[12:15], v[16:19]
    ds_read_b128 a[88:91], v90 offset:1536
    v_mfma_f32_16x16x32_bf16 v[20:23], a[16:19], a[28:31], v[20:23]
    ds_read_b128 a[92:95], v91 offset:2048
    v_mfma_f32_16x16x32_bf16 v[20:23], a[24:27], a[20:23], v[20:23]
    v_lshlrev_b32 v50, 16, v71
    v_mfma_f32_16x16x32_bf16 v[24:27], a[24:27], a[28:31], v[24:27]
    ds_read_b128 a[96:99], v90 offset:1024
    v_mfma_f32_16x16x32_bf16 v[16:19], a[0:3], a[36:39], v[16:19]
    ds_read_b128 a[100:103], v91 offset:2560
    v_mfma_f32_16x16x32_bf16 v[16:19], a[32:35], a[4:7], v[16:19]
    v_and_b32 v51, 0xffff0000, v71
    v_mfma_f32_16x16x32_bf16 v[20:23], a[8:11], a[36:39], v[20:23]
    ds_read_b128 a[104:107], v90 offset:512
    v_mfma_f32_16x16x32_bf16 v[20:23], a[32:35], a[12:15], v[20:23]
    ds_read_b128 a[108:111], v91 offset:3072
    v_mfma_f32_16x16x32_bf16 v[24:27], a[16:19], a[36:39], v[24:27]
    v_mul_f32 v50, v92, v50
    v_mfma_f32_16x16x32_bf16 v[24:27], a[32:35], a[20:23], v[24:27]
    v_mul_f32 v51, v92, v51
    v_mfma_f32_16x16x32_bf16 v[20:23], a[0:3], a[44:47], v[20:23]
    v_mfma_f32_16x16x32_bf16 v[20:23], a[40:43], a[4:7], v[20:23]
    s_waitcnt lgkmcnt(8)
    ds_read_b32 v72, v94 offset:3072
    ds_read_b32 v73, v94 offset:3088
    v_mfma_f32_16x16x32_bf16 v[24:27], a[8:11], a[44:47], v[24:27]
    v_mfma_f32_16x16x32_bf16 v[24:27], a[40:43], a[12:15], v[24:27]
    v_mfma_f32_16x16x32_bf16 v[24:27], a[0:3], a[52:55], v[24:27]
    v_mfma_f32_16x16x32_bf16 v[24:27], a[48:51], a[4:7], v[24:27]
    s_waitcnt lgkmcnt(0)
    v_mfma_f32_16x16x32_bf16 v[0:3], a[56:59], a[60:63], v[0:3]
    v_lshlrev_b32 v52, 16, v72
    v_mfma_f32_16x16x32_bf16 v[4:7], a[56:59], a[68:71], v[4:7]
    v_and_b32 v53, 0xffff0000, v72
    v_mfma_f32_16x16x32_bf16 v[4:7], a[64:67], a[60:63], v[4:7]
    v_mul_f32 v52, v92, v52
    v_mfma_f32_16x16x32_bf16 v[8:11], a[56:59], a[76:79], v[8:11]
    v_mul_f32 v53, v92, v53
    v_mfma_f32_16x16x32_bf16 v[8:11], a[64:67], a[68:71], v[8:11]
    v_lshlrev_b32 v54, 16, v73
    v_mfma_f32_16x16x32_bf16 v[8:11], a[72:75], a[60:63], v[8:11]
    v_and_b32 v55, 0xffff0000, v73
    v_mfma_f32_16x16x32_bf16 v[12:15], a[56:59], a[84:87], v[12:15]
    v_mul_f32 v54, v92, v54
    v_mfma_f32_16x16x32_bf16 v[12:15], a[64:67], a[76:79], v[12:15]
    v_mul_f32 v55, v92, v55
    v_add_f32 v28, v28, v0
    v_add_f32 v29, v29, v1
    v_mfma_f32_16x16x32_bf16 v[12:15], a[72:75], a[68:71], v[12:15]
    v_cvt_pk_bf16_f32 v28, v28, v29
    ds_write_b32 v109, v28 offset:0
    v_mfma_f32_16x16x32_bf16 v[12:15], a[80:83], a[60:63], v[12:15]
    v_add_f32 v30, v30, v2
    v_add_f32 v31, v31, v3
    v_mfma_f32_16x16x32_bf16 v[16:19], a[56:59], a[92:95], v[16:19]
    v_cvt_pk_bf16_f32 v30, v30, v31
    ds_write_b32 v109, v30 offset:16
    v_mfma_f32_16x16x32_bf16 v[16:19], a[64:67], a[84:87], v[16:19]
    v_add_f32 v32, v32, v4
    v_add_f32 v33, v33, v5
    v_mfma_f32_16x16x32_bf16 v[16:19], a[72:75], a[76:79], v[16:19]
    v_cvt_pk_bf16_f32 v32, v32, v33
    ds_write_b32 v109, v32 offset:512
    v_mfma_f32_16x16x32_bf16 v[16:19], a[80:83], a[68:71], v[16:19]
    v_add_f32 v34, v34, v6
    v_add_f32 v35, v35, v7
    v_mfma_f32_16x16x32_bf16 v[16:19], a[88:91], a[60:63], v[16:19]
    v_cvt_pk_bf16_f32 v34, v34, v35
    ds_write_b32 v109, v34 offset:528
    v_mfma_f32_16x16x32_bf16 v[20:23], a[56:59], a[100:103], v[20:23]
    v_add_f32 v36, v36, v8
    v_add_f32 v37, v37, v9
    v_mfma_f32_16x16x32_bf16 v[20:23], a[64:67], a[92:95], v[20:23]
    v_cvt_pk_bf16_f32 v36, v36, v37
    ds_write_b32 v109, v36 offset:1024
    v_mfma_f32_16x16x32_bf16 v[20:23], a[72:75], a[84:87], v[20:23]
    v_add_f32 v38, v38, v10
    v_add_f32 v39, v39, v11
    v_mfma_f32_16x16x32_bf16 v[20:23], a[80:83], a[76:79], v[20:23]
    v_cvt_pk_bf16_f32 v38, v38, v39
    ds_write_b32 v109, v38 offset:1040
    v_mfma_f32_16x16x32_bf16 v[20:23], a[88:91], a[68:71], v[20:23]
    v_add_f32 v40, v40, v12
    v_add_f32 v41, v41, v13
    v_mfma_f32_16x16x32_bf16 v[20:23], a[96:99], a[60:63], v[20:23]
    v_cvt_pk_bf16_f32 v40, v40, v41
    ds_write_b32 v109, v40 offset:1536
    v_mfma_f32_16x16x32_bf16 v[24:27], a[56:59], a[108:111], v[24:27]
    v_add_f32 v42, v42, v14
    v_add_f32 v43, v43, v15
    v_mfma_f32_16x16x32_bf16 v[24:27], a[64:67], a[100:103], v[24:27]
    v_cvt_pk_bf16_f32 v42, v42, v43
    ds_write_b32 v109, v42 offset:1552
    v_mfma_f32_16x16x32_bf16 v[24:27], a[72:75], a[92:95], v[24:27]
    v_add_f32 v44, v44, v16
    v_add_f32 v45, v45, v17
    v_mfma_f32_16x16x32_bf16 v[24:27], a[80:83], a[84:87], v[24:27]
    v_cvt_pk_bf16_f32 v44, v44, v45
    ds_write_b32 v109, v44 offset:2048
    v_mfma_f32_16x16x32_bf16 v[24:27], a[88:91], a[76:79], v[24:27]
    v_add_f32 v46, v46, v18
    v_add_f32 v47, v47, v19
    v_mfma_f32_16x16x32_bf16 v[24:27], a[96:99], a[68:71], v[24:27]
    v_cvt_pk_bf16_f32 v46, v46, v47
    ds_write_b32 v109, v46 offset:2064
    v_mfma_f32_16x16x32_bf16 v[24:27], a[104:107], a[60:63], v[24:27]
    v_add_f32 v48, v48, v20
    v_add_f32 v49, v49, v21
    v_cvt_pk_bf16_f32 v48, v48, v49
    ds_write_b32 v109, v48 offset:2560
    v_add_f32 v50, v50, v22
    v_add_f32 v51, v51, v23
    v_cvt_pk_bf16_f32 v50, v50, v51
    ds_write_b32 v109, v50 offset:2576
    s_nop 7
    v_add_f32 v52, v52, v24
    v_add_f32 v53, v53, v25
    v_cvt_pk_bf16_f32 v52, v52, v53
    ds_write_b32 v109, v52 offset:3072
    v_add_f32 v54, v54, v26
    v_add_f32 v55, v55, v27
    v_cvt_pk_bf16_f32 v54, v54, v55
    ds_write_b32 v109, v54 offset:3088
    s_waitcnt lgkmcnt(0)
    ds_read_b128 v[60:63], v110 offset:0
    ds_read_b128 v[64:67], v110 offset:1024
    ds_read_b128 v[68:71], v110 offset:2048
    ds_read_b128 v[72:75], v110 offset:3072
    s_add_u32 s41, s92, 0
    s_waitcnt lgkmcnt(3)
    buffer_store_dwordx4 v[60:63], v93, s[16:19], s41 offen sc1
    s_add_u32 s41, s92, 1048576
    s_waitcnt lgkmcnt(2)
    buffer_store_dwordx4 v[64:67], v93, s[16:19], s41 offen sc1
    s_add_u32 s41, s92, 2097152
    s_waitcnt lgkmcnt(1)
    buffer_store_dwordx4 v[68:71], v93, s[16:19], s41 offen sc1
    s_add_u32 s41, s92, 3145728
    s_waitcnt lgkmcnt(0)
    s_mov_b64 exec, 0xffffffff
    buffer_store_dwordx4 v[72:75], v93, s[16:19], s41 offen sc1
    s_mov_b64 exec, -1
    s_cmp_ge_u32 s89, 2
    s_cbranch_scc1 L_pf2_64
    s_cmp_eq_u32 s89, 1
    s_cbranch_scc1 L_pf1_63
    s_mov_b32 s43, 0x8000
L_flp_66:
    s_waitcnt vmcnt(0)
    v_cmp_gt_u32 s[44:45], s3, v255
    s_nop 1
    s_cmp_eq_u64 s[44:45], 0
    s_cbranch_scc1 L_fok_65
    buffer_load_dword v255, v239, s[16:19], s86 offen sc1
    s_sub_u32 s43, s43, 1
    s_cbranch_scc0 L_flp_66
L_fok_65:
    s_add_u32 s43, s80, 0
    buffer_load_dwordx4 v[116:119], v250, s[16:19], s43 offen offset:0 sc1
    buffer_load_dwordx4 v[148:151], v250, s[16:19], s43 offen offset:1024 sc1
    s_add_u32 s43, s80, 12288
    buffer_load_dwordx4 v[120:123], v250, s[16:19], s43 offen offset:0 sc1
    buffer_load_dwordx4 v[152:155], v250, s[16:19], s43 offen offset:1024 sc1
    s_add_u32 s43, s80, 24576
    buffer_load_dwordx4 v[124:127], v250, s[16:19], s43 offen offset:0 sc1
    buffer_load_dwordx4 v[156:159], v250, s[16:19], s43 offen offset:1024 sc1
    s_add_u32 s43, s80, 36864
    buffer_load_dwordx4 v[128:131], v250, s[16:19], s43 offen offset:0 sc1
    buffer_load_dwordx4 v[160:163], v250, s[16:19], s43 offen offset:1024 sc1
L_pf1_63:
    s_add_u32 s43, s80, 49152
    buffer_load_dwordx4 v[132:135], v250, s[16:19], s43 offen offset:0 sc1
    buffer_load_dwordx4 v[164:167], v250, s[16:19], s43 offen offset:1024 sc1
    s_add_u32 s43, s80, 61440
    buffer_load_dwordx4 v[136:139], v250, s[16:19], s43 offen offset:0 sc1
    buffer_load_dwordx4 v[168:171], v250, s[16:19], s43 offen offset:1024 sc1
    s_add_u32 s43, s80, 73728
    buffer_load_dwordx4 v[140:143], v250, s[16:19], s43 offen offset:0 sc1
    buffer_load_dwordx4 v[172:175], v250, s[16:19], s43 offen offset:1024 sc1
    s_add_u32 s43, s80, 86016
    buffer_load_dwordx4 v[144:147], v250, s[16:19], s43 offen offset:0 sc1
    buffer_load_dwordx4 v[176:179], v250, s[16:19], s43 offen offset:1024 sc1
    s_waitcnt vmcnt(0)
L_pf2_64:
    s_waitcnt vmcnt(4)
    s_branch L_final
L_cv3:
    s_mov_b32 s49, s101
    v_add_u32 v13, 4294934528, v90
    v_add_u32 v15, 4294948736, v91
    v_add_u32 v17, 4294952320, v94
    v_add_u32 v12, 4294901760, v90
    v_add_u32 v14, 18560, v91
    v_add_u32 v16, 22144, v94
    v_add_u32 v90, 4294868992, v90
    v_add_u32 v91, 0, v91
    v_add_u32 v94, 3584, v94
    s_cmp_ge_u32 s49, 288
    s_cselect_b32 s41, 1, 0
    s_mul_i32 s40, s41, 320
    s_sub_u32 s40, s49, s40
    s_ashr_i32 s40, s40, 4
    s_cmp_lt_i32 s40, 0
    s_cselect_b32 s42, 18, 0
    s_add_i32 s40, s40, s42
    s_lshl_b32 s41, s41, 17
    s_lshr_b32 s42, s40, 1
    s_lshl_b32 s42, s42, 14
    s_and_b32 s92, s40, 1
    s_lshl_b32 s92, s92, 10
    s_add_u32 s42, s42, s92
    s_lshl_b32 s92, s40, 14
    s_sub_u32 s92, s92, 155648
    s_mov_b32 s95, 1024
    s_cmp_lt_u32 s40, 16
    s_cselect_b32 s95, 2048, s95
    s_cselect_b32 s92, s42, s92
    v_mad_u32_u24 v93, v99, s95, v98
    s_add_u32 s92, s92, s41
    s_and_b32 s42, s49, 15
    s_lshl_b32 s42, s42, 6
    s_add_u32 s92, s92, s42
    s_add_u32 s92, s92, 50331648
    s_add_u32 s49, s49, 1
    v_lshlrev_b32 v95, 16, v95
    s_cmp_ge_u32 s49, 288
    s_cselect_b32 s41, 1, 0
    s_mul_i32 s40, s41, 320
    s_sub_u32 s40, s49, s40
    s_ashr_i32 s40, s40, 4
    s_cmp_lt_i32 s40, 0
    s_cselect_b32 s42, 18, 0
    s_add_i32 s40, s40, s42
    s_lshl_b32 s41, s41, 17
    s_lshr_b32 s42, s40, 1
    s_lshl_b32 s42, s42, 14
    s_and_b32 s93, s40, 1
    s_lshl_b32 s93, s93, 10
    s_add_u32 s42, s42, s93
    s_lshl_b32 s93, s40, 14
    s_sub_u32 s93, s93, 155648
    s_mov_b32 s95, 1024
    s_cmp_lt_u32 s40, 16
    s_cselect_b32 s95, 2048, s95
    s_cselect_b32 s93, s42, s93
    v_mad_u32_u24 v18, v99, s95, v98
    s_add_u32 s93, s93, s41
    s_and_b32 s42, s49, 15
    s_lshl_b32 s42, s42, 6
    s_add_u32 s93, s93, s42
    s_add_u32 s93, s93, 50331648
    s_add_u32 s49, s49, 1
    v_lshlrev_b32 v96, 16, v96
    s_cmp_ge_u32 s49, 288
    s_cselect_b32 s41, 1, 0
    s_mul_i32 s40, s41, 320
    s_sub_u32 s40, s49, s40
    s_ashr_i32 s40, s40, 4
    s_cmp_lt_i32 s40, 0
    s_cselect_b32 s42, 18, 0
    s_add_i32 s40, s40, s42
    s_lshl_b32 s41, s41, 17
    s_lshr_b32 s42, s40, 1
    s_lshl_b32 s42, s42, 14
    s_and_b32 s94, s40, 1
    s_lshl_b32 s94, s94, 10
    s_add_u32 s42, s42, s94
    s_lshl_b32 s94, s40, 14
    s_sub_u32 s94, s94, 155648
    s_mov_b32 s95, 1024
    s_cmp_lt_u32 s40, 16
    s_cselect_b32 s95, 2048, s95
    s_cselect_b32 s94, s42, s94
    v_mad_u32_u24 v19, v99, s95, v98
    s_add_u32 s94, s94, s41
    s_and_b32 s42, s49, 15
    s_lshl_b32 s42, s42, 6
    s_add_u32 s94, s94, s42
    s_add_u32 s94, s94, 50331648
    s_add_u32 s49, s49, 1
    v_lshlrev_b32 v97, 16, v97
    s_cmp_eq_u32 s89, 4
    s_cbranch_scc1 L_s4_67
    s_waitcnt vmcnt(0)
    v_cmp_gt_u32 s[90:91], s3, v255
    s_nop 1
    s_cmp_eq_u64 s[90:91], 0
    s_cselect_b32 s89, 3, 0
    s_cbranch_scc1 L_rp_68
    buffer_load_dword v255, v239, s[16:19], s86 offen sc1
    s_branch L_rp_68
L_s4_67:
    s_waitcnt vmcnt(6)
L_rp_68:
    s_waitcnt lgkmcnt(0)
    s_barrier
    ds_read_b128 a[0:3], v90 offset:4032
    ds_read_b128 a[4:7], v91 offset:4032
    ds_read_b128 a[8:11], v90 offset:3520
    ds_read_b128 a[12:15], v91 offset:3520
    ds_read_b128 a[16:19], v90 offset:3008
    ds_read_b128 a[20:23], v91 offset:3008
    ds_read_b128 a[24:27], v90 offset:2496
    ds_read_b128 a[28:31], v91 offset:2496
    ds_read_b128 a[32:35], v90 offset:1984
    ds_read_b128 a[36:39], v91 offset:1984
    ds_read_b128 a[40:43], v90 offset:1472
    ds_read_b128 a[44:47], v91 offset:1472
    s_cmp_eq_u32 s89, 3
    s_cbranch_scc0 L_sm_69
    s_add_u32 s43, s80, 0
    buffer_load_dwordx4 v[116:119], v250, s[16:19], s43 offen offset:0 sc1
    buffer_load_dwordx4 v[148:151], v250, s[16:19], s43 offen offset:1024 sc1
L_sm_69:
    s_waitcnt lgkmcnt(8)
    v_mfma_f32_16x16x32_bf16 v[0:3], a[0:3], a[4:7], 0
    ds_read_b128 a[48:51], v90 offset:960
    ds_read_b128 a[52:55], v91 offset:960
    v_mfma_f32_16x16x32_bf16 v[0:3], a[8:11], a[12:15], v[0:3]
    ds_read_b128 a[56:59], v90 offset:448
    ds_read_b128 a[60:63], v91 offset:448
    s_waitcnt lgkmcnt(8)
    v_mfma_f32_16x16x32_bf16 v[0:3], a[16:19], a[20:23], v[0:3]
    ds_read_b128 a[0:3], v90 offset:3968
    ds_read_b128 a[4:7], v91 offset:3968
    v_mfma_f32_16x16x32_bf16 v[0:3], a[24:27], a[28:31], v[0:3]
    ds_read_b128 a[8:11], v90 offset:3456
    ds_read_b128 a[12:15], v91 offset:3456
    s_waitcnt lgkmcnt(8)
    v_mfma_f32_16x16x32_bf16 v[0:3], a[32:35], a[36:39], v[0:3]
    ds_read_b128 a[16:19], v90 offset:2944
    ds_read_b128 a[20:23], v91 offset:2944
    v_mfma_f32_16x16x32_bf16 v[0:3], a[40:43], a[44:47], v[0:3]
    ds_read_b128 a[24:27], v90 offset:2432
    ds_read_b128 a[28:31], v91 offset:2432
    s_waitcnt lgkmcnt(8)
    v_mfma_f32_16x16x32_bf16 v[0:3], a[48:51], a[52:55], v[0:3]
    ds_read_b128 a[32:35], v90 offset:1920
    ds_read_b128 a[36:39], v91 offset:1920
    v_mfma_f32_16x16x32_bf16 v[0:3], a[56:59], a[60:63], v[0:3]
    ds_read_b128 a[40:43], v90 offset:1408
    ds_read_b128 a[44:47], v91 offset:1408
    s_waitcnt lgkmcnt(8)
    v_mfma_f32_16x16x32_bf16 v[0:3], a[0:3], a[4:7], v[0:3]
    ds_read_b128 a[48:51], v90 offset:896
    ds_read_b128 a[52:55], v91 offset:896
    v_mfma_f32_16x16x32_bf16 v[0:3], a[8:11], a[12:15], v[0:3]
    ds_read_b128 a[56:59], v90 offset:384
    ds_read_b128 a[60:63], v91 offset:384
    s_waitcnt lgkmcnt(8)
    v_mfma_f32_16x16x32_bf16 v[0:3], a[16:19], a[20:23], v[0:3]
    ds_read_b128 a[0:3], v90 offset:3904
    ds_read_b128 a[4:7], v91 offset:3904
    v_mfma_f32_16x16x32_bf16 v[0:3], a[24:27], a[28:31], v[0:3]
    ds_read_b128 a[8:11], v90 offset:3392
    ds_read_b128 a[12:15], v91 offset:3392
    s_waitcnt lgkmcnt(8)
    v_mfma_f32_16x16x32_bf16 v[0:3], a[32:35], a[36:39], v[0:3]
    ds_read_b128 a[16:19], v90 offset:2880
    ds_read_b128 a[20:23], v91 offset:2880
    v_mfma_f32_16x16x32_bf16 v[0:3], a[40:43], a[44:47], v[0:3]
    ds_read_b128 a[24:27], v90 offset:2368
    ds_read_b128 a[28:31], v91 offset:2368
    s_waitcnt lgkmcnt(8)
    v_mfma_f32_16x16x32_bf16 v[0:3], a[48:51], a[52:55], v[0:3]
    ds_read_b128 a[32:35], v90 offset:1856
    ds_read_b128 a[36:39], v91 offset:1856
    v_mfma_f32_16x16x32_bf16 v[0:3], a[56:59], a[60:63], v[0:3]
    ds_read_b128 a[40:43], v90 offset:1344
    ds_read_b128 a[44:47], v91 offset:1344
    s_waitcnt lgkmcnt(8)
    v_mfma_f32_16x16x32_bf16 v[0:3], a[0:3], a[4:7], v[0:3]
    ds_read_b128 a[48:51], v90 offset:832
    ds_read_b128 a[52:55], v91 offset:832
    v_mfma_f32_16x16x32_bf16 v[0:3], a[8:11], a[12:15], v[0:3]
    ds_read_b128 a[56:59], v90 offset:320
    ds_read_b128 a[60:63], v91 offset:320
    s_waitcnt lgkmcnt(8)
    v_mfma_f32_16x16x32_bf16 v[0:3], a[16:19], a[20:23], v[0:3]
    ds_read_b128 a[0:3], v90 offset:3840
    ds_read_b128 a[4:7], v91 offset:3840
    v_mfma_f32_16x16x32_bf16 v[0:3], a[24:27], a[28:31], v[0:3]
    ds_read_b128 a[8:11], v90 offset:3328
    ds_read_b128 a[12:15], v91 offset:3328
    s_waitcnt lgkmcnt(8)
    v_mfma_f32_16x16x32_bf16 v[0:3], a[32:35], a[36:39], v[0:3]
    ds_read_b128 a[16:19], v90 offset:2816
    ds_read_b128 a[20:23], v91 offset:2816
    v_mfma_f32_16x16x32_bf16 v[0:3], a[40:43], a[44:47], v[0:3]
    ds_read_b128 a[24:27], v90 offset:2304
    ds_read_b128 a[28:31], v91 offset:2304
    s_waitcnt lgkmcnt(8)
    v_mfma_f32_16x16x32_bf16 v[0:3], a[48:51], a[52:55], v[0:3]
    ds_read_b128 a[32:35], v90 offset:1792
    ds_read_b128 a[36:39], v91 offset:1792
    v_mfma_f32_16x16x32_bf16 v[0:3], a[56:59], a[60:63], v[0:3]
    ds_read_b128 a[40:43], v90 offset:1280
    ds_read_b128 a[44:47], v91 offset:1280
    s_cmp_eq_u32 s89, 3
    s_cbranch_scc0 L_sm_70
    s_add_u32 s43, s80, 12288
    buffer_load_dwordx4 v[120:123], v250, s[16:19], s43 offen offset:0 sc1
    buffer_load_dwordx4 v[152:155], v250, s[16:19], s43 offen offset:1024 sc1
    s_add_u32 s43, s80, 24576
    buffer_load_dwordx4 v[124:127], v250, s[16:19], s43 offen offset:0 sc1
    buffer_load_dwordx4 v[156:159], v250, s[16:19], s43 offen offset:1024 sc1
L_sm_70:
    s_waitcnt lgkmcnt(8)
    v_mfma_f32_16x16x32_bf16 v[0:3], a[0:3], a[4:7], v[0:3]
    ds_read_b128 a[48:51], v90 offset:768
    ds_read_b128 a[52:55], v91 offset:768
    v_mfma_f32_16x16x32_bf16 v[0:3], a[8:11], a[12:15], v[0:3]
    ds_read_b128 a[56:59], v90 offset:256
    ds_read_b128 a[60:63], v91 offset:256
    s_waitcnt lgkmcnt(8)
    v_mfma_f32_16x16x32_bf16 v[0:3], a[16:19], a[20:23], v[0:3]
    ds_read_b128 a[0:3], v90 offset:3776
    ds_read_b128 a[4:7], v91 offset:3776
    v_mfma_f32_16x16x32_bf16 v[0:3], a[24:27], a[28:31], v[0:3]
    ds_read_b128 a[8:11], v90 offset:3264
    ds_read_b128 a[12:15], v91 offset:3264
    s_waitcnt lgkmcnt(8)
    v_mfma_f32_16x16x32_bf16 v[0:3], a[32:35], a[36:39], v[0:3]
    ds_read_b128 a[16:19], v90 offset:2752
    ds_read_b128 a[20:23], v91 offset:2752
    v_mfma_f32_16x16x32_bf16 v[0:3], a[40:43], a[44:47], v[0:3]
    ds_read_b128 a[24:27], v90 offset:2240
    ds_read_b128 a[28:31], v91 offset:2240
    s_waitcnt lgkmcnt(8)
    v_mfma_f32_16x16x32_bf16 v[0:3], a[48:51], a[52:55], v[0:3]
    ds_read_b128 a[32:35], v90 offset:1728
    ds_read_b128 a[36:39], v91 offset:1728
    v_mfma_f32_16x16x32_bf16 v[0:3], a[56:59], a[60:63], v[0:3]
    ds_read_b128 a[40:43], v90 offset:1216
    ds_read_b128 a[44:47], v91 offset:1216
    s_waitcnt lgkmcnt(8)
    v_mfma_f32_16x16x32_bf16 v[0:3], a[0:3], a[4:7], v[0:3]
    ds_read_b128 a[48:51], v90 offset:704
    ds_read_b128 a[52:55], v91 offset:704
    v_mfma_f32_16x16x32_bf16 v[0:3], a[8:11], a[12:15], v[0:3]
    ds_read_b128 a[56:59], v90 offset:192
    ds_read_b128 a[60:63], v91 offset:192
    s_waitcnt lgkmcnt(8)
    v_mfma_f32_16x16x32_bf16 v[0:3], a[16:19], a[20:23], v[0:3]
    ds_read_b128 a[0:3], v90 offset:3712
    ds_read_b128 a[4:7], v91 offset:3712
    v_mfma_f32_16x16x32_bf16 v[0:3], a[24:27], a[28:31], v[0:3]
    ds_read_b128 a[8:11], v90 offset:3200
    ds_read_b128 a[12:15], v91 offset:3200
    s_waitcnt lgkmcnt(8)
    v_mfma_f32_16x16x32_bf16 v[0:3], a[32:35], a[36:39], v[0:3]
    ds_read_b128 a[16:19], v90 offset:2688
    ds_read_b128 a[20:23], v91 offset:2688
    v_mfma_f32_16x16x32_bf16 v[0:3], a[40:43], a[44:47], v[0:3]
    ds_read_b128 a[24:27], v90 offset:2176
    ds_read_b128 a[28:31], v91 offset:2176
    s_waitcnt lgkmcnt(8)
    v_mfma_f32_16x16x32_bf16 v[0:3], a[48:51], a[52:55], v[0:3]
    ds_read_b128 a[32:35], v90 offset:1664
    ds_read_b128 a[36:39], v91 offset:1664
    v_mfma_f32_16x16x32_bf16 v[0:3], a[56:59], a[60:63], v[0:3]
    ds_read_b128 a[40:43], v90 offset:1152
    ds_read_b128 a[44:47], v91 offset:1152
    s_waitcnt lgkmcnt(8)
    v_mfma_f32_16x16x32_bf16 v[0:3], a[0:3], a[4:7], v[0:3]
    ds_read_b128 a[48:51], v90 offset:640
    ds_read_b128 a[52:55], v91 offset:640
    v_mfma_f32_16x16x32_bf16 v[0:3], a[8:11], a[12:15], v[0:3]
    ds_read_b128 a[56:59], v90 offset:128
    ds_read_b128 a[60:63], v91 offset:128
    s_waitcnt lgkmcnt(8)
    v_mfma_f32_16x16x32_bf16 v[0:3], a[16:19], a[20:23], v[0:3]
    ds_read_b128 a[0:3], v90 offset:3648
    ds_read_b128 a[4:7], v91 offset:3648
    v_mfma_f32_16x16x32_bf16 v[0:3], a[24:27], a[28:31], v[0:3]
    ds_read_b128 a[8:11], v90 offset:3136
    ds_read_b128 a[12:15], v91 offset:3136
    s_waitcnt lgkmcnt(8)
    v_mfma_f32_16x16x32_bf16 v[0:3], a[32:35], a[36:39], v[0:3]
    ds_read_b128 a[16:19], v90 offset:2624
    ds_read_b128 a[20:23], v91 offset:2624
    v_mfma_f32_16x16x32_bf16 v[0:3], a[40:43], a[44:47], v[0:3]
    ds_read_b128 a[24:27], v90 offset:2112
    ds_read_b128 a[28:31], v91 offset:2112
    s_waitcnt lgkmcnt(8)
    v_mfma_f32_16x16x32_bf16 v[0:3], a[48:51], a[52:55], v[0:3]
    ds_read_b128 a[32:35], v90 offset:1600
    ds_read_b128 a[36:39], v91 offset:1600
    v_mfma_f32_16x16x32_bf16 v[0:3], a[56:59], a[60:63], v[0:3]
    ds_read_b128 a[40:43], v90 offset:1088
    ds_read_b128 a[44:47], v91 offset:1088
    s_cmp_eq_u32 s89, 3
    s_cbranch_scc0 L_sm_71
    s_add_u32 s43, s80, 36864
    buffer_load_dwordx4 v[128:131], v250, s[16:19], s43 offen offset:0 sc1
    buffer_load_dwordx4 v[160:163], v250, s[16:19], s43 offen offset:1024 sc1
L_sm_71:
    s_cmp_eq_u32 s89, 0
    s_cbranch_scc0 L_trs_72
    s_waitcnt vmcnt(0)
    v_cmp_gt_u32 s[90:91], s3, v255
    s_nop 1
    s_cmp_eq_u64 s[90:91], 0
    s_cbranch_scc0 L_tra_73
    s_add_u32 s43, s80, 0
    buffer_load_dwordx4 v[116:119], v250, s[16:19], s43 offen offset:0 sc1
    buffer_load_dwordx4 v[148:151], v250, s[16:19], s43 offen offset:1024 sc1
    s_add_u32 s43, s80, 12288
    buffer_load_dwordx4 v[120:123], v250, s[16:19], s43 offen offset:0 sc1
    buffer_load_dwordx4 v[152:155], v250, s[16:19], s43 offen offset:1024 sc1
    s_add_u32 s43, s80, 24576
    buffer_load_dwordx4 v[124:127], v250, s[16:19], s43 offen offset:0 sc1
    buffer_load_dwordx4 v[156:159], v250, s[16:19], s43 offen offset:1024 sc1
    s_add_u32 s43, s80, 36864
    buffer_load_dwordx4 v[128:131], v250, s[16:19], s43 offen offset:0 sc1
    buffer_load_dwordx4 v[160:163], v250, s[16:19], s43 offen offset:1024 sc1
    s_add_u32 s89, s89, 1
    s_branch L_trs_72
L_tra_73:
    buffer_load_dword v255, v239, s[16:19], s86 offen sc1
L_trs_72:
    s_waitcnt lgkmcnt(8)
    v_mfma_f32_16x16x32_bf16 v[0:3], a[0:3], a[4:7], v[0:3]
    ds_read_b128 a[48:51], v90 offset:576
    ds_read_b128 a[52:55], v91 offset:576
    v_mfma_f32_16x16x32_bf16 v[0:3], a[8:11], a[12:15], v[0:3]
    ds_read_b128 a[56:59], v90 offset:64
    ds_read_b128 a[60:63], v91 offset:64
    s_waitcnt lgkmcnt(8)
    v_mfma_f32_16x16x32_bf16 v[0:3], a[16:19], a[20:23], v[0:3]
    ds_read_b128 a[0:3], v90 offset:3584
    ds_read_b128 a[4:7], v91 offset:3584
    v_mfma_f32_16x16x32_bf16 v[0:3], a[24:27], a[28:31], v[0:3]
    ds_read_b128 a[8:11], v90 offset:3072
    ds_read_b128 a[12:15], v91 offset:3072
    s_waitcnt lgkmcnt(8)
    v_mfma_f32_16x16x32_bf16 v[0:3], a[32:35], a[36:39], v[0:3]
    ds_read_b128 a[16:19], v90 offset:2560
    ds_read_b128 a[20:23], v91 offset:2560
    v_mfma_f32_16x16x32_bf16 v[0:3], a[40:43], a[44:47], v[0:3]
    ds_read_b128 a[24:27], v90 offset:2048
    ds_read_b128 a[28:31], v91 offset:2048
    s_waitcnt lgkmcnt(8)
    v_mfma_f32_16x16x32_bf16 v[0:3], a[48:51], a[52:55], v[0:3]
    ds_read_b128 a[32:35], v90 offset:1536
    ds_read_b128 a[36:39], v91 offset:1536
    v_mfma_f32_16x16x32_bf16 v[0:3], a[56:59], a[60:63], v[0:3]
    ds_read_b128 a[40:43], v90 offset:1024
    ds_read_b128 a[44:47], v91 offset:1024
    s_waitcnt lgkmcnt(8)
    v_mfma_f32_16x16x32_bf16 v[0:3], a[0:3], a[4:7], v[0:3]
    ds_read_b128 a[48:51], v90 offset:512
    ds_read_b128 a[52:55], v91 offset:512
    v_mfma_f32_16x16x32_bf16 v[0:3], a[8:11], a[12:15], v[0:3]
    ds_read_b128 a[56:59], v90 offset:0
    ds_read_b128 a[60:63], v91 offset:0
    s_waitcnt lgkmcnt(8)
    v_mfma_f32_16x16x32_bf16 v[0:3], a[16:19], a[20:23], v[0:3]
    ds_read_b128 a[0:3], v12 offset:4032
    ds_read_b128 a[4:7], v14 offset:4032
    v_mfma_f32_16x16x32_bf16 v[0:3], a[24:27], a[28:31], v[0:3]
    ds_read_b128 a[8:11], v12 offset:3520
    ds_read_b128 a[12:15], v14 offset:3520
    s_waitcnt lgkmcnt(8)
    v_mfma_f32_16x16x32_bf16 v[0:3], a[32:35], a[36:39], v[0:3]
    ds_read_b128 a[16:19], v12 offset:3008
    ds_read_b128 a[20:23], v14 offset:3008
    v_mfma_f32_16x16x32_bf16 v[0:3], a[40:43], a[44:47], v[0:3]
    ds_read_b128 a[24:27], v12 offset:2496
    ds_read_b128 a[28:31], v14 offset:2496
    s_waitcnt lgkmcnt(8)
    v_mfma_f32_16x16x32_bf16 v[0:3], a[48:51], a[52:55], v[0:3]
    ds_read_b128 a[32:35], v12 offset:1984
    ds_read_b128 a[36:39], v14 offset:1984
    v_mfma_f32_16x16x32_bf16 v[0:3], a[56:59], a[60:63], v[0:3]
    ds_read_b128 a[40:43], v12 offset:1472
    ds_read_b128 a[44:47], v14 offset:1472
    s_waitcnt lgkmcnt(8)
    v_mfma_f32_16x16x32_bf16 v[4:7], a[0:3], a[4:7], 0
    ds_read_b128 a[48:51], v12 offset:960
    ds_read_b128 a[52:55], v14 offset:960
    v_mfma_f32_16x16x32_bf16 v[4:7], a[8:11], a[12:15], v[4:7]
    ds_read_b128 a[56:59], v12 offset:448
    ds_read_b128 a[60:63], v14 offset:448
    s_waitcnt lgkmcnt(8)
    v_mfma_f32_16x16x32_bf16 v[4:7], a[16:19], a[20:23], v[4:7]
    ds_read_b128 a[0:3], v12 offset:3968
    ds_read_b128 a[4:7], v14 offset:3968
    v_mfma_f32_16x16x32_bf16 v[4:7], a[24:27], a[28:31], v[4:7]
    ds_read_b128 a[8:11], v12 offset:3456
    ds_read_b128 a[12:15], v14 offset:3456
    s_waitcnt lgkmcnt(8)
    v_mfma_f32_16x16x32_bf16 v[4:7], a[32:35], a[36:39], v[4:7]
    ds_read_b128 a[16:19], v12 offset:2944
    ds_read_b128 a[20:23], v14 offset:2944
    v_mfma_f32_16x16x32_bf16 v[4:7], a[40:43], a[44:47], v[4:7]
    ds_read_b128 a[24:27], v12 offset:2432
    ds_read_b128 a[28:31], v14 offset:2432
    s_waitcnt lgkmcnt(8)
    v_mfma_f32_16x16x32_bf16 v[4:7], a[48:51], a[52:55], v[4:7]
    ds_read_b128 a[32:35], v12 offset:1920
    ds_read_b128 a[36:39], v14 offset:1920
    v_mfma_f32_16x16x32_bf16 v[4:7], a[56:59], a[60:63], v[4:7]
    ds_read_b128 a[40:43], v12 offset:1408
    ds_read_b128 a[44:47], v14 offset:1408
    s_cmp_eq_u32 s89, 3
    s_cbranch_scc0 L_sm_74
    s_add_u32 s43, s80, 49152
    buffer_load_dwordx4 v[132:135], v250, s[16:19], s43 offen offset:0 sc1
    buffer_load_dwordx4 v[164:167], v250, s[16:19], s43 offen offset:1024 sc1
    s_add_u32 s43, s80, 61440
    buffer_load_dwordx4 v[136:139], v250, s[16:19], s43 offen offset:0 sc1
    buffer_load_dwordx4 v[168:171], v250, s[16:19], s43 offen offset:1024 sc1
L_sm_74:
    s_waitcnt lgkmcnt(8)
    v_mfma_f32_16x16x32_bf16 v[4:7], a[0:3], a[4:7], v[4:7]
    ds_read_b128 a[48:51], v12 offset:896
    ds_read_b128 a[52:55], v14 offset:896
    v_mfma_f32_16x16x32_bf16 v[4:7], a[8:11], a[12:15], v[4:7]
    ds_read_b128 a[56:59], v12 offset:384
    ds_read_b128 a[60:63], v14 offset:384
    s_waitcnt lgkmcnt(8)
    v_mfma_f32_16x16x32_bf16 v[4:7], a[16:19], a[20:23], v[4:7]
    ds_read_b128 a[0:3], v12 offset:3904
    ds_read_b128 a[4:7], v14 offset:3904
    v_mfma_f32_16x16x32_bf16 v[4:7], a[24:27], a[28:31], v[4:7]
    ds_read_b128 a[8:11], v12 offset:3392
    ds_read_b128 a[12:15], v14 offset:3392
    s_waitcnt lgkmcnt(8)
    v_mfma_f32_16x16x32_bf16 v[4:7], a[32:35], a[36:39], v[4:7]
    ds_read_b128 a[16:19], v12 offset:2880
    ds_read_b128 a[20:23], v14 offset:2880
    v_mfma_f32_16x16x32_bf16 v[4:7], a[40:43], a[44:47], v[4:7]
    ds_read_b128 a[24:27], v12 offset:2368
    ds_read_b128 a[28:31], v14 offset:2368
    s_waitcnt lgkmcnt(8)
    v_mfma_f32_16x16x32_bf16 v[4:7], a[48:51], a[52:55], v[4:7]
    ds_read_b128 a[32:35], v12 offset:1856
    ds_read_b128 a[36:39], v14 offset:1856
    v_mfma_f32_16x16x32_bf16 v[4:7], a[56:59], a[60:63], v[4:7]
    ds_read_b128 a[40:43], v12 offset:1344
    ds_read_b128 a[44:47], v14 offset:1344
    s_waitcnt lgkmcnt(8)
    v_mfma_f32_16x16x32_bf16 v[4:7], a[0:3], a[4:7], v[4:7]
    ds_read_b128 a[48:51], v12 offset:832
    ds_read_b128 a[52:55], v14 offset:832
    v_mfma_f32_16x16x32_bf16 v[4:7], a[8:11], a[12:15], v[4:7]
    ds_read_b128 a[56:59], v12 offset:320
    ds_read_b128 a[60:63], v14 offset:320
    s_waitcnt lgkmcnt(8)
    v_mfma_f32_16x16x32_bf16 v[4:7], a[16:19], a[20:23], v[4:7]
    ds_read_b128 a[0:3], v12 offset:3840
    ds_read_b128 a[4:7], v14 offset:3840
    v_mfma_f32_16x16x32_bf16 v[4:7], a[24:27], a[28:31], v[4:7]
    ds_read_b128 a[8:11], v12 offset:3328
    ds_read_b128 a[12:15], v14 offset:3328
    s_waitcnt lgkmcnt(8)
    v_mfma_f32_16x16x32_bf16 v[4:7], a[32:35], a[36:39], v[4:7]
    ds_read_b128 a[16:19], v12 offset:2816
    ds_read_b128 a[20:23], v14 offset:2816
    v_mfma_f32_16x16x32_bf16 v[4:7], a[40:43], a[44:47], v[4:7]
    ds_read_b128 a[24:27], v12 offset:2304
    ds_read_b128 a[28:31], v14 offset:2304
    s_waitcnt lgkmcnt(8)
    v_mfma_f32_16x16x32_bf16 v[4:7], a[48:51], a[52:55], v[4:7]
    ds_read_b128 a[32:35], v12 offset:1792
    ds_read_b128 a[36:39], v14 offset:1792
    v_mfma_f32_16x16x32_bf16 v[4:7], a[56:59], a[60:63], v[4:7]
    ds_read_b128 a[40:43], v12 offset:1280
    ds_read_b128 a[44:47], v14 offset:1280
    s_waitcnt lgkmcnt(8)
    v_mfma_f32_16x16x32_bf16 v[4:7], a[0:3], a[4:7], v[4:7]
    ds_read_b128 a[48:51], v12 offset:768
    ds_read_b128 a[52:55], v14 offset:768
    v_mfma_f32_16x16x32_bf16 v[4:7], a[8:11], a[12:15], v[4:7]
    ds_read_b128 a[56:59], v12 offset:256
    ds_read_b128 a[60:63], v14 offset:256
    s_waitcnt lgkmcnt(8)
    v_mfma_f32_16x16x32_bf16 v[4:7], a[16:19], a[20:23], v[4:7]
    ds_read_b128 a[0:3], v12 offset:3776
    ds_read_b128 a[4:7], v14 offset:3776
    v_mfma_f32_16x16x32_bf16 v[4:7], a[24:27], a[28:31], v[4:7]
    ds_read_b128 a[8:11], v12 offset:3264
    ds_read_b128 a[12:15], v14 offset:3264
    s_waitcnt lgkmcnt(8)
    v_mfma_f32_16x16x32_bf16 v[4:7], a[32:35], a[36:39], v[4:7]
    ds_read_b128 a[16:19], v12 offset:2752
    ds_read_b128 a[20:23], v14 offset:2752
    v_mfma_f32_16x16x32_bf16 v[4:7], a[40:43], a[44:47], v[4:7]
    ds_read_b128 a[24:27], v12 offset:2240
    ds_read_b128 a[28:31], v14 offset:2240
    s_waitcnt lgkmcnt(8)
    v_mfma_f32_16x16x32_bf16 v[4:7], a[48:51], a[52:55], v[4:7]
    ds_read_b128 a[32:35], v12 offset:1728
    ds_read_b128 a[36:39], v14 offset:1728
    v_mfma_f32_16x16x32_bf16 v[4:7], a[56:59], a[60:63], v[4:7]
    ds_read_b128 a[40:43], v12 offset:1216
    ds_read_b128 a[44:47], v14 offset:1216
    s_cmp_eq_u32 s89, 3
    s_cbranch_scc0 L_sm_75
    s_add_u32 s43, s80, 73728
    buffer_load_dwordx4 v[140:143], v250, s[16:19], s43 offen offset:0 sc1
    buffer_load_dwordx4 v[172:175], v250, s[16:19], s43 offen offset:1024 sc1
    s_add_u32 s43, s80, 86016
    buffer_load_dwordx4 v[144:147], v250, s[16:19], s43 offen offset:0 sc1
    buffer_load_dwordx4 v[176:179], v250, s[16:19], s43 offen offset:1024 sc1
L_sm_75:
    s_cmp_eq_u32 s89, 1
    s_cbranch_scc0 L_trs_76
    s_add_u32 s43, s80, 49152
    buffer_load_dwordx4 v[132:135], v250, s[16:19], s43 offen offset:0 sc1
    buffer_load_dwordx4 v[164:167], v250, s[16:19], s43 offen offset:1024 sc1
    s_add_u32 s43, s80, 61440
    buffer_load_dwordx4 v[136:139], v250, s[16:19], s43 offen offset:0 sc1
    buffer_load_dwordx4 v[168:171], v250, s[16:19], s43 offen offset:1024 sc1
    s_add_u32 s43, s80, 73728
    buffer_load_dwordx4 v[140:143], v250, s[16:19], s43 offen offset:0 sc1
    buffer_load_dwordx4 v[172:175], v250, s[16:19], s43 offen offset:1024 sc1
    s_add_u32 s43, s80, 86016
    buffer_load_dwordx4 v[144:147], v250, s[16:19], s43 offen offset:0 sc1
    buffer_load_dwordx4 v[176:179], v250, s[16:19], s43 offen offset:1024 sc1
    s_add_u32 s89, s89, 1
L_trs_76:
    s_cmp_eq_u32 s89, 0
    s_cbranch_scc0 L_trs_78
    s_waitcnt vmcnt(0)
    v_cmp_gt_u32 s[90:91], s3, v255
    s_nop 1
    s_cmp_eq_u64 s[90:91], 0
    s_cbranch_scc0 L_tra_79
    s_add_u32 s43, s80, 0
    buffer_load_dwordx4 v[116:119], v250, s[16:19], s43 offen offset:0 sc1
    buffer_load_dwordx4 v[148:151], v250, s[16:19], s43 offen offset:1024 sc1
    s_add_u32 s43, s80, 12288
    buffer_load_dwordx4 v[120:123], v250, s[16:19], s43 offen offset:0 sc1
    buffer_load_dwordx4 v[152:155], v250, s[16:19], s43 offen offset:1024 sc1
    s_add_u32 s43, s80, 24576
    buffer_load_dwordx4 v[124:127], v250, s[16:19], s43 offen offset:0 sc1
    buffer_load_dwordx4 v[156:159], v250, s[16:19], s43 offen offset:1024 sc1
    s_add_u32 s43, s80, 36864
    buffer_load_dwordx4 v[128:131], v250, s[16:19], s43 offen offset:0 sc1
    buffer_load_dwordx4 v[160:163], v250, s[16:19], s43 offen offset:1024 sc1
    s_add_u32 s89, s89, 1
    s_branch L_trs_78
L_tra_79:
    buffer_load_dword v255, v239, s[16:19], s86 offen sc1
L_trs_78:
    s_waitcnt lgkmcnt(8)
    v_mfma_f32_16x16x32_bf16 v[4:7], a[0:3], a[4:7], v[4:7]
    ds_read_b128 a[48:51], v12 offset:704
    ds_read_b128 a[52:55], v14 offset:704
    v_mfma_f32_16x16x32_bf16 v[4:7], a[8:11], a[12:15], v[4:7]
    ds_read_b128 a[56:59], v12 offset:192
    ds_read_b128 a[60:63], v14 offset:192
    s_waitcnt lgkmcnt(8)
    v_mfma_f32_16x16x32_bf16 v[4:7], a[16:19], a[20:23], v[4:7]
    ds_read_b128 a[0:3], v12 offset:3712
    ds_read_b128 a[4:7], v14 offset:3712
    v_mfma_f32_16x16x32_bf16 v[4:7], a[24:27], a[28:31], v[4:7]
    ds_read_b128 a[8:11], v12 offset:3200
    ds_read_b128 a[12:15], v14 offset:3200
    s_waitcnt lgkmcnt(8)
    v_mfma_f32_16x16x32_bf16 v[4:7], a[32:35], a[36:39], v[4:7]
    ds_read_b128 a[16:19], v12 offset:2688
    ds_read_b128 a[20:23], v14 offset:2688
    v_mfma_f32_16x16x32_bf16 v[4:7], a[40:43], a[44:47], v[4:7]
    ds_read_b128 a[24:27], v12 offset:2176
    ds_read_b128 a[28:31], v14 offset:2176
    s_waitcnt lgkmcnt(8)
    v_mfma_f32_16x16x32_bf16 v[4:7], a[48:51], a[52:55], v[4:7]
    ds_read_b128 a[32:35], v12 offset:1664
    ds_read_b128 a[36:39], v14 offset:1664
    v_mfma_f32_16x16x32_bf16 v[4:7], a[56:59], a[60:63], v[4:7]
    ds_read_b128 a[40:43], v12 offset:1152
    ds_read_b128 a[44:47], v14 offset:1152
    s_waitcnt lgkmcnt(8)
    v_mfma_f32_16x16x32_bf16 v[4:7], a[0:3], a[4:7], v[4:7]
    ds_read_b128 a[48:51], v12 offset:640
    ds_read_b128 a[52:55], v14 offset:640
    v_mfma_f32_16x16x32_bf16 v[4:7], a[8:11], a[12:15], v[4:7]
    ds_read_b128 a[56:59], v12 offset:128
    ds_read_b128 a[60:63], v14 offset:128
    s_waitcnt lgkmcnt(8)
    v_mfma_f32_16x16x32_bf16 v[4:7], a[16:19], a[20:23], v[4:7]
    ds_read_b128 a[0:3], v12 offset:3648
    ds_read_b128 a[4:7], v14 offset:3648
    v_mfma_f32_16x16x32_bf16 v[4:7], a[24:27], a[28:31], v[4:7]
    ds_read_b128 a[8:11], v12 offset:3136
    ds_read_b128 a[12:15], v14 offset:3136
    s_waitcnt lgkmcnt(8)
    v_mfma_f32_16x16x32_bf16 v[4:7], a[32:35], a[36:39], v[4:7]
    ds_read_b128 a[16:19], v12 offset:2624
    ds_read_b128 a[20:23], v14 offset:2624
    v_mfma_f32_16x16x32_bf16 v[4:7], a[40:43], a[44:47], v[4:7]
    ds_read_b128 a[24:27], v12 offset:2112
    ds_read_b128 a[28:31], v14 offset:2112
    s_waitcnt lgkmcnt(8)
    v_mfma_f32_16x16x32_bf16 v[4:7], a[48:51], a[52:55], v[4:7]
    ds_read_b128 a[32:35], v12 offset:1600
    ds_read_b128 a[36:39], v14 offset:1600
    v_mfma_f32_16x16x32_bf16 v[4:7], a[56:59], a[60:63], v[4:7]
    ds_read_b128 a[40:43], v12 offset:1088
    ds_read_b128 a[44:47], v14 offset:1088
    s_waitcnt lgkmcnt(8)
    v_mfma_f32_16x16x32_bf16 v[4:7], a[0:3], a[4:7], v[4:7]
    ds_read_b128 a[48:51], v12 offset:576
    ds_read_b128 a[52:55], v14 offset:576
    v_mfma_f32_16x16x32_bf16 v[4:7], a[8:11], a[12:15], v[4:7]
    ds_read_b128 a[56:59], v12 offset:64
    ds_read_b128 a[60:63], v14 offset:64
    s_waitcnt lgkmcnt(8)
    v_mfma_f32_16x16x32_bf16 v[4:7], a[16:19], a[20:23], v[4:7]
    ds_read_b128 a[0:3], v12 offset:3584
    ds_read_b128 a[4:7], v14 offset:3584
    v_mfma_f32_16x16x32_bf16 v[4:7], a[24:27], a[28:31], v[4:7]
    ds_read_b128 a[8:11], v12 offset:3072
    ds_read_b128 a[12:15], v14 offset:3072
    s_waitcnt lgkmcnt(8)
    v_mfma_f32_16x16x32_bf16 v[4:7], a[32:35], a[36:39], v[4:7]
    ds_read_b128 a[16:19], v12 offset:2560
    ds_read_b128 a[20:23], v14 offset:2560
    v_mfma_f32_16x16x32_bf16 v[4:7], a[40:43], a[44:47], v[4:7]
    ds_read_b128 a[24:27], v12 offset:2048
    ds_read_b128 a[28:31], v14 offset:2048
    s_waitcnt lgkmcnt(8)
    v_mfma_f32_16x16x32_bf16 v[4:7], a[48:51], a[52:55], v[4:7]
    ds_read_b128 a[32:35], v12 offset:1536
    ds_read_b128 a[36:39], v14 offset:1536
    v_mfma_f32_16x16x32_bf16 v[4:7], a[56:59], a[60:63], v[4:7]
    ds_read_b128 a[40:43], v12 offset:1024
    ds_read_b128 a[44:47], v14 offset:1024
    s_waitcnt lgkmcnt(8)
    v_mfma_f32_16x16x32_bf16 v[4:7], a[0:3], a[4:7], v[4:7]
    ds_read_b128 a[48:51], v12 offset:512
    ds_read_b128 a[52:55], v14 offset:512
    v_mfma_f32_16x16x32_bf16 v[4:7], a[8:11], a[12:15], v[4:7]
    ds_read_b128 a[56:59], v12 offset:0
    ds_read_b128 a[60:63], v14 offset:0
    s_waitcnt lgkmcnt(8)
    v_mfma_f32_16x16x32_bf16 v[4:7], a[16:19], a[20:23], v[4:7]
    ds_read_b128 a[0:3], v13 offset:4032
    ds_read_b128 a[4:7], v15 offset:4032
    v_mfma_f32_16x16x32_bf16 v[4:7], a[24:27], a[28:31], v[4:7]
    ds_read_b128 a[8:11], v13 offset:3520
    ds_read_b128 a[12:15], v15 offset:3520
    s_waitcnt lgkmcnt(8)
    v_mfma_f32_16x16x32_bf16 v[4:7], a[32:35], a[36:39], v[4:7]
    ds_read_b128 a[16:19], v13 offset:3008
    ds_read_b128 a[20:23], v15 offset:3008
    v_mfma_f32_16x16x32_bf16 v[4:7], a[40:43], a[44:47], v[4:7]
    ds_read_b128 a[24:27], v13 offset:2496
    ds_read_b128 a[28:31], v15 offset:2496
    s_waitcnt lgkmcnt(8)
    v_mfma_f32_16x16x32_bf16 v[4:7], a[48:51], a[52:55], v[4:7]
    ds_read_b128 a[32:35], v13 offset:1984
    ds_read_b128 a[36:39], v15 offset:1984
    v_mfma_f32_16x16x32_bf16 v[4:7], a[56:59], a[60:63], v[4:7]
    ds_read_b128 a[40:43], v13 offset:1472
    ds_read_b128 a[44:47], v15 offset:1472
    s_waitcnt lgkmcnt(8)
    v_mfma_f32_16x16x32_bf16 v[8:11], a[0:3], a[4:7], 0
    ds_read_b128 a[48:51], v13 offset:960
    ds_read_b128 a[52:55], v15 offset:960
    v_mfma_f32_16x16x32_bf16 v[8:11], a[8:11], a[12:15], v[8:11]
    ds_read_b128 a[56:59], v13 offset:448
    ds_read_b128 a[60:63], v15 offset:448
    s_waitcnt lgkmcnt(8)
    v_mfma_f32_16x16x32_bf16 v[8:11], a[16:19], a[20:23], v[8:11]
    ds_read_b128 a[0:3], v13 offset:3968
    ds_read_b128 a[4:7], v15 offset:3968
    v_mfma_f32_16x16x32_bf16 v[8:11], a[24:27], a[28:31], v[8:11]
    ds_read_b128 a[8:11], v13 offset:3456
    ds_read_b128 a[12:15], v15 offset:3456
    s_waitcnt lgkmcnt(8)
    v_mfma_f32_16x16x32_bf16 v[8:11], a[32:35], a[36:39], v[8:11]
    ds_read_b128 a[16:19], v13 offset:2944
    ds_read_b128 a[20:23], v15 offset:2944
    v_mfma_f32_16x16x32_bf16 v[8:11], a[40:43], a[44:47], v[8:11]
    ds_read_b128 a[24:27], v13 offset:2432
    ds_read_b128 a[28:31], v15 offset:2432
    s_waitcnt lgkmcnt(8)
    v_mfma_f32_16x16x32_bf16 v[8:11], a[48:51], a[52:55], v[8:11]
    ds_read_b128 a[32:35], v13 offset:1920
    ds_read_b128 a[36:39], v15 offset:1920
    v_mfma_f32_16x16x32_bf16 v[8:11], a[56:59], a[60:63], v[8:11]
    ds_read_b128 a[40:43], v13 offset:1408
    ds_read_b128 a[44:47], v15 offset:1408
    s_waitcnt lgkmcnt(8)
    v_mfma_f32_16x16x32_bf16 v[8:11], a[0:3], a[4:7], v[8:11]
    ds_read_b128 a[48:51], v13 offset:896
    ds_read_b128 a[52:55], v15 offset:896
    v_mfma_f32_16x16x32_bf16 v[8:11], a[8:11], a[12:15], v[8:11]
    ds_read_b128 a[56:59], v13 offset:384
    ds_read_b128 a[60:63], v15 offset:384
    s_waitcnt lgkmcnt(8)
    v_mfma_f32_16x16x32_bf16 v[8:11], a[16:19], a[20:23], v[8:11]
    ds_read_b128 a[0:3], v13 offset:3904
    ds_read_b128 a[4:7], v15 offset:3904
    v_mfma_f32_16x16x32_bf16 v[8:11], a[24:27], a[28:31], v[8:11]
    ds_read_b128 a[8:11], v13 offset:3392
    ds_read_b128 a[12:15], v15 offset:3392
    s_waitcnt lgkmcnt(8)
    v_mfma_f32_16x16x32_bf16 v[8:11], a[32:35], a[36:39], v[8:11]
    ds_read_b128 a[16:19], v13 offset:2880
    ds_read_b128 a[20:23], v15 offset:2880
    v_mfma_f32_16x16x32_bf16 v[8:11], a[40:43], a[44:47], v[8:11]
    ds_read_b128 a[24:27], v13 offset:2368
    ds_read_b128 a[28:31], v15 offset:2368
    s_waitcnt lgkmcnt(8)
    v_mfma_f32_16x16x32_bf16 v[8:11], a[48:51], a[52:55], v[8:11]
    ds_read_b128 a[32:35], v13 offset:1856
    ds_read_b128 a[36:39], v15 offset:1856
    v_mfma_f32_16x16x32_bf16 v[8:11], a[56:59], a[60:63], v[8:11]
    ds_read_b128 a[40:43], v13 offset:1344
    ds_read_b128 a[44:47], v15 offset:1344
    s_cmp_eq_u32 s89, 1
    s_cbranch_scc0 L_trs_80
    s_add_u32 s43, s80, 49152
    buffer_load_dwordx4 v[132:135], v250, s[16:19], s43 offen offset:0 sc1
    buffer_load_dwordx4 v[164:167], v250, s[16:19], s43 offen offset:1024 sc1
    s_add_u32 s43, s80, 61440
    buffer_load_dwordx4 v[136:139], v250, s[16:19], s43 offen offset:0 sc1
    buffer_load_dwordx4 v[168:171], v250, s[16:19], s43 offen offset:1024 sc1
    s_add_u32 s43, s80, 73728
    buffer_load_dwordx4 v[140:143], v250, s[16:19], s43 offen offset:0 sc1
    buffer_load_dwordx4 v[172:175], v250, s[16:19], s43 offen offset:1024 sc1
    s_add_u32 s43, s80, 86016
    buffer_load_dwordx4 v[144:147], v250, s[16:19], s43 offen offset:0 sc1
    buffer_load_dwordx4 v[176:179], v250, s[16:19], s43 offen offset:1024 sc1
    s_add_u32 s89, s89, 1
L_trs_80:
    s_waitcnt lgkmcnt(8)
    v_mfma_f32_16x16x32_bf16 v[8:11], a[0:3], a[4:7], v[8:11]
    ds_read_b128 a[48:51], v13 offset:832
    ds_read_b128 a[52:55], v15 offset:832
    v_mfma_f32_16x16x32_bf16 v[8:11], a[8:11], a[12:15], v[8:11]
    ds_read_b128 a[56:59], v13 offset:320
    ds_read_b128 a[60:63], v15 offset:320
    s_waitcnt lgkmcnt(8)
    v_mfma_f32_16x16x32_bf16 v[8:11], a[16:19], a[20:23], v[8:11]
    ds_read_b128 a[0:3], v13 offset:3840
    ds_read_b128 a[4:7], v15 offset:3840
    v_mfma_f32_16x16x32_bf16 v[8:11], a[24:27], a[28:31], v[8:11]
    ds_read_b128 a[8:11], v13 offset:3328
    ds_read_b128 a[12:15], v15 offset:3328
    s_waitcnt lgkmcnt(8)
    v_mfma_f32_16x16x32_bf16 v[8:11], a[32:35], a[36:39], v[8:11]
    ds_read_b128 a[16:19], v13 offset:2816
    ds_read_b128 a[20:23], v15 offset:2816
    v_mfma_f32_16x16x32_bf16 v[8:11], a[40:43], a[44:47], v[8:11]
    ds_read_b128 a[24:27], v13 offset:2304
    ds_read_b128 a[28:31], v15 offset:2304
    s_waitcnt lgkmcnt(8)
    v_mfma_f32_16x16x32_bf16 v[8:11], a[48:51], a[52:55], v[8:11]
    ds_read_b128 a[32:35], v13 offset:1792
    ds_read_b128 a[36:39], v15 offset:1792
    v_mfma_f32_16x16x32_bf16 v[8:11], a[56:59], a[60:63], v[8:11]
    ds_read_b128 a[40:43], v13 offset:1280
    ds_read_b128 a[44:47], v15 offset:1280
    s_waitcnt lgkmcnt(8)
    v_mfma_f32_16x16x32_bf16 v[8:11], a[0:3], a[4:7], v[8:11]
    ds_read_b128 a[48:51], v13 offset:768
    ds_read_b128 a[52:55], v15 offset:768
    v_mfma_f32_16x16x32_bf16 v[8:11], a[8:11], a[12:15], v[8:11]
    ds_read_b128 a[56:59], v13 offset:256
    ds_read_b128 a[60:63], v15 offset:256
    s_waitcnt lgkmcnt(8)
    v_mfma_f32_16x16x32_bf16 v[8:11], a[16:19], a[20:23], v[8:11]
    ds_read_b128 a[0:3], v13 offset:3776
    ds_read_b128 a[4:7], v15 offset:3776
    v_mfma_f32_16x16x32_bf16 v[8:11], a[24:27], a[28:31], v[8:11]
    ds_read_b128 a[8:11], v13 offset:3264
    ds_read_b128 a[12:15], v15 offset:3264
    s_waitcnt lgkmcnt(8)
    v_mfma_f32_16x16x32_bf16 v[8:11], a[32:35], a[36:39], v[8:11]
    ds_read_b128 a[16:19], v13 offset:2752
    ds_read_b128 a[20:23], v15 offset:2752
    v_mfma_f32_16x16x32_bf16 v[8:11], a[40:43], a[44:47], v[8:11]
    ds_read_b128 a[24:27], v13 offset:2240
    ds_read_b128 a[28:31], v15 offset:2240
    s_waitcnt lgkmcnt(8)
    v_mfma_f32_16x16x32_bf16 v[8:11], a[48:51], a[52:55], v[8:11]
    ds_read_b128 a[32:35], v13 offset:1728
    ds_read_b128 a[36:39], v15 offset:1728
    v_mfma_f32_16x16x32_bf16 v[8:11], a[56:59], a[60:63], v[8:11]
    ds_read_b128 a[40:43], v13 offset:1216
    ds_read_b128 a[44:47], v15 offset:1216
    s_waitcnt lgkmcnt(8)
    v_mfma_f32_16x16x32_bf16 v[8:11], a[0:3], a[4:7], v[8:11]
    ds_read_b128 a[48:51], v13 offset:704
    ds_read_b128 a[52:55], v15 offset:704
    v_mfma_f32_16x16x32_bf16 v[8:11], a[8:11], a[12:15], v[8:11]
    ds_read_b128 a[56:59], v13 offset:192
    ds_read_b128 a[60:63], v15 offset:192
    s_waitcnt lgkmcnt(8)
    v_mfma_f32_16x16x32_bf16 v[8:11], a[16:19], a[20:23], v[8:11]
    ds_read_b128 a[0:3], v13 offset:3712
    ds_read_b128 a[4:7], v15 offset:3712
    v_mfma_f32_16x16x32_bf16 v[8:11], a[24:27], a[28:31], v[8:11]
    ds_read_b128 a[8:11], v13 offset:3200
    ds_read_b128 a[12:15], v15 offset:3200
    s_waitcnt lgkmcnt(8)
    v_mfma_f32_16x16x32_bf16 v[8:11], a[32:35], a[36:39], v[8:11]
    ds_read_b128 a[16:19], v13 offset:2688
    ds_read_b128 a[20:23], v15 offset:2688
    v_mfma_f32_16x16x32_bf16 v[8:11], a[40:43], a[44:47], v[8:11]
    ds_read_b128 a[24:27], v13 offset:2176
    ds_read_b128 a[28:31], v15 offset:2176
    s_waitcnt lgkmcnt(8)
    v_mfma_f32_16x16x32_bf16 v[8:11], a[48:51], a[52:55], v[8:11]
    ds_read_b128 a[32:35], v13 offset:1664
    ds_read_b128 a[36:39], v15 offset:1664
    v_mfma_f32_16x16x32_bf16 v[8:11], a[56:59], a[60:63], v[8:11]
    ds_read_b128 a[40:43], v13 offset:1152
    ds_read_b128 a[44:47], v15 offset:1152
    s_waitcnt lgkmcnt(8)
    v_mfma_f32_16x16x32_bf16 v[8:11], a[0:3], a[4:7], v[8:11]
    ds_read_b128 a[48:51], v13 offset:640
    ds_read_b128 a[52:55], v15 offset:640
    v_mfma_f32_16x16x32_bf16 v[8:11], a[8:11], a[12:15], v[8:11]
    ds_read_b128 a[56:59], v13 offset:128
    ds_read_b128 a[60:63], v15 offset:128
    s_waitcnt lgkmcnt(8)
    v_mfma_f32_16x16x32_bf16 v[8:11], a[16:19], a[20:23], v[8:11]
    ds_read_b128 a[0:3], v13 offset:3648
    ds_read_b128 a[4:7], v15 offset:3648
    v_mfma_f32_16x16x32_bf16 v[8:11], a[24:27], a[28:31], v[8:11]
    ds_read_b128 a[8:11], v13 offset:3136
    ds_read_b128 a[12:15], v15 offset:3136
    s_waitcnt lgkmcnt(8)
    v_mfma_f32_16x16x32_bf16 v[8:11], a[32:35], a[36:39], v[8:11]
    ds_read_b128 a[16:19], v13 offset:2624
    ds_read_b128 a[20:23], v15 offset:2624
    v_mfma_f32_16x16x32_bf16 v[8:11], a[40:43], a[44:47], v[8:11]
    ds_read_b128 a[24:27], v13 offset:2112
    ds_read_b128 a[28:31], v15 offset:2112
    s_waitcnt lgkmcnt(8)
    v_mfma_f32_16x16x32_bf16 v[8:11], a[48:51], a[52:55], v[8:11]
    ds_read_b128 a[32:35], v13 offset:1600
    ds_read_b128 a[36:39], v15 offset:1600
    v_mfma_f32_16x16x32_bf16 v[8:11], a[56:59], a[60:63], v[8:11]
    ds_read_b128 a[40:43], v13 offset:1088
    ds_read_b128 a[44:47], v15 offset:1088
    s_waitcnt lgkmcnt(8)
    v_mfma_f32_16x16x32_bf16 v[8:11], a[0:3], a[4:7], v[8:11]
    ds_read_b128 a[48:51], v13 offset:576
    ds_read_b128 a[52:55], v15 offset:576
    v_mfma_f32_16x16x32_bf16 v[8:11], a[8:11], a[12:15], v[8:11]
    ds_read_b128 a[56:59], v13 offset:64
    ds_read_b128 a[60:63], v15 offset:64
    s_waitcnt lgkmcnt(8)
    v_mfma_f32_16x16x32_bf16 v[8:11], a[16:19], a[20:23], v[8:11]
    ds_read_b128 a[0:3], v13 offset:3584
    ds_read_b128 a[4:7], v15 offset:3584
    v_mfma_f32_16x16x32_bf16 v[8:11], a[24:27], a[28:31], v[8:11]
    ds_read_b128 a[8:11], v13 offset:3072
    ds_read_b128 a[12:15], v15 offset:3072
    s_waitcnt lgkmcnt(8)
    v_mfma_f32_16x16x32_bf16 v[8:11], a[32:35], a[36:39], v[8:11]
    ds_read_b128 a[16:19], v13 offset:2560
    ds_read_b128 a[20:23], v15 offset:2560
    v_mfma_f32_16x16x32_bf16 v[8:11], a[40:43], a[44:47], v[8:11]
    ds_read_b128 a[24:27], v13 offset:2048
    ds_read_b128 a[28:31], v15 offset:2048
    s_waitcnt lgkmcnt(8)
    v_mfma_f32_16x16x32_bf16 v[8:11], a[48:51], a[52:55], v[8:11]
    ds_read_b128 a[32:35], v13 offset:1536
    ds_read_b128 a[36:39], v15 offset:1536
    v_mfma_f32_16x16x32_bf16 v[8:11], a[56:59], a[60:63], v[8:11]
    ds_read_b128 a[40:43], v13 offset:1024
    ds_read_b128 a[44:47], v15 offset:1024
    s_waitcnt lgkmcnt(8)
    v_mfma_f32_16x16x32_bf16 v[8:11], a[0:3], a[4:7], v[8:11]
    ds_read_b128 a[48:51], v13 offset:512
    ds_read_b128 a[52:55], v15 offset:512
    v_mfma_f32_16x16x32_bf16 v[8:11], a[8:11], a[12:15], v[8:11]
    ds_read_b128 a[56:59], v13 offset:0
    ds_read_b128 a[60:63], v15 offset:0
    s_waitcnt lgkmcnt(8)
    v_mfma_f32_16x16x32_bf16 v[8:11], a[16:19], a[20:23], v[8:11]
    ds_read_b32 v60, v94
    ds_read_b32 v61, v94 offset:16
    v_mfma_f32_16x16x32_bf16 v[8:11], a[24:27], a[28:31], v[8:11]
    ds_read_b32 v62, v16
    ds_read_b32 v63, v16 offset:16
    s_waitcnt lgkmcnt(8)
    v_mfma_f32_16x16x32_bf16 v[8:11], a[32:35], a[36:39], v[8:11]
    ds_read_b32 v64, v17
    ds_read_b32 v65, v17 offset:16
    v_mfma_f32_16x16x32_bf16 v[8:11], a[40:43], a[44:47], v[8:11]
    s_waitcnt lgkmcnt(6)
    v_mfma_f32_16x16x32_bf16 v[8:11], a[48:51], a[52:55], v[8:11]
    v_mfma_f32_16x16x32_bf16 v[8:11], a[56:59], a[60:63], v[8:11]
    s_waitcnt lgkmcnt(0)
    v_lshlrev_b32 v80, 16, v60
    v_and_b32 v81, 0xffff0000, v60
    v_fma_f32 v80, v80, v95, v0
    v_fma_f32 v81, v81, v95, v1
    v_cvt_pk_bf16_f32 v60, v80, v81
    ds_write_b32 v109, v60 offset:0
    v_lshlrev_b32 v82, 16, v61
    v_and_b32 v83, 0xffff0000, v61
    v_fma_f32 v82, v82, v95, v2
    v_fma_f32 v83, v83, v95, v3
    v_cvt_pk_bf16_f32 v61, v82, v83
    ds_write_b32 v109, v61 offset:16
    v_lshlrev_b32 v80, 16, v62
    v_and_b32 v81, 0xffff0000, v62
    v_fma_f32 v80, v80, v96, v4
    v_fma_f32 v81, v81, v96, v5
    v_cvt_pk_bf16_f32 v62, v80, v81
    ds_write_b32 v109, v62 offset:1024
    v_lshlrev_b32 v82, 16, v63
    v_and_b32 v83, 0xffff0000, v63
    v_fma_f32 v82, v82, v96, v6
    v_fma_f32 v83, v83, v96, v7
    v_cvt_pk_bf16_f32 v63, v82, v83
    ds_write_b32 v109, v63 offset:1040
    v_lshlrev_b32 v80, 16, v64
    v_and_b32 v81, 0xffff0000, v64
    v_fma_f32 v80, v80, v97, v8
    v_fma_f32 v81, v81, v97, v9
    v_cvt_pk_bf16_f32 v64, v80, v81
    ds_write_b32 v109, v64 offset:2048
    v_lshlrev_b32 v82, 16, v65
    v_and_b32 v83, 0xffff0000, v65
    v_fma_f32 v82, v82, v97, v10
    v_fma_f32 v83, v83, v97, v11
    v_cvt_pk_bf16_f32 v65, v82, v83
    ds_write_b32 v109, v65 offset:2064
    s_waitcnt lgkmcnt(0)
    ds_read_b128 v[68:71], v110 offset:0
    ds_read_b128 v[72:75], v110 offset:1024
    ds_read_b128 v[76:79], v110 offset:2048
    s_mov_b64 exec, 0xffffffff
    s_add_u32 s41, s92, 3670016
    s_waitcnt lgkmcnt(2)
    buffer_store_dwordx4 v[68:71], v93, s[16:19], s41 offen sc1
    s_add_u32 s41, s93, 3670016
    s_waitcnt lgkmcnt(1)
    buffer_store_dwordx4 v[72:75], v18, s[16:19], s41 offen sc1
    s_add_u32 s41, s94, 3670016
    s_waitcnt lgkmcnt(0)
    buffer_store_dwordx4 v[76:79], v19, s[16:19], s41 offen sc1
    s_mov_b64 exec, -1
    s_cmp_ge_u32 s89, 2
    s_cbranch_scc1 L_pf2_83
    s_cmp_eq_u32 s89, 1
    s_cbranch_scc1 L_pf1_82
    s_mov_b32 s43, 0x8000
L_flp_85:
    s_waitcnt vmcnt(0)
    v_cmp_gt_u32 s[44:45], s3, v255
    s_nop 1
    s_cmp_eq_u64 s[44:45], 0
    s_cbranch_scc1 L_fok_84
    buffer_load_dword v255, v239, s[16:19], s86 offen sc1
    s_sub_u32 s43, s43, 1
    s_cbranch_scc0 L_flp_85
L_fok_84:
    s_add_u32 s43, s80, 0
    buffer_load_dwordx4 v[116:119], v250, s[16:19], s43 offen offset:0 sc1
    buffer_load_dwordx4 v[148:151], v250, s[16:19], s43 offen offset:1024 sc1
    s_add_u32 s43, s80, 12288
    buffer_load_dwordx4 v[120:123], v250, s[16:19], s43 offen offset:0 sc1
    buffer_load_dwordx4 v[152:155], v250, s[16:19], s43 offen offset:1024 sc1
    s_add_u32 s43, s80, 24576
    buffer_load_dwordx4 v[124:127], v250, s[16:19], s43 offen offset:0 sc1
    buffer_load_dwordx4 v[156:159], v250, s[16:19], s43 offen offset:1024 sc1
    s_add_u32 s43, s80, 36864
    buffer_load_dwordx4 v[128:131], v250, s[16:19], s43 offen offset:0 sc1
    buffer_load_dwordx4 v[160:163], v250, s[16:19], s43 offen offset:1024 sc1
L_pf1_82:
    s_add_u32 s43, s80, 49152
    buffer_load_dwordx4 v[132:135], v250, s[16:19], s43 offen offset:0 sc1
    buffer_load_dwordx4 v[164:167], v250, s[16:19], s43 offen offset:1024 sc1
    s_add_u32 s43, s80, 61440
    buffer_load_dwordx4 v[136:139], v250, s[16:19], s43 offen offset:0 sc1
    buffer_load_dwordx4 v[168:171], v250, s[16:19], s43 offen offset:1024 sc1
    s_add_u32 s43, s80, 73728
    buffer_load_dwordx4 v[140:143], v250, s[16:19], s43 offen offset:0 sc1
    buffer_load_dwordx4 v[172:175], v250, s[16:19], s43 offen offset:1024 sc1
    s_add_u32 s43, s80, 86016
    buffer_load_dwordx4 v[144:147], v250, s[16:19], s43 offen offset:0 sc1
    buffer_load_dwordx4 v[176:179], v250, s[16:19], s43 offen offset:1024 sc1
    s_waitcnt vmcnt(0)
L_pf2_83:
    s_waitcnt vmcnt(3)
    s_branch L_final
L_noconv:
    s_sub_u32 s40, s22, 6
    s_mul_i32 s40, s40, 16352
    s_sub_u32 s88, s88, s40
    v_lshrrev_b32 v245, 5, v253
    v_bfe_u32 v244, v253, 1, 4
    v_lshlrev_b32 v244, 6, v244
    v_lshl_add_u32 v244, v245, 14, v244
    v_and_b32 v200, 16, v250
    v_add_u32 v244, v244, v200
    v_lshlrev_b32 v245, 8, v245
    v_bfe_u32 v200, v253, 4, 1
    v_lshl_add_u32 v245, v200, 9, v245
    v_and_b32 v200, 15, v253
    v_lshl_add_u32 v245, v200, 3, v245
    s_mul_i32 s40, s20, 3072
    s_add_u32 s40, s40, 18432
    v_add_u32 v245, s40, v245
    s_mul_i32 s40, s21, 147456
    s_mul_i32 s41, s20, 36864
    s_add_u32 s40, s41, s40
    s_mul_i32 s42, s23, 640
    s_add_u32 s41, s40, s42
    s_lshl_b32 s42, s22, 6
    s_add_u32 s82, s41, s42
    s_add_u32 s83, s82, 32
    s_lshl_b32 s41, s23, 6
    s_add_u32 s40, s40, s41
    s_mul_i32 s41, s22, 18432
    s_add_u32 s40, s40, s41
    s_add_u32 s84, s40, 4294857216
    v_and_b32 v236, 31, v253
    v_lshrrev_b32 v200, 5, v253
    v_mul_u32_u24 v236, 1152, v236
    v_lshl_add_u32 v236, v200, 4, v236
    s_mul_i32 s40, s20, 3072
    s_add_u32 s40, s40, 16384
    v_add_u32 v238, s40, v250
    v_and_b32 v237, 3, v253
    v_lshlrev_b32 v237, 3, v237
    v_lshl_add_u32 v237, v200, 9, v237
    v_bfe_u32 v200, v253, 4, 1
    v_lshl_add_u32 v237, v200, 5, v237
    v_bfe_u32 v200, v253, 2, 2
    v_lshl_add_u32 v237, v200, 6, v237
    v_add_u32 v237, s40, v237
    v_and_b32 v240, 15, v253
    v_mul_u32_u24 v240, 1152, v240
    v_bfe_u32 v200, v253, 4, 1
    v_lshl_add_u32 v240, v200, 5, v240
    v_lshrrev_b32 v200, 5, v253
    v_lshl_add_u32 v240, v200, 4, v240
    v_accvgpr_read_b32 v212, a44
    v_accvgpr_read_b32 v213, a45
    v_accvgpr_read_b32 v214, a46
    v_accvgpr_read_b32 v215, a47
    v_accvgpr_read_b32 v216, a48
    v_accvgpr_read_b32 v217, a49
    v_accvgpr_read_b32 v218, a50
    v_accvgpr_read_b32 v219, a51
    s_waitcnt vmcnt(0) lgkmcnt(0)
    v_mov_b32 v254, 3
    s_mov_b64 exec, 1
    buffer_store_dword v254, v251, s[16:19], s85 offen sc1
    s_mov_b64 exec, -1
    buffer_load_dword v255, v239, s[16:19], s86 offen sc1
    s_mov_b32 s43, 0x8000
L_flp_87:
    s_waitcnt vmcnt(0)
    v_cmp_gt_u32 s[44:45], 3, v255
    s_nop 1
    s_cmp_eq_u64 s[44:45], 0
    s_cbranch_scc1 L_fok_86
    buffer_load_dword v255, v239, s[16:19], s86 offen sc1
    s_sub_u32 s43, s43, 1
    s_cbranch_scc0 L_flp_87
L_fok_86:
    buffer_load_dwordx4 v[220:223], v240, s[12:15], s84 offen
    s_add_u32 s43, s80, 0
    buffer_load_dwordx4 v[116:119], v250, s[16:19], s43 offen offset:0 sc1
    buffer_load_dwordx4 v[148:151], v250, s[16:19], s43 offen offset:1024 sc1
    s_add_u32 s43, s80, 12288
    buffer_load_dwordx4 v[120:123], v250, s[16:19], s43 offen offset:0 sc1
    buffer_load_dwordx4 v[152:155], v250, s[16:19], s43 offen offset:1024 sc1
    s_add_u32 s43, s80, 24576
    buffer_load_dwordx4 v[124:127], v250, s[16:19], s43 offen offset:0 sc1
    buffer_load_dwordx4 v[156:159], v250, s[16:19], s43 offen offset:1024 sc1
    s_add_u32 s43, s80, 36864
    buffer_load_dwordx4 v[128:131], v250, s[16:19], s43 offen offset:0 sc1
    buffer_load_dwordx4 v[160:163], v250, s[16:19], s43 offen offset:1024 sc1
    s_add_u32 s43, s80, 49152
    buffer_load_dwordx4 v[132:135], v250, s[16:19], s43 offen offset:0 sc1
    buffer_load_dwordx4 v[164:167], v250, s[16:19], s43 offen offset:1024 sc1
    s_add_u32 s43, s80, 61440
    buffer_load_dwordx4 v[136:139], v250, s[16:19], s43 offen offset:0 sc1
    buffer_load_dwordx4 v[168:171], v250, s[16:19], s43 offen offset:1024 sc1
    s_add_u32 s43, s80, 73728
    buffer_load_dwordx4 v[140:143], v250, s[16:19], s43 offen offset:0 sc1
    buffer_load_dwordx4 v[172:175], v250, s[16:19], s43 offen offset:1024 sc1
    s_add_u32 s43, s80, 86016
    buffer_load_dwordx4 v[144:147], v250, s[16:19], s43 offen offset:0 sc1
    buffer_load_dwordx4 v[176:179], v250, s[16:19], s43 offen offset:1024 sc1
    s_add_u32 s43, s87, 0
    buffer_load_dwordx4 v[180:183], v250, s[16:19], s43 offen offset:0 sc1
    s_add_u32 s43, s87, 12288
    buffer_load_dwordx4 v[184:187], v250, s[16:19], s43 offen offset:0 sc1
    s_add_u32 s43, s87, 24576
    buffer_load_dwordx4 v[188:191], v250, s[16:19], s43 offen offset:0 sc1
    s_add_u32 s43, s87, 36864
    buffer_load_dwordx4 v[192:195], v250, s[16:19], s43 offen offset:0 sc1
    s_add_u32 s43, s87, 49152
    buffer_load_dwordx4 v[196:199], v250, s[16:19], s43 offen offset:0 sc1
    s_add_u32 s43, s87, 61440
    buffer_load_dwordx4 v[200:203], v250, s[16:19], s43 offen offset:0 sc1
    s_add_u32 s43, s87, 73728
    buffer_load_dwordx4 v[204:207], v250, s[16:19], s43 offen offset:0 sc1
    s_add_u32 s43, s87, 86016
    buffer_load_dwordx4 v[208:211], v250, s[16:19], s43 offen offset:0 sc1
    s_waitcnt vmcnt(0)
L_final:
    s_mov_b32 s40, 0x00003f80
    s_mov_b32 s41, 0x3f800000
    s_mov_b32 s46, 0xbfb8aa3b
    s_mov_b32 s47, 0xbfb8aa3b
    s_mov_b32 s78, 2359296
    s_mov_b32 s79, 0x00020000
    s_cmp_ge_u32 s22, 6
    s_cbranch_scc1 L_fin3
L_g0:
    v_lshlrev_b32 v28, 16, v116
    v_and_b32 v29, 0xffff0000, v116
    v_lshlrev_b32 v30, 16, v117
    v_and_b32 v31, 0xffff0000, v117
    v_lshlrev_b32 v32, 16, v118
    v_and_b32 v33, 0xffff0000, v118
    v_lshlrev_b32 v34, 16, v119
    v_and_b32 v35, 0xffff0000, v119
    v_dot2c_f32_bf16 v28, s40, v120
    v_dot2c_f32_bf16 v29, s41, v120
    v_dot2c_f32_bf16 v30, s40, v121
    v_dot2c_f32_bf16 v31, s41, v121
    v_dot2c_f32_bf16 v32, s40, v122
    v_dot2c_f32_bf16 v33, s41, v122
    v_dot2c_f32_bf16 v34, s40, v123
    v_dot2c_f32_bf16 v35, s41, v123
    v_dot2c_f32_bf16 v28, s40, v124
    v_dot2c_f32_bf16 v29, s41, v124
    v_dot2c_f32_bf16 v30, s40, v125
    v_dot2c_f32_bf16 v31, s41, v125
    v_dot2c_f32_bf16 v32, s40, v126
    v_dot2c_f32_bf16 v33, s41, v126
    v_dot2c_f32_bf16 v34, s40, v127
    v_dot2c_f32_bf16 v35, s41, v127
    v_dot2c_f32_bf16 v28, s40, v128
    v_dot2c_f32_bf16 v29, s41, v128
    v_dot2c_f32_bf16 v30, s40, v129
    v_dot2c_f32_bf16 v31, s41, v129
    v_dot2c_f32_bf16 v32, s40, v130
    v_dot2c_f32_bf16 v33, s41, v130
    v_dot2c_f32_bf16 v34, s40, v131
    v_dot2c_f32_bf16 v35, s41, v131
    v_dot2c_f32_bf16 v28, s40, v132
    v_dot2c_f32_bf16 v29, s41, v132
    v_dot2c_f32_bf16 v30, s40, v133
    v_dot2c_f32_bf16 v31, s41, v133
    v_dot2c_f32_bf16 v32, s40, v134
    v_dot2c_f32_bf16 v33, s41, v134
    v_dot2c_f32_bf16 v34, s40, v135
    v_dot2c_f32_bf16 v35, s41, v135
    v_dot2c_f32_bf16 v28, s40, v136
    v_dot2c_f32_bf16 v29, s41, v136
    v_dot2c_f32_bf16 v30, s40, v137
    v_dot2c_f32_bf16 v31, s41, v137
    v_dot2c_f32_bf16 v32, s40, v138
    v_dot2c_f32_bf16 v33, s41, v138
    v_dot2c_f32_bf16 v34, s40, v139
    v_dot2c_f32_bf16 v35, s41, v139
    v_dot2c_f32_bf16 v28, s40, v140
    v_dot2c_f32_bf16 v29, s41, v140
    v_dot2c_f32_bf16 v30, s40, v141
    v_dot2c_f32_bf16 v31, s41, v141
    v_dot2c_f32_bf16 v32, s40, v142
    v_dot2c_f32_bf16 v33, s41, v142
    v_dot2c_f32_bf16 v34, s40, v143
    v_dot2c_f32_bf16 v35, s41, v143
    v_dot2c_f32_bf16 v28, s40, v144
    v_dot2c_f32_bf16 v29, s41, v144
    v_dot2c_f32_bf16 v30, s40, v145
    v_dot2c_f32_bf16 v31, s41, v145
    v_dot2c_f32_bf16 v32, s40, v146
    v_dot2c_f32_bf16 v33, s41, v146
    v_dot2c_f32_bf16 v34, s40, v147
    v_dot2c_f32_bf16 v35, s41, v147
    s_nop 2
    v_permlane32_swap_b32 v28, v32
    v_permlane32_swap_b32 v29, v33
    v_permlane32_swap_b32 v30, v34
    v_permlane32_swap_b32 v31, v35
    v_pk_mul_f32 v[52:53], v[28:29], s[46:47]
    v_pk_mul_f32 v[54:55], v[30:31], s[46:47]
    v_pk_mul_f32 v[56:57], v[32:33], s[46:47]
    v_pk_mul_f32 v[58:59], v[34:35], s[46:47]
    v_exp_f32 v52, v52
    v_exp_f32 v53, v53
    v_exp_f32 v54, v54
    v_exp_f32 v55, v55
    v_exp_f32 v56, v56
    v_exp_f32 v57, v57
    v_exp_f32 v58, v58
    v_exp_f32 v59, v59
    v_pk_add_f32 v[52:53], v[52:53], 1.0 op_sel_hi:[1,0]
    v_pk_add_f32 v[54:55], v[54:55], 1.0 op_sel_hi:[1,0]
    v_pk_add_f32 v[56:57], v[56:57], 1.0 op_sel_hi:[1,0]
    v_pk_add_f32 v[58:59], v[58:59], 1.0 op_sel_hi:[1,0]
    v_rcp_f32 v52, v52
    v_rcp_f32 v53, v53
    v_rcp_f32 v54, v54
    v_rcp_f32 v55, v55
    v_rcp_f32 v56, v56
    v_rcp_f32 v57, v57
    v_rcp_f32 v58, v58
    v_rcp_f32 v59, v59
    v_lshlrev_b32 v116, 16, v212
    v_and_b32 v117, 0xffff0000, v212
    v_lshlrev_b32 v118, 16, v213
    v_and_b32 v119, 0xffff0000, v213
    v_lshlrev_b32 v120, 16, v214
    v_and_b32 v121, 0xffff0000, v214
    v_lshlrev_b32 v122, 16, v215
    v_and_b32 v123, 0xffff0000, v215
    v_pk_mul_f32 v[28:29], v[52:53], v[28:29]
    v_pk_mul_f32 v[30:31], v[54:55], v[30:31]
    v_pk_mul_f32 v[32:33], v[56:57], v[32:33]
    v_pk_mul_f32 v[34:35], v[58:59], v[34:35]
    buffer_load_dwordx4 v[224:227], v250, s[16:19], s81 offen offset:0 sc1
    buffer_load_dwordx4 v[228:231], v250, s[16:19], s81 offen offset:1024 sc1
L_g1:
    v_lshlrev_b32 v36, 16, v148
    v_and_b32 v37, 0xffff0000, v148
    v_lshlrev_b32 v38, 16, v149
    v_and_b32 v39, 0xffff0000, v149
    v_lshlrev_b32 v40, 16, v150
    v_and_b32 v41, 0xffff0000, v150
    v_lshlrev_b32 v42, 16, v151
    v_and_b32 v43, 0xffff0000, v151
    v_dot2c_f32_bf16 v36, s40, v152
    v_dot2c_f32_bf16 v37, s41, v152
    v_dot2c_f32_bf16 v38, s40, v153
    v_dot2c_f32_bf16 v39, s41, v153
    v_dot2c_f32_bf16 v40, s40, v154
    v_dot2c_f32_bf16 v41, s41, v154
    v_dot2c_f32_bf16 v42, s40, v155
    v_dot2c_f32_bf16 v43, s41, v155
    v_dot2c_f32_bf16 v36, s40, v156
    v_dot2c_f32_bf16 v37, s41, v156
    v_dot2c_f32_bf16 v38, s40, v157
    v_dot2c_f32_bf16 v39, s41, v157
    v_dot2c_f32_bf16 v40, s40, v158
    v_dot2c_f32_bf16 v41, s41, v158
    v_dot2c_f32_bf16 v42, s40, v159
    v_dot2c_f32_bf16 v43, s41, v159
    v_dot2c_f32_bf16 v36, s40, v160
    v_dot2c_f32_bf16 v37, s41, v160
    v_dot2c_f32_bf16 v38, s40, v161
    v_dot2c_f32_bf16 v39, s41, v161
    v_dot2c_f32_bf16 v40, s40, v162
    v_dot2c_f32_bf16 v41, s41, v162
    v_dot2c_f32_bf16 v42, s40, v163
    v_dot2c_f32_bf16 v43, s41, v163
    v_dot2c_f32_bf16 v36, s40, v164
    v_dot2c_f32_bf16 v37, s41, v164
    v_dot2c_f32_bf16 v38, s40, v165
    v_dot2c_f32_bf16 v39, s41, v165
    v_dot2c_f32_bf16 v40, s40, v166
    v_dot2c_f32_bf16 v41, s41, v166
    v_dot2c_f32_bf16 v42, s40, v167
    v_dot2c_f32_bf16 v43, s41, v167
    v_dot2c_f32_bf16 v36, s40, v168
    v_dot2c_f32_bf16 v37, s41, v168
    v_dot2c_f32_bf16 v38, s40, v169
    v_dot2c_f32_bf16 v39, s41, v169
    v_dot2c_f32_bf16 v40, s40, v170
    v_dot2c_f32_bf16 v41, s41, v170
    v_dot2c_f32_bf16 v42, s40, v171
    v_dot2c_f32_bf16 v43, s41, v171
    v_dot2c_f32_bf16 v36, s40, v172
    v_dot2c_f32_bf16 v37, s41, v172
    v_dot2c_f32_bf16 v38, s40, v173
    v_dot2c_f32_bf16 v39, s41, v173
    v_dot2c_f32_bf16 v40, s40, v174
    v_dot2c_f32_bf16 v41, s41, v174
    v_dot2c_f32_bf16 v42, s40, v175
    v_dot2c_f32_bf16 v43, s41, v175
    v_dot2c_f32_bf16 v36, s40, v176
    v_dot2c_f32_bf16 v37, s41, v176
    v_dot2c_f32_bf16 v38, s40, v177
    v_dot2c_f32_bf16 v39, s41, v177
    v_dot2c_f32_bf16 v40, s40, v178
    v_dot2c_f32_bf16 v41, s41, v178
    v_dot2c_f32_bf16 v42, s40, v179
    v_dot2c_f32_bf16 v43, s41, v179
    s_nop 2
    v_permlane32_swap_b32 v36, v40
    v_permlane32_swap_b32 v37, v41
    v_permlane32_swap_b32 v38, v42
    v_permlane32_swap_b32 v39, v43
    v_pk_mul_f32 v[52:53], v[36:37], s[46:47]
    v_pk_mul_f32 v[54:55], v[38:39], s[46:47]
    v_pk_mul_f32 v[56:57], v[40:41], s[46:47]
    v_pk_mul_f32 v[58:59], v[42:43], s[46:47]
    v_exp_f32 v52, v52
    v_exp_f32 v53, v53
    v_exp_f32 v54, v54
    v_exp_f32 v55, v55
    v_exp_f32 v56, v56
    v_exp_f32 v57, v57
    v_exp_f32 v58, v58
    v_exp_f32 v59, v59
    v_pk_add_f32 v[52:53], v[52:53], 1.0 op_sel_hi:[1,0]
    v_pk_add_f32 v[54:55], v[54:55], 1.0 op_sel_hi:[1,0]
    v_pk_add_f32 v[56:57], v[56:57], 1.0 op_sel_hi:[1,0]
    v_pk_add_f32 v[58:59], v[58:59], 1.0 op_sel_hi:[1,0]
    v_rcp_f32 v52, v52
    v_rcp_f32 v53, v53
    v_rcp_f32 v54, v54
    v_rcp_f32 v55, v55
    v_rcp_f32 v56, v56
    v_rcp_f32 v57, v57
    v_rcp_f32 v58, v58
    v_rcp_f32 v59, v59
    v_lshlrev_b32 v148, 16, v216
    v_and_b32 v149, 0xffff0000, v216
    v_lshlrev_b32 v150, 16, v217
    v_and_b32 v151, 0xffff0000, v217
    v_lshlrev_b32 v152, 16, v218
    v_and_b32 v153, 0xffff0000, v218
    v_lshlrev_b32 v154, 16, v219
    v_and_b32 v155, 0xffff0000, v219
    v_pk_mul_f32 v[36:37], v[52:53], v[36:37]
    v_pk_mul_f32 v[38:39], v[54:55], v[38:39]
    v_pk_mul_f32 v[40:41], v[56:57], v[40:41]
    v_pk_mul_f32 v[42:43], v[58:59], v[42:43]
    s_mov_b32 s43, 0x8000
L_slp_89:
    s_waitcnt vmcnt(0)
    v_max3_u32 v60, v224, v225, v226
    v_max3_u32 v60, v60, v227, v228
    v_max3_u32 v60, v60, v229, v230
    v_max_u32 v60, v60, v231
    v_cmp_eq_u32 s[44:45], -1, v60
    s_nop 1
    s_cmp_eq_u64 s[44:45], 0
    s_cbranch_scc1 L_sok_88
    buffer_load_dwordx4 v[224:227], v250, s[16:19], s81 offen offset:0 sc1
    buffer_load_dwordx4 v[228:231], v250, s[16:19], s81 offen offset:1024 sc1
    s_sub_u32 s43, s43, 1
    s_cbranch_scc0 L_slp_89
    s_waitcnt vmcnt(0)
L_sok_88:
    ds_write_b128 v238, v[224:227] offset:0
    ds_write_b128 v238, v[228:231] offset:1024
    s_waitcnt lgkmcnt(0)
    ds_read_b64_tr_b16 v[224:225], v237 offset:0
    ds_read_b64_tr_b16 v[226:227], v237 offset:256
    ds_read_b64_tr_b16 v[228:229], v237 offset:1024
    ds_read_b64_tr_b16 v[230:231], v237 offset:1280
    s_waitcnt lgkmcnt(2)
    v_lshlrev_b32 v64, 16, v224
    v_and_b32 v65, 0xffff0000, v224
    v_lshlrev_b32 v66, 16, v225
    v_and_b32 v67, 0xffff0000, v225
    v_lshlrev_b32 v68, 16, v226
    v_and_b32 v69, 0xffff0000, v226
    v_lshlrev_b32 v70, 16, v227
    v_and_b32 v71, 0xffff0000, v227
    v_pk_fma_f32 v[28:29], v[28:29], v[64:65], v[116:117]
    v_pk_fma_f32 v[30:31], v[30:31], v[66:67], v[118:119]
    v_pk_fma_f32 v[32:33], v[32:33], v[68:69], v[120:121]
    v_pk_fma_f32 v[34:35], v[34:35], v[70:71], v[122:123]
    v_cvt_pk_bf16_f32 v212, v28, v29
    v_cvt_pk_bf16_f32 v213, v30, v31
    v_cvt_pk_bf16_f32 v214, v32, v33
    v_cvt_pk_bf16_f32 v215, v34, v35
    s_waitcnt lgkmcnt(0)
    v_lshlrev_b32 v72, 16, v228
    v_and_b32 v73, 0xffff0000, v228
    v_lshlrev_b32 v74, 16, v229
    v_and_b32 v75, 0xffff0000, v229
    v_lshlrev_b32 v76, 16, v230
    v_and_b32 v77, 0xffff0000, v230
    v_lshlrev_b32 v78, 16, v231
    v_and_b32 v79, 0xffff0000, v231
    v_pk_fma_f32 v[36:37], v[36:37], v[72:73], v[148:149]
    v_pk_fma_f32 v[38:39], v[38:39], v[74:75], v[150:151]
    v_pk_fma_f32 v[40:41], v[40:41], v[76:77], v[152:153]
    v_pk_fma_f32 v[42:43], v[42:43], v[78:79], v[154:155]
    v_cvt_pk_bf16_f32 v216, v36, v37
    v_cvt_pk_bf16_f32 v217, v38, v39
    v_cvt_pk_bf16_f32 v218, v40, v41
    v_cvt_pk_bf16_f32 v219, v42, v43
    s_nop 1
    v_permlane16_swap_b32 v212, v216
    v_permlane16_swap_b32 v213, v217
    v_permlane16_swap_b32 v214, v218
    v_permlane16_swap_b32 v215, v219
    s_add_u32 s43, s82, 18432
    buffer_store_dwordx4 v[212:215], v240, s[76:79], s82 offen sc1
    buffer_store_dwordx4 v[216:219], v240, s[76:79], s43 offen sc1
    s_branch L_ka_fin
L_fin3:
    v_lshlrev_b32 v28, 16, v116
    v_and_b32 v29, 0xffff0000, v116
    v_lshlrev_b32 v30, 16, v117
    v_and_b32 v31, 0xffff0000, v117
    v_lshlrev_b32 v32, 16, v118
    v_and_b32 v33, 0xffff0000, v118
    v_lshlrev_b32 v34, 16, v119
    v_and_b32 v35, 0xffff0000, v119
    v_dot2c_f32_bf16 v28, s40, v120
    v_dot2c_f32_bf16 v29, s41, v120
    v_dot2c_f32_bf16 v30, s40, v121
    v_dot2c_f32_bf16 v31, s41, v121
    v_dot2c_f32_bf16 v32, s40, v122
    v_dot2c_f32_bf16 v33, s41, v122
    v_dot2c_f32_bf16 v34, s40, v123
    v_dot2c_f32_bf16 v35, s41, v123
    v_dot2c_f32_bf16 v28, s40, v124
    v_dot2c_f32_bf16 v29, s41, v124
    v_dot2c_f32_bf16 v30, s40, v125
    v_dot2c_f32_bf16 v31, s41, v125
    v_dot2c_f32_bf16 v32, s40, v126
    v_dot2c_f32_bf16 v33, s41, v126
    v_dot2c_f32_bf16 v34, s40, v127
    v_dot2c_f32_bf16 v35, s41, v127
    v_dot2c_f32_bf16 v28, s40, v128
    v_dot2c_f32_bf16 v29, s41, v128
    v_dot2c_f32_bf16 v30, s40, v129
    v_dot2c_f32_bf16 v31, s41, v129
    v_dot2c_f32_bf16 v32, s40, v130
    v_dot2c_f32_bf16 v33, s41, v130
    v_dot2c_f32_bf16 v34, s40, v131
    v_dot2c_f32_bf16 v35, s41, v131
    v_dot2c_f32_bf16 v28, s40, v132
    v_dot2c_f32_bf16 v29, s41, v132
    v_dot2c_f32_bf16 v30, s40, v133
    v_dot2c_f32_bf16 v31, s41, v133
    v_dot2c_f32_bf16 v32, s40, v134
    v_dot2c_f32_bf16 v33, s41, v134
    v_dot2c_f32_bf16 v34, s40, v135
    v_dot2c_f32_bf16 v35, s41, v135
    v_dot2c_f32_bf16 v28, s40, v136
    v_dot2c_f32_bf16 v29, s41, v136
    v_dot2c_f32_bf16 v30, s40, v137
    v_dot2c_f32_bf16 v31, s41, v137
    v_dot2c_f32_bf16 v32, s40, v138
    v_dot2c_f32_bf16 v33, s41, v138
    v_dot2c_f32_bf16 v34, s40, v139
    v_dot2c_f32_bf16 v35, s41, v139
    v_dot2c_f32_bf16 v28, s40, v140
    v_dot2c_f32_bf16 v29, s41, v140
    v_dot2c_f32_bf16 v30, s40, v141
    v_dot2c_f32_bf16 v31, s41, v141
    v_dot2c_f32_bf16 v32, s40, v142
    v_dot2c_f32_bf16 v33, s41, v142
    v_dot2c_f32_bf16 v34, s40, v143
    v_dot2c_f32_bf16 v35, s41, v143
    v_dot2c_f32_bf16 v28, s40, v144
    v_dot2c_f32_bf16 v29, s41, v144
    v_dot2c_f32_bf16 v30, s40, v145
    v_dot2c_f32_bf16 v31, s41, v145
    v_dot2c_f32_bf16 v32, s40, v146
    v_dot2c_f32_bf16 v33, s41, v146
    v_dot2c_f32_bf16 v34, s40, v147
    v_dot2c_f32_bf16 v35, s41, v147
    s_nop 2
    v_permlane32_swap_b32 v28, v32
    v_permlane32_swap_b32 v29, v33
    v_permlane32_swap_b32 v30, v34
    v_permlane32_swap_b32 v31, v35
    v_pk_mul_f32 v[52:53], v[28:29], s[46:47]
    v_pk_mul_f32 v[54:55], v[30:31], s[46:47]
    v_pk_mul_f32 v[56:57], v[32:33], s[46:47]
    v_pk_mul_f32 v[58:59], v[34:35], s[46:47]
    v_exp_f32 v52, v52
    v_exp_f32 v53, v53
    v_exp_f32 v54, v54
    v_exp_f32 v55, v55
    v_exp_f32 v56, v56
    v_exp_f32 v57, v57
    v_exp_f32 v58, v58
    v_exp_f32 v59, v59
    v_pk_add_f32 v[52:53], v[52:53], 1.0 op_sel_hi:[1,0]
    v_pk_add_f32 v[54:55], v[54:55], 1.0 op_sel_hi:[1,0]
    v_pk_add_f32 v[56:57], v[56:57], 1.0 op_sel_hi:[1,0]
    v_pk_add_f32 v[58:59], v[58:59], 1.0 op_sel_hi:[1,0]
    v_rcp_f32 v52, v52
    v_rcp_f32 v53, v53
    v_rcp_f32 v54, v54
    v_rcp_f32 v55, v55
    v_rcp_f32 v56, v56
    v_rcp_f32 v57, v57
    v_rcp_f32 v58, v58
    v_rcp_f32 v59, v59
    v_lshlrev_b32 v116, 16, v212
    v_and_b32 v117, 0xffff0000, v212
    v_lshlrev_b32 v118, 16, v213
    v_and_b32 v119, 0xffff0000, v213
    v_lshlrev_b32 v120, 16, v214
    v_and_b32 v121, 0xffff0000, v214
    v_lshlrev_b32 v122, 16, v215
    v_and_b32 v123, 0xffff0000, v215
    v_pk_mul_f32 v[28:29], v[52:53], v[28:29]
    v_pk_mul_f32 v[30:31], v[54:55], v[30:31]
    v_pk_mul_f32 v[32:33], v[56:57], v[32:33]
    v_pk_mul_f32 v[34:35], v[58:59], v[34:35]
    v_lshlrev_b32 v36, 16, v148
    v_and_b32 v37, 0xffff0000, v148
    v_lshlrev_b32 v38, 16, v149
    v_and_b32 v39, 0xffff0000, v149
    v_lshlrev_b32 v40, 16, v150
    v_and_b32 v41, 0xffff0000, v150
    v_lshlrev_b32 v42, 16, v151
    v_and_b32 v43, 0xffff0000, v151
    v_dot2c_f32_bf16 v36, s40, v152
    v_dot2c_f32_bf16 v37, s41, v152
    v_dot2c_f32_bf16 v38, s40, v153
    v_dot2c_f32_bf16 v39, s41, v153
    v_dot2c_f32_bf16 v40, s40, v154
    v_dot2c_f32_bf16 v41, s41, v154
    v_dot2c_f32_bf16 v42, s40, v155
    v_dot2c_f32_bf16 v43, s41, v155
    v_dot2c_f32_bf16 v36, s40, v156
    v_dot2c_f32_bf16 v37, s41, v156
    v_dot2c_f32_bf16 v38, s40, v157
    v_dot2c_f32_bf16 v39, s41, v157
    v_dot2c_f32_bf16 v40, s40, v158
    v_dot2c_f32_bf16 v41, s41, v158
    v_dot2c_f32_bf16 v42, s40, v159
    v_dot2c_f32_bf16 v43, s41, v159
    v_dot2c_f32_bf16 v36, s40, v160
    v_dot2c_f32_bf16 v37, s41, v160
    v_dot2c_f32_bf16 v38, s40, v161
    v_dot2c_f32_bf16 v39, s41, v161
    v_dot2c_f32_bf16 v40, s40, v162
    v_dot2c_f32_bf16 v41, s41, v162
    v_dot2c_f32_bf16 v42, s40, v163
    v_dot2c_f32_bf16 v43, s41, v163
    v_dot2c_f32_bf16 v36, s40, v164
    v_dot2c_f32_bf16 v37, s41, v164
    v_dot2c_f32_bf16 v38, s40, v165
    v_dot2c_f32_bf16 v39, s41, v165
    v_dot2c_f32_bf16 v40, s40, v166
    v_dot2c_f32_bf16 v41, s41, v166
    v_dot2c_f32_bf16 v42, s40, v167
    v_dot2c_f32_bf16 v43, s41, v167
    v_dot2c_f32_bf16 v36, s40, v168
    v_dot2c_f32_bf16 v37, s41, v168
    v_dot2c_f32_bf16 v38, s40, v169
    v_dot2c_f32_bf16 v39, s41, v169
    v_dot2c_f32_bf16 v40, s40, v170
    v_dot2c_f32_bf16 v41, s41, v170
    v_dot2c_f32_bf16 v42, s40, v171
    v_dot2c_f32_bf16 v43, s41, v171
    v_dot2c_f32_bf16 v36, s40, v172
    v_dot2c_f32_bf16 v37, s41, v172
    v_dot2c_f32_bf16 v38, s40, v173
    v_dot2c_f32_bf16 v39, s41, v173
    v_dot2c_f32_bf16 v40, s40, v174
    v_dot2c_f32_bf16 v41, s41, v174
    v_dot2c_f32_bf16 v42, s40, v175
    v_dot2c_f32_bf16 v43, s41, v175
    v_dot2c_f32_bf16 v36, s40, v176
    v_dot2c_f32_bf16 v37, s41, v176
    v_dot2c_f32_bf16 v38, s40, v177
    v_dot2c_f32_bf16 v39, s41, v177
    v_dot2c_f32_bf16 v40, s40, v178
    v_dot2c_f32_bf16 v41, s41, v178
    v_dot2c_f32_bf16 v42, s40, v179
    v_dot2c_f32_bf16 v43, s41, v179
    s_nop 2
    v_permlane32_swap_b32 v36, v40
    v_permlane32_swap_b32 v37, v41
    v_permlane32_swap_b32 v38, v42
    v_permlane32_swap_b32 v39, v43
    v_pk_mul_f32 v[52:53], v[36:37], s[46:47]
    v_pk_mul_f32 v[54:55], v[38:39], s[46:47]
    v_pk_mul_f32 v[56:57], v[40:41], s[46:47]
    v_pk_mul_f32 v[58:59], v[42:43], s[46:47]
    v_exp_f32 v52, v52
    v_exp_f32 v53, v53
    v_exp_f32 v54, v54
    v_exp_f32 v55, v55
    v_exp_f32 v56, v56
    v_exp_f32 v57, v57
    v_exp_f32 v58, v58
    v_exp_f32 v59, v59
    v_pk_add_f32 v[52:53], v[52:53], 1.0 op_sel_hi:[1,0]
    v_pk_add_f32 v[54:55], v[54:55], 1.0 op_sel_hi:[1,0]
    v_pk_add_f32 v[56:57], v[56:57], 1.0 op_sel_hi:[1,0]
    v_pk_add_f32 v[58:59], v[58:59], 1.0 op_sel_hi:[1,0]
    v_rcp_f32 v52, v52
    v_rcp_f32 v53, v53
    v_rcp_f32 v54, v54
    v_rcp_f32 v55, v55
    v_rcp_f32 v56, v56
    v_rcp_f32 v57, v57
    v_rcp_f32 v58, v58
    v_rcp_f32 v59, v59
    v_lshlrev_b32 v148, 16, v216
    v_and_b32 v149, 0xffff0000, v216
    v_lshlrev_b32 v150, 16, v217
    v_and_b32 v151, 0xffff0000, v217
    v_lshlrev_b32 v152, 16, v218
    v_and_b32 v153, 0xffff0000, v218
    v_lshlrev_b32 v154, 16, v219
    v_and_b32 v155, 0xffff0000, v219
    v_pk_mul_f32 v[36:37], v[52:53], v[36:37]
    v_pk_mul_f32 v[38:39], v[54:55], v[38:39]
    v_pk_mul_f32 v[40:41], v[56:57], v[40:41]
    v_pk_mul_f32 v[42:43], v[58:59], v[42:43]
    buffer_load_dwordx4 v[224:227], v250, s[16:19], s81 offen offset:0 sc1
    buffer_load_dwordx4 v[228:231], v250, s[16:19], s81 offen offset:1024 sc1
    buffer_load_dwordx4 v[232:235], v244, s[16:19], s88 offen offset:0 sc1
    v_lshlrev_b32 v44, 16, v180
    v_and_b32 v45, 0xffff0000, v180
    v_lshlrev_b32 v46, 16, v181
    v_and_b32 v47, 0xffff0000, v181
    v_lshlrev_b32 v48, 16, v182
    v_and_b32 v49, 0xffff0000, v182
    v_lshlrev_b32 v50, 16, v183
    v_and_b32 v51, 0xffff0000, v183
    v_dot2c_f32_bf16 v44, s40, v184
    v_dot2c_f32_bf16 v45, s41, v184
    v_dot2c_f32_bf16 v46, s40, v185
    v_dot2c_f32_bf16 v47, s41, v185
    v_dot2c_f32_bf16 v48, s40, v186
    v_dot2c_f32_bf16 v49, s41, v186
    v_dot2c_f32_bf16 v50, s40, v187
    v_dot2c_f32_bf16 v51, s41, v187
    v_dot2c_f32_bf16 v44, s40, v188
    v_dot2c_f32_bf16 v45, s41, v188
    v_dot2c_f32_bf16 v46, s40, v189
    v_dot2c_f32_bf16 v47, s41, v189
    v_dot2c_f32_bf16 v48, s40, v190
    v_dot2c_f32_bf16 v49, s41, v190
    v_dot2c_f32_bf16 v50, s40, v191
    v_dot2c_f32_bf16 v51, s41, v191
    v_dot2c_f32_bf16 v44, s40, v192
    v_dot2c_f32_bf16 v45, s41, v192
    v_dot2c_f32_bf16 v46, s40, v193
    v_dot2c_f32_bf16 v47, s41, v193
    v_dot2c_f32_bf16 v48, s40, v194
    v_dot2c_f32_bf16 v49, s41, v194
    v_dot2c_f32_bf16 v50, s40, v195
    v_dot2c_f32_bf16 v51, s41, v195
    v_dot2c_f32_bf16 v44, s40, v196
    v_dot2c_f32_bf16 v45, s41, v196
    v_dot2c_f32_bf16 v46, s40, v197
    v_dot2c_f32_bf16 v47, s41, v197
    v_dot2c_f32_bf16 v48, s40, v198
    v_dot2c_f32_bf16 v49, s41, v198
    v_dot2c_f32_bf16 v50, s40, v199
    v_dot2c_f32_bf16 v51, s41, v199
    v_dot2c_f32_bf16 v44, s40, v200
    v_dot2c_f32_bf16 v45, s41, v200
    v_dot2c_f32_bf16 v46, s40, v201
    v_dot2c_f32_bf16 v47, s41, v201
    v_dot2c_f32_bf16 v48, s40, v202
    v_dot2c_f32_bf16 v49, s41, v202
    v_dot2c_f32_bf16 v50, s40, v203
    v_dot2c_f32_bf16 v51, s41, v203
    v_dot2c_f32_bf16 v44, s40, v204
    v_dot2c_f32_bf16 v45, s41, v204
    v_dot2c_f32_bf16 v46, s40, v205
    v_dot2c_f32_bf16 v47, s41, v205
    v_dot2c_f32_bf16 v48, s40, v206
    v_dot2c_f32_bf16 v49, s41, v206
    v_dot2c_f32_bf16 v50, s40, v207
    v_dot2c_f32_bf16 v51, s41, v207
    v_dot2c_f32_bf16 v44, s40, v208
    v_dot2c_f32_bf16 v45, s41, v208
    v_dot2c_f32_bf16 v46, s40, v209
    v_dot2c_f32_bf16 v47, s41, v209
    v_dot2c_f32_bf16 v48, s40, v210
    v_dot2c_f32_bf16 v49, s41, v210
    v_dot2c_f32_bf16 v50, s40, v211
    v_dot2c_f32_bf16 v51, s41, v211
    s_nop 2
    v_permlane32_swap_b32 v44, v48
    v_permlane32_swap_b32 v45, v49
    v_permlane32_swap_b32 v46, v50
    v_permlane32_swap_b32 v47, v51
    v_pk_mul_f32 v[52:53], v[44:45], s[46:47]
    v_pk_mul_f32 v[54:55], v[46:47], s[46:47]
    v_pk_mul_f32 v[56:57], v[48:49], s[46:47]
    v_pk_mul_f32 v[58:59], v[50:51], s[46:47]
    v_exp_f32 v52, v52
    v_exp_f32 v53, v53
    v_exp_f32 v54, v54
    v_exp_f32 v55, v55
    v_exp_f32 v56, v56
    v_exp_f32 v57, v57
    v_exp_f32 v58, v58
    v_exp_f32 v59, v59
    v_pk_add_f32 v[52:53], v[52:53], 1.0 op_sel_hi:[1,0]
    v_pk_add_f32 v[54:55], v[54:55], 1.0 op_sel_hi:[1,0]
    v_pk_add_f32 v[56:57], v[56:57], 1.0 op_sel_hi:[1,0]
    v_pk_add_f32 v[58:59], v[58:59], 1.0 op_sel_hi:[1,0]
    v_rcp_f32 v52, v52
    v_rcp_f32 v53, v53
    v_rcp_f32 v54, v54
    v_rcp_f32 v55, v55
    v_rcp_f32 v56, v56
    v_rcp_f32 v57, v57
    v_rcp_f32 v58, v58
    v_rcp_f32 v59, v59
    v_lshlrev_b32 v180, 16, v220
    v_and_b32 v181, 0xffff0000, v220
    v_lshlrev_b32 v182, 16, v221
    v_and_b32 v183, 0xffff0000, v221
    v_lshlrev_b32 v184, 16, v222
    v_and_b32 v185, 0xffff0000, v222
    v_lshlrev_b32 v186, 16, v223
    v_and_b32 v187, 0xffff0000, v223
    v_pk_mul_f32 v[44:45], v[52:53], v[44:45]
    v_pk_mul_f32 v[46:47], v[54:55], v[46:47]
    v_pk_mul_f32 v[48:49], v[56:57], v[48:49]
    v_pk_mul_f32 v[50:51], v[58:59], v[50:51]
    s_mov_b32 s43, 0x8000
L_slp_91:
    s_waitcnt vmcnt(0)
    v_max3_u32 v60, v224, v225, v226
    v_max3_u32 v60, v60, v227, v228
    v_max3_u32 v60, v60, v229, v230
    v_max3_u32 v60, v60, v231, v232
    v_max3_u32 v60, v60, v233, v234
    v_max_u32 v60, v60, v235
    v_cmp_eq_u32 s[44:45], -1, v60
    s_nop 1
    s_cmp_eq_u64 s[44:45], 0
    s_cbranch_scc1 L_sok_90
    buffer_load_dwordx4 v[224:227], v250, s[16:19], s81 offen offset:0 sc1
    buffer_load_dwordx4 v[228:231], v250, s[16:19], s81 offen offset:1024 sc1
    buffer_load_dwordx4 v[232:235], v244, s[16:19], s88 offen offset:0 sc1
    s_sub_u32 s43, s43, 1
    s_cbranch_scc0 L_slp_91
    s_waitcnt vmcnt(0)
L_sok_90:
    ds_write_b128 v238, v[224:227] offset:0
    ds_write_b128 v238, v[228:231] offset:1024
    ds_write_b128 v238, v[232:235] offset:2048
    s_waitcnt lgkmcnt(0)
    ds_read_b64_tr_b16 v[224:225], v237 offset:0
    ds_read_b64_tr_b16 v[226:227], v237 offset:256
    ds_read_b64_tr_b16 v[228:229], v237 offset:1024
    ds_read_b64_tr_b16 v[230:231], v237 offset:1280
    ds_read_b64_tr_b16 v[232:233], v245 offset:0
    ds_read_b64_tr_b16 v[234:235], v245 offset:128
    s_waitcnt lgkmcnt(4)
    v_lshlrev_b32 v64, 16, v224
    v_and_b32 v65, 0xffff0000, v224
    v_lshlrev_b32 v66, 16, v225
    v_and_b32 v67, 0xffff0000, v225
    v_lshlrev_b32 v68, 16, v226
    v_and_b32 v69, 0xffff0000, v226
    v_lshlrev_b32 v70, 16, v227
    v_and_b32 v71, 0xffff0000, v227
    v_pk_fma_f32 v[28:29], v[28:29], v[64:65], v[116:117]
    v_pk_fma_f32 v[30:31], v[30:31], v[66:67], v[118:119]
    v_pk_fma_f32 v[32:33], v[32:33], v[68:69], v[120:121]
    v_pk_fma_f32 v[34:35], v[34:35], v[70:71], v[122:123]
    v_cvt_pk_bf16_f32 v212, v28, v29
    v_cvt_pk_bf16_f32 v213, v30, v31
    v_cvt_pk_bf16_f32 v214, v32, v33
    v_cvt_pk_bf16_f32 v215, v34, v35
    s_waitcnt lgkmcnt(2)
    v_lshlrev_b32 v72, 16, v228
    v_and_b32 v73, 0xffff0000, v228
    v_lshlrev_b32 v74, 16, v229
    v_and_b32 v75, 0xffff0000, v229
    v_lshlrev_b32 v76, 16, v230
    v_and_b32 v77, 0xffff0000, v230
    v_lshlrev_b32 v78, 16, v231
    v_and_b32 v79, 0xffff0000, v231
    v_pk_fma_f32 v[36:37], v[36:37], v[72:73], v[148:149]
    v_pk_fma_f32 v[38:39], v[38:39], v[74:75], v[150:151]
    v_pk_fma_f32 v[40:41], v[40:41], v[76:77], v[152:153]
    v_pk_fma_f32 v[42:43], v[42:43], v[78:79], v[154:155]
    v_cvt_pk_bf16_f32 v216, v36, v37
    v_cvt_pk_bf16_f32 v217, v38, v39
    v_cvt_pk_bf16_f32 v218, v40, v41
    v_cvt_pk_bf16_f32 v219, v42, v43
    s_nop 1
    v_permlane16_swap_b32 v212, v216
    v_permlane16_swap_b32 v213, v217
    v_permlane16_swap_b32 v214, v218
    v_permlane16_swap_b32 v215, v219
    s_add_u32 s43, s82, 18432
    buffer_store_dwordx4 v[212:215], v240, s[76:79], s82 offen sc1
    buffer_store_dwordx4 v[216:219], v240, s[76:79], s43 offen sc1
    s_waitcnt lgkmcnt(0)
    v_lshlrev_b32 v80, 16, v232
    v_and_b32 v81, 0xffff0000, v232
    v_lshlrev_b32 v82, 16, v233
    v_and_b32 v83, 0xffff0000, v233
    v_lshlrev_b32 v84, 16, v234
    v_and_b32 v85, 0xffff0000, v234
    v_lshlrev_b32 v86, 16, v235
    v_and_b32 v87, 0xffff0000, v235
    v_pk_fma_f32 v[44:45], v[44:45], v[80:81], v[180:181]
    v_pk_fma_f32 v[46:47], v[46:47], v[82:83], v[182:183]
    v_pk_fma_f32 v[48:49], v[48:49], v[84:85], v[184:185]
    v_pk_fma_f32 v[50:51], v[50:51], v[86:87], v[186:187]
    v_cvt_pk_bf16_f32 v220, v44, v45
    v_cvt_pk_bf16_f32 v221, v46, v47
    v_cvt_pk_bf16_f32 v222, v48, v49
    v_cvt_pk_bf16_f32 v223, v50, v51
    buffer_store_dwordx4 v[220:223], v240, s[76:79], s84 offen sc1
L_ka_fin:
    s_cmp_eq_u32 s20, 0
    s_cbranch_scc0 L_xad_92
    v_accvgpr_read_b32 v254, a252
    v_mul_lo_u32 v254, v254, s50
    v_add_u32 v254, 0x7f4a7c15, v254
    s_mov_b64 exec, 1
    buffer_store_dword v254, v251, s[16:19], s69 offen sc1
    s_mov_b64 exec, -1
L_xad_92:
L_ka_end:
    s_endpgm
L_code_end:
.section .rodata,"a"
.p2align 6
.amdhsa_kernel recurrent_scan__ssm_conv_s4__dense_activation_silu__prompt_kernel
  .amdhsa_next_free_vgpr 512
  .amdhsa_next_free_sgpr 102
  .amdhsa_accum_offset 256
  .amdhsa_group_segment_fixed_size 0
  .amdhsa_kernarg_size 120
  .amdhsa_user_sgpr_count 2
  .amdhsa_user_sgpr_kernarg_segment_ptr 1
  .amdhsa_system_sgpr_workgroup_id_x 1
.end_amdhsa_kernel
```
